```python
import torch

def _softmax(x, axis=-1):
    return torch.softmax(x, dim=axis)
def _gelu(x):
    return torch.nn.functional.gelu(x, approximate="tanh")
def _silu(x):
    return torch.nn.functional.silu(x)
def _sigmoid(x):
    return torch.sigmoid(x)
def _layernorm(x, axis=-1, eps=1e-5):
    m = x.mean(dim=axis, keepdim=True)
    v = x.var(dim=axis, keepdim=True, unbiased=False)
    return (x - m) / torch.sqrt(v + eps)
def _scatter_add(tgt, idx, src, axis=0):
    return tgt.clone().index_add_(axis, idx, src)
def _segment_sum(src, seg, n):
    out = torch.zeros((n,) + src.shape[1:], dtype=src.dtype)
    return out.index_add_(0, seg, src)
def _pad(x, pw):
    flat = tuple(v for pair in reversed(pw) for v in pair)
    return torch.nn.functional.pad(x, flat)

kernel_name = 'concat_heads__gqa_block_cached__gqa_block_cached__near_ridge'

def setup_inputs():

    _w = (lambda a: (lambda t: t.to(torch.bfloat16) if t.is_floating_point() else t)(torch.as_tensor(a)))
    def _A_setup():
        B, Sq, D = 8, 192, 640
        Hq, Hkv, Sk, Dh = 32, 32, 1024, 128
        assert Hq % Hkv == 0, (Hq, Hkv)
        return {
            "x": _w((lambda *s: torch.randn(*s, dtype=torch.bfloat16) * 0.8)(B, Sq, D)),
            "k_cache": _w((lambda *s: torch.randn(*s, dtype=torch.bfloat16) * 0.8)(B, Hkv, Sk, Dh)),
            "v_cache": _w((lambda *s: torch.randn(*s, dtype=torch.bfloat16) * 0.05)(B, Hkv, Sk, Dh)),
            "wq": _w((lambda *s: torch.randn(*s, dtype=torch.bfloat16) * 0.8)(D, Hq * Dh) * (D ** -0.5)),
            "wo": _w((lambda *s: torch.randn(*s, dtype=torch.bfloat16) * 0.05)(Hq * Dh, D) * ((Hq * Dh) ** -0.5)),
        }
    _A_in = _A_setup()

    def _B_setup():
        B, Sq, D = 8, 192, 640
        Hq, Hkv, Sk, Dh = 32, 32, 1024, 128
        assert Hq % Hkv == 0, (Hq, Hkv)
        return {
            "x": _w((lambda *s: torch.randn(*s, dtype=torch.bfloat16) * 0.8)(B, Sq, D)),
            "k_cache": _w((lambda *s: torch.randn(*s, dtype=torch.bfloat16) * 0.8)(B, Hkv, Sk, Dh)),
            "v_cache": _w((lambda *s: torch.randn(*s, dtype=torch.bfloat16) * 0.05)(B, Hkv, Sk, Dh)),
            "wq": _w((lambda *s: torch.randn(*s, dtype=torch.bfloat16) * 0.8)(D, Hq * Dh) * (D ** -0.5)),
            "wo": _w((lambda *s: torch.randn(*s, dtype=torch.bfloat16) * 0.05)(Hq * Dh, D) * ((Hq * Dh) ** -0.5)),
        }
    _B_in = _B_setup()

    return {
        "A_x": _A_in["x"],
        "A_k_cache": _A_in["k_cache"],
        "A_v_cache": _A_in["v_cache"],
        "A_wq": _A_in["wq"],
        "A_wo": _A_in["wo"],
        "B_x": _B_in["x"],
        "B_k_cache": _B_in["k_cache"],
        "B_v_cache": _B_in["v_cache"],
        "B_wq": _B_in["wq"],
        "B_wo": _B_in["wo"],
    }

def reference(A_x, A_k_cache, A_v_cache, A_wq, A_wo, B_x, B_k_cache, B_v_cache, B_wq, B_wo):
    def _A_ref(x, k_cache, v_cache, wq, wo):
        B, Sq, D = x.shape
        Hq, Dh = 32, 128
        Hkv = k_cache.shape[1]
        rep = Hq // Hkv
        q = (lambda x, *d: x.permute(*d))((x @ wq).reshape(B, Sq, Hq, Dh), 0, 2, 1, 3)
        k = (lambda x, n, axis: torch.repeat_interleave(x, n, dim=axis))(k_cache, rep, axis=1)
        v = (lambda x, n, axis: torch.repeat_interleave(x, n, dim=axis))(v_cache, rep, axis=1)
        scores = torch.einsum("bhqd,bhkd->bhqk", q, k) * (Dh ** -0.5)
        p = _softmax(scores, axis=-1)
        o = torch.einsum("bhqk,bhkd->bhqd", p, v)
        return (lambda x, *d: x.permute(*d))(o, 0, 2, 1, 3).reshape(B, Sq, Hq * Dh) @ wo

    def _B_ref(x, k_cache, v_cache, wq, wo):
        B, Sq, D = x.shape
        Hq, Dh = 32, 128
        Hkv = k_cache.shape[1]
        rep = Hq // Hkv
        q = (lambda x, *d: x.permute(*d))((x @ wq).reshape(B, Sq, Hq, Dh), 0, 2, 1, 3)
        k = (lambda x, n, axis: torch.repeat_interleave(x, n, dim=axis))(k_cache, rep, axis=1)
        v = (lambda x, n, axis: torch.repeat_interleave(x, n, dim=axis))(v_cache, rep, axis=1)
        scores = torch.einsum("bhqd,bhkd->bhqk", q, k) * (Dh ** -0.5)
        p = _softmax(scores, axis=-1)
        o = torch.einsum("bhqk,bhkd->bhqd", p, v)
        return (lambda x, *d: x.permute(*d))(o, 0, 2, 1, 3).reshape(B, Sq, Hq * Dh) @ wo

    a = _A_ref(A_x, A_k_cache, A_v_cache, A_wq, A_wo)
    b = _B_ref(B_x, B_k_cache, B_v_cache, B_wq, B_wo)
    return torch.concatenate([a, b], axis=-1)
```

```asm
; @launch kernel=attn_kernel grid=(256,1,1) block=(512,1,1) lds=163840
; @launch kernel=oproj_kernel grid=(240,1,1) block=(256,1,1) lds=131072
.amdgcn_target "amdgcn-amd-amdhsa--gfx950"
.text
.globl attn_kernel
.p2align 8
.type attn_kernel,@function
attn_kernel:
  s_cmp_ge_u32 s2, 256
  s_cbranch_scc1 A_END
  s_load_dwordx8 s[40:47], s[0:1], 0
  s_load_dwordx8 s[48:55], s[0:1], 40
  s_load_dwordx2 s[56:57], s[0:1], 96
  s_load_dwordx2 s[68:69], s[0:1], 32
  s_load_dwordx2 s[70:71], s[0:1], 72
  v_lshrrev_b32 v1, 6, v0
  v_and_b32 v0, 63, v0
  v_readfirstlane_b32 s3, v1
  s_nop 1
  s_lshr_b32 s29, s3, 2
  s_and_b32 s3, s3, 3
  s_lshl_b32 s38, s29, 8
  s_add_u32 s2, s2, s38
  s_mul_i32 s28, s29, 81920
  s_and_b32 s4, s2, 7
  s_lshr_b32 s5, s2, 3
  s_lshr_b32 s6, s4, 2
  s_and_b32 s7, s4, 1
  s_lshl_b32 s7, s7, 2
  s_and_b32 s38, s5, 3
  s_add_u32 s7, s7, s38
  s_bfe_u32 s4, s4, 0x10001
  s_lshl_b32 s4, s4, 4
  s_lshr_b32 s5, s5, 2
  s_add_u32 s4, s4, s5
  s_and_b32 s5, s5, 7
  s_mul_i32 s38, s38, 5
  s_add_u32 s38, s38, 1
  s_lshr_b32 s38, s38, 1
  s_add_u32 s60, s38, s5
  s_cmp_ge_u32 s60, 10
  s_cselect_b32 s38, 10, 0
  s_sub_u32 s60, s60, s38
  s_mov_b32 s30, s60
  s_lshl_b32 s32, s3, 11
  s_mov_b32 s33, 20480
  s_mov_b32 s34, 40960
  s_mov_b32 s36, 131072
  s_mov_b32 s37, 262144
  s_mov_b32 s31, 0
  s_mov_b32 s58, 0x3e0293ee
  s_mov_b32 s59, 0x3e0293ee
  v_and_b32 v6, 15, v0
  v_lshrrev_b32 v7, 4, v0
  v_bfe_u32 v8, v0, 2, 3
  v_lshrrev_b32 v9, 5, v0
  v_and_b32 v10, 3, v0
  v_lshrrev_b32 v11, 1, v8
  v_and_b32 v11, 2, v11
  v_xor_b32 v11, v11, v10
  v_lshlrev_b32 v11, 4, v11
  v_lshl_add_u32 v13, v9, 6, v11
  v_lshl_add_u32 v11, v8, 8, v13
  v_add_u32 v4, s32, v11
  v_lshlrev_b32 v11, 4, v10
  v_lshl_add_u32 v11, v9, 6, v11
  v_lshl_add_u32 v11, v8, 13, v11
  s_lshl_b32 s38, s3, 16
  v_add_u32 v108, s38, v11
  s_mul_i32 s38, s3, 61440
  v_mul_u32_u24 v11, 1280, v8
  v_add3_u32 v109, v11, v13, s38
  v_lshrrev_b32 v11, 2, v6
  v_lshlrev_b32 v11, 6, v11
  v_lshl_add_u32 v11, v10, 4, v11
  v_lshl_add_u32 v110, v7, 11, v11
  v_add_u32 v111, 0x10000, v110
  v_and_b32 v11, 7, v6
  v_lshrrev_b32 v12, 1, v11
  v_and_b32 v12, 2, v12
  v_xor_b32 v12, v12, v7
  v_lshlrev_b32 v12, 4, v12
  v_lshl_add_u32 v12, v11, 6, v12
  v_lshrrev_b32 v11, 3, v6
  v_lshl_add_u32 v1, v11, 11, v12
  v_lshl_add_u32 v13, v11, 10, v12
  v_add_u32 v14, s32, v13
  v_and_b32 v11, 1, v7
  v_lshrrev_b32 v12, 2, v6
  v_lshl_add_u32 v12, v11, 2, v12
  v_lshlrev_b32 v12, 6, v12
  v_lshl_add_u32 v12, v11, 5, v12
  v_lshl_add_u32 v12, v10, 3, v12
  v_lshrrev_b32 v11, 1, v7
  v_lshl_add_u32 v2, v11, 11, v12
  v_xor_b32 v3, 32, v2
  v_lshrrev_b32 v11, 2, v6
  v_lshlrev_b32 v11, 13, v11
  v_lshl_add_u32 v11, v7, 6, v11
  v_lshl_add_u32 v11, v10, 4, v11
  s_lshl_b32 s38, s3, 16
  v_add_u32 v108, s38, v11
  v_lshrrev_b32 v11, 2, v6
  v_lshlrev_b32 v12, 6, v10
  v_lshl_add_u32 v12, v11, 10, v12
  v_lshrrev_b32 v15, 1, v6
  v_and_b32 v15, 2, v15
  v_xor_b32 v15, v15, v7
  v_lshl_add_u32 v1, v15, 4, v12
  v_and_b32 v15, 1, v7
  v_lshlrev_b32 v12, 6, v11
  v_lshl_add_u32 v12, v15, 10, v12
  v_lshl_add_u32 v12, v15, 5, v12
  v_lshl_add_u32 v12, v10, 3, v12
  v_lshrrev_b32 v15, 1, v7
  v_lshl_add_u32 v2, v15, 11, v12
  v_xor_b32 v3, 32, v2
  v_lshlrev_b32 v12, 8, v11
  v_lshl_add_u32 v12, v7, 6, v12
  v_lshl_add_u32 v12, v10, 4, v12
  v_add_u32 v4, s32, v12
  v_mov_b32 v5, v14
  v_lshlrev_b32 v6, 7, v0
  v_xor_b32 v0, 32, v4
  s_add_u32 s32, s32, s28
  v_add_u32 v1, s28, v1
  v_add_u32 v2, s28, v2
  v_add_u32 v3, s28, v3
  v_add_u32 v110, s28, v110
  v_add_u32 v111, s28, v111
  v_add_u32 v6, 81920, v5
  s_mul_i32 s38, s29, 10240
  v_add_u32 v109, s38, v109
  s_lshl_b32 s33, s3, 1
  s_add_u32 s33, s33, s29
  s_lshl_b32 s33, s33, 10
  s_waitcnt lgkmcnt(0)
  s_cmp_eq_u32 s6, 0
  s_cselect_b32 s40, s40, s48
  s_cselect_b32 s41, s41, s49
  s_cselect_b32 s42, s42, s50
  s_cselect_b32 s43, s43, s51
  s_cselect_b32 s44, s44, s52
  s_cselect_b32 s45, s45, s53
  s_cselect_b32 s46, s46, s54
  s_cselect_b32 s47, s47, s55
  s_lshl_b32 s38, s7, 5
  s_add_u32 s38, s38, s4
  s_lshl_b32 s38, s38, 18
  s_add_u32 s8, s42, s38
  s_addc_u32 s9, s43, 0
  s_mov_b32 s10, 262144
  s_mov_b32 s11, 0x20000
  s_add_u32 s12, s44, s38
  s_addc_u32 s13, s45, 0
  s_mov_b32 s14, 262144
  s_mov_b32 s15, 0x20000
  s_mul_i32 s38, s7, 245760
  s_add_u32 s16, s40, s38
  s_addc_u32 s17, s41, 0
  s_mov_b32 s18, 245760
  s_mov_b32 s19, 0x20000
  s_lshl_b32 s38, s4, 8
  s_add_u32 s20, s46, s38
  s_addc_u32 s21, s47, 0
  s_sub_u32 s22, 5242880, s38
  s_mov_b32 s23, 0x20000
  s_mul_i32 s38, s7, 12
  s_mul_i32 s39, s3, 3
  s_add_u32 s38, s38, s39
  s_lshl_b32 s38, s38, 17
  s_mul_i32 s39, s6, 12582912
  s_add_u32 s38, s38, s39
  s_lshl_b32 s39, s4, 12
  s_add_u32 s38, s38, s39
  s_add_u32 s24, s56, s38
  s_addc_u32 s25, s57, 0
  s_mov_b32 s26, 266240
  s_mov_b32 s27, 0x20000
  s_cmp_lt_u32 s2, 256
  s_cselect_b32 s68, s68, s70
  s_cselect_b32 s69, s69, s71
  s_and_b32 s38, s2, 255
  s_mul_i32 s38, s38, 20480
  s_mul_i32 s39, s3, 3072
  s_add_u32 s38, s38, s39
  s_add_u32 s68, s68, s38
  s_addc_u32 s69, s69, 0
  s_mov_b32 s70, 11264
  s_mov_b32 s71, 0x20000
  s_lshl_b32 s52, s30, 7
  s_lshl_b32 s35, s30, 19
  s_mul_i32 s53, s4, 0
  s_mul_i32 s38, s7, 0
  s_add_u32 s53, s53, s38
  s_mul_i32 s38, s6, 0
  s_add_u32 s53, s53, s38
  s_and_b32 s53, s53, 31
  s_lshl_b32 s53, s53, 13
  s_add_u32 m0, s32, 65536
  s_nop 0
  buffer_load_dwordx4 v108, s[20:23], s35 offen lds
  s_add_u32 m0, s32, 66560
  s_add_u32 s38, s35, 32768
  buffer_load_dwordx4 v108, s[20:23], s38 offen lds
  s_add_u32 m0, s33, 40960
  s_add_u32 s38, s52, 0
  buffer_load_dwordx4 v109, s[16:19], s38 offen lds
  s_add_u32 m0, s33, 16384
  s_add_u32 s38, s52, 20480
  buffer_load_dwordx4 v109, s[16:19], s38 offen lds
  s_add_u32 m0, s33, 49152
  s_add_u32 s38, s52, 40960
  buffer_load_dwordx4 v109, s[16:19], s38 offen lds
  s_add_u32 s35, s35, 262144
  s_add_u32 m0, s32, 73728
  s_nop 0
  buffer_load_dwordx4 v108, s[20:23], s35 offen lds
  s_add_u32 m0, s32, 74752
  s_add_u32 s38, s35, 32768
  buffer_load_dwordx4 v108, s[20:23], s38 offen lds
  s_add_u32 s35, s35, 262144
  s_cmp_eq_u32 s35, 5242880
  s_cselect_b32 s35, 0, s35
  s_add_u32 m0, s32, 57344
  s_nop 0
  buffer_load_dwordx4 v108, s[20:23], s35 offen lds
  s_add_u32 m0, s32, 58368
  s_add_u32 s38, s35, 32768
  buffer_load_dwordx4 v108, s[20:23], s38 offen lds
  s_add_u32 s52, s52, 128
  s_cmp_eq_u32 s52, 1280
  s_cselect_b32 s52, 0, s52
  s_add_u32 m0, s33, 122880
  s_add_u32 s38, s52, 0
  buffer_load_dwordx4 v109, s[16:19], s38 offen lds
  s_add_u32 m0, s33, 98304
  s_add_u32 s38, s52, 20480
  buffer_load_dwordx4 v109, s[16:19], s38 offen lds
  s_add_u32 m0, s33, 131072
  s_add_u32 s38, s52, 40960
  buffer_load_dwordx4 v109, s[16:19], s38 offen lds
  s_add_u32 s52, s52, 128
  s_cmp_eq_u32 s52, 1280
  s_cselect_b32 s52, 0, s52
  s_add_u32 m0, s33, 0
  s_add_u32 s38, s52, 0
  buffer_load_dwordx4 v109, s[16:19], s38 offen lds
  s_add_u32 m0, s33, 8192
  s_add_u32 s38, s52, 20480
  buffer_load_dwordx4 v109, s[16:19], s38 offen lds
  s_add_u32 m0, s33, 32768
  s_add_u32 s38, s52, 40960
  buffer_load_dwordx4 v109, s[16:19], s38 offen lds
  s_waitcnt vmcnt(10)
  s_barrier
  ds_read_b128 a[64:67], v5 offset:40960
  ds_read_b128 a[68:71], v5 offset:16384
  ds_read_b128 a[72:75], v5 offset:49152
  ds_read_b64_tr_b16 a[0:1], v111 offset:0
  ds_read_b64_tr_b16 a[2:3], v111 offset:1024
  ds_read_b64_tr_b16 a[4:5], v111 offset:8
  ds_read_b64_tr_b16 a[6:7], v111 offset:1032
  ds_read_b64_tr_b16 a[8:9], v111 offset:256
  ds_read_b64_tr_b16 a[10:11], v111 offset:1280
  ds_read_b64_tr_b16 a[12:13], v111 offset:264
  ds_read_b64_tr_b16 a[14:15], v111 offset:1288
  ds_read_b64_tr_b16 a[16:17], v111 offset:512
  ds_read_b64_tr_b16 a[18:19], v111 offset:1536
  ds_read_b64_tr_b16 a[20:21], v111 offset:520
  ds_read_b64_tr_b16 a[22:23], v111 offset:1544
  ds_read_b64_tr_b16 a[24:25], v111 offset:768
  ds_read_b64_tr_b16 a[26:27], v111 offset:1792
  ds_read_b64_tr_b16 a[28:29], v111 offset:776
  ds_read_b64_tr_b16 a[30:31], v111 offset:1800
  s_waitcnt vmcnt(8)
  s_barrier
  s_waitcnt lgkmcnt(14)
  v_mfma_f32_16x16x32_bf16 v[12:15], a[0:3], a[64:67], 0
  ds_read_b128 a[76:79], v5 offset:41472
  s_add_u32 s35, s35, 262144
  s_add_u32 m0, s32, 24576
  s_nop 0
  buffer_load_dwordx4 v108, s[20:23], s35 offen lds
  v_mfma_f32_16x16x32_bf16 v[16:19], a[0:3], a[68:71], 0
  ds_read_b128 a[80:83], v5 offset:16896
  v_mfma_f32_16x16x32_bf16 v[20:23], a[0:3], a[72:75], 0
  ds_read_b128 a[84:87], v5 offset:49664
  s_add_u32 m0, s32, 25600
  s_add_u32 s38, s35, 32768
  buffer_load_dwordx4 v108, s[20:23], s38 offen lds
  s_waitcnt lgkmcnt(15)
  v_mfma_f32_16x16x32_bf16 v[24:27], a[4:7], a[64:67], 0
  ds_read_b64_tr_b16 a[32:33], v111 offset:8192
  v_mfma_f32_16x16x32_bf16 v[28:31], a[4:7], a[68:71], 0
  ds_read_b64_tr_b16 a[34:35], v111 offset:9216
  v_mfma_f32_16x16x32_bf16 v[32:35], a[4:7], a[72:75], 0
  ds_read_b64_tr_b16 a[36:37], v111 offset:8200
  s_waitcnt lgkmcnt(15)
  v_mfma_f32_16x16x32_bf16 v[36:39], a[8:11], a[64:67], 0
  ds_read_b64_tr_b16 a[38:39], v111 offset:9224
  v_mfma_f32_16x16x32_bf16 v[40:43], a[8:11], a[68:71], 0
  ds_read_b64_tr_b16 a[40:41], v111 offset:8448
  v_mfma_f32_16x16x32_bf16 v[44:47], a[8:11], a[72:75], 0
  ds_read_b64_tr_b16 a[42:43], v111 offset:9472
  s_waitcnt lgkmcnt(15)
  v_mfma_f32_16x16x32_bf16 v[48:51], a[12:15], a[64:67], 0
  ds_read_b64_tr_b16 a[44:45], v111 offset:8456
  v_mfma_f32_16x16x32_bf16 v[52:55], a[12:15], a[68:71], 0
  ds_read_b64_tr_b16 a[46:47], v111 offset:9480
  v_mfma_f32_16x16x32_bf16 v[56:59], a[12:15], a[72:75], 0
  ds_read_b64_tr_b16 a[48:49], v111 offset:8704
  v_mfma_f32_16x16x32_bf16 v[60:63], a[16:19], a[64:67], 0
  ds_read_b64_tr_b16 a[50:51], v111 offset:9728
  v_mfma_f32_16x16x32_bf16 v[64:67], a[16:19], a[68:71], 0
  ds_read_b64_tr_b16 a[52:53], v111 offset:8712
  v_mfma_f32_16x16x32_bf16 v[68:71], a[16:19], a[72:75], 0
  ds_read_b64_tr_b16 a[54:55], v111 offset:9736
  s_waitcnt lgkmcnt(15)
  v_mfma_f32_16x16x32_bf16 v[72:75], a[20:23], a[64:67], 0
  ds_read_b64_tr_b16 a[56:57], v111 offset:8960
  v_mfma_f32_16x16x32_bf16 v[76:79], a[20:23], a[68:71], 0
  ds_read_b64_tr_b16 a[58:59], v111 offset:9984
  v_mfma_f32_16x16x32_bf16 v[80:83], a[20:23], a[72:75], 0
  ds_read_b64_tr_b16 a[60:61], v111 offset:8968
  v_mfma_f32_16x16x32_bf16 v[84:87], a[24:27], a[64:67], 0
  ds_read_b64_tr_b16 a[62:63], v111 offset:9992
  v_mfma_f32_16x16x32_bf16 v[88:91], a[24:27], a[68:71], 0
  v_mfma_f32_16x16x32_bf16 v[92:95], a[24:27], a[72:75], 0
  v_mfma_f32_16x16x32_bf16 v[96:99], a[28:31], a[64:67], 0
  v_mfma_f32_16x16x32_bf16 v[100:103], a[28:31], a[68:71], 0
  v_mfma_f32_16x16x32_bf16 v[104:107], a[28:31], a[72:75], 0
  s_waitcnt vmcnt(5) lgkmcnt(15)
  s_barrier
  s_waitcnt lgkmcnt(14)
  v_mfma_f32_16x16x32_bf16 v[12:15], a[32:35], a[76:79], v[12:15]
  ds_read_b128 a[64:67], v6 offset:40960
  s_add_u32 s35, s35, 262144
  s_cmp_eq_u32 s35, 5242880
  s_cselect_b32 s35, 0, s35
  s_add_u32 m0, s32, 65536
  s_nop 0
  buffer_load_dwordx4 v108, s[20:23], s35 offen lds
  v_mfma_f32_16x16x32_bf16 v[16:19], a[32:35], a[80:83], v[16:19]
  ds_read_b128 a[68:71], v6 offset:16384
  v_mfma_f32_16x16x32_bf16 v[20:23], a[32:35], a[84:87], v[20:23]
  ds_read_b128 a[72:75], v6 offset:49152
  s_add_u32 m0, s32, 66560
  s_add_u32 s38, s35, 32768
  buffer_load_dwordx4 v108, s[20:23], s38 offen lds
  s_waitcnt lgkmcnt(15)
  v_mfma_f32_16x16x32_bf16 v[24:27], a[36:39], a[76:79], v[24:27]
  ds_read_b64_tr_b16 a[0:1], v110 offset:57344
  v_mfma_f32_16x16x32_bf16 v[28:31], a[36:39], a[80:83], v[28:31]
  ds_read_b64_tr_b16 a[2:3], v110 offset:58368
  s_add_u32 s52, s52, 128
  s_cmp_eq_u32 s52, 1280
  s_cselect_b32 s52, 0, s52
  s_add_u32 m0, s33, 81920
  s_add_u32 s38, s52, 0
  buffer_load_dwordx4 v109, s[16:19], s38 offen lds
  v_mfma_f32_16x16x32_bf16 v[32:35], a[36:39], a[84:87], v[32:35]
  ds_read_b64_tr_b16 a[4:5], v110 offset:57352
  s_waitcnt lgkmcnt(15)
  v_mfma_f32_16x16x32_bf16 v[36:39], a[40:43], a[76:79], v[36:39]
  ds_read_b64_tr_b16 a[6:7], v110 offset:58376
  s_add_u32 m0, s33, 90112
  s_add_u32 s38, s52, 20480
  buffer_load_dwordx4 v109, s[16:19], s38 offen lds
  v_mfma_f32_16x16x32_bf16 v[40:43], a[40:43], a[80:83], v[40:43]
  ds_read_b64_tr_b16 a[8:9], v110 offset:57600
  v_mfma_f32_16x16x32_bf16 v[44:47], a[40:43], a[84:87], v[44:47]
  ds_read_b64_tr_b16 a[10:11], v110 offset:58624
  s_add_u32 m0, s33, 114688
  s_add_u32 s38, s52, 40960
  buffer_load_dwordx4 v109, s[16:19], s38 offen lds
  s_waitcnt lgkmcnt(15)
  v_mfma_f32_16x16x32_bf16 v[48:51], a[44:47], a[76:79], v[48:51]
  ds_read_b64_tr_b16 a[12:13], v110 offset:57608
  v_mfma_f32_16x16x32_bf16 v[52:55], a[44:47], a[80:83], v[52:55]
  ds_read_b64_tr_b16 a[14:15], v110 offset:58632
  v_mfma_f32_16x16x32_bf16 v[56:59], a[44:47], a[84:87], v[56:59]
  ds_read_b64_tr_b16 a[16:17], v110 offset:57856
  v_mfma_f32_16x16x32_bf16 v[60:63], a[48:51], a[76:79], v[60:63]
  ds_read_b64_tr_b16 a[18:19], v110 offset:58880
  s_mov_b32 s38, 1024
  buffer_load_dwordx4 a[96:99], v4, s[68:71], s38 offen
  v_mfma_f32_16x16x32_bf16 v[64:67], a[48:51], a[80:83], v[64:67]
  ds_read_b64_tr_b16 a[20:21], v110 offset:57864
  v_mfma_f32_16x16x32_bf16 v[68:71], a[48:51], a[84:87], v[68:71]
  ds_read_b64_tr_b16 a[22:23], v110 offset:58888
  s_waitcnt lgkmcnt(15)
  v_mfma_f32_16x16x32_bf16 v[72:75], a[52:55], a[76:79], v[72:75]
  ds_read_b64_tr_b16 a[24:25], v110 offset:58112
  v_mfma_f32_16x16x32_bf16 v[76:79], a[52:55], a[80:83], v[76:79]
  ds_read_b64_tr_b16 a[26:27], v110 offset:59136
  v_mfma_f32_16x16x32_bf16 v[80:83], a[52:55], a[84:87], v[80:83]
  ds_read_b64_tr_b16 a[28:29], v110 offset:58120
  v_mfma_f32_16x16x32_bf16 v[84:87], a[56:59], a[76:79], v[84:87]
  ds_read_b64_tr_b16 a[30:31], v110 offset:59144
  v_mfma_f32_16x16x32_bf16 v[88:91], a[56:59], a[80:83], v[88:91]
  v_mfma_f32_16x16x32_bf16 v[92:95], a[56:59], a[84:87], v[92:95]
  v_mfma_f32_16x16x32_bf16 v[96:99], a[60:63], a[76:79], v[96:99]
  v_mfma_f32_16x16x32_bf16 v[100:103], a[60:63], a[80:83], v[100:103]
  v_mfma_f32_16x16x32_bf16 v[104:107], a[60:63], a[84:87], v[104:107]
  s_waitcnt vmcnt(6)
  s_barrier
  s_waitcnt lgkmcnt(14)
  v_mfma_f32_16x16x32_bf16 v[12:15], a[0:3], a[64:67], v[12:15]
  ds_read_b128 a[76:79], v6 offset:41472
  s_add_u32 s35, s35, 262144
  s_add_u32 m0, s32, 73728
  s_nop 0
  buffer_load_dwordx4 v108, s[20:23], s35 offen lds
  v_mfma_f32_16x16x32_bf16 v[16:19], a[0:3], a[68:71], v[16:19]
  ds_read_b128 a[80:83], v6 offset:16896
  v_mfma_f32_16x16x32_bf16 v[20:23], a[0:3], a[72:75], v[20:23]
  ds_read_b128 a[84:87], v6 offset:49664
  s_add_u32 m0, s32, 74752
  s_add_u32 s38, s35, 32768
  buffer_load_dwordx4 v108, s[20:23], s38 offen lds
  s_waitcnt lgkmcnt(15)
  v_mfma_f32_16x16x32_bf16 v[24:27], a[4:7], a[64:67], v[24:27]
  ds_read_b64_tr_b16 a[32:33], v110 offset:24576
  v_mfma_f32_16x16x32_bf16 v[28:31], a[4:7], a[68:71], v[28:31]
  ds_read_b64_tr_b16 a[34:35], v110 offset:25600
  v_mfma_f32_16x16x32_bf16 v[32:35], a[4:7], a[72:75], v[32:35]
  ds_read_b64_tr_b16 a[36:37], v110 offset:24584
  s_waitcnt lgkmcnt(15)
  v_mfma_f32_16x16x32_bf16 v[36:39], a[8:11], a[64:67], v[36:39]
  ds_read_b64_tr_b16 a[38:39], v110 offset:25608
  v_mfma_f32_16x16x32_bf16 v[40:43], a[8:11], a[68:71], v[40:43]
  ds_read_b64_tr_b16 a[40:41], v110 offset:24832
  v_mfma_f32_16x16x32_bf16 v[44:47], a[8:11], a[72:75], v[44:47]
  ds_read_b64_tr_b16 a[42:43], v110 offset:25856
  s_waitcnt lgkmcnt(15)
  v_mfma_f32_16x16x32_bf16 v[48:51], a[12:15], a[64:67], v[48:51]
  ds_read_b64_tr_b16 a[44:45], v110 offset:24840
  v_mfma_f32_16x16x32_bf16 v[52:55], a[12:15], a[68:71], v[52:55]
  ds_read_b64_tr_b16 a[46:47], v110 offset:25864
  v_mfma_f32_16x16x32_bf16 v[56:59], a[12:15], a[72:75], v[56:59]
  ds_read_b64_tr_b16 a[48:49], v110 offset:25088
  v_mfma_f32_16x16x32_bf16 v[60:63], a[16:19], a[64:67], v[60:63]
  ds_read_b64_tr_b16 a[50:51], v110 offset:26112
  v_mfma_f32_16x16x32_bf16 v[64:67], a[16:19], a[68:71], v[64:67]
  ds_read_b64_tr_b16 a[52:53], v110 offset:25096
  v_mfma_f32_16x16x32_bf16 v[68:71], a[16:19], a[72:75], v[68:71]
  ds_read_b64_tr_b16 a[54:55], v110 offset:26120
  s_waitcnt lgkmcnt(15)
  v_mfma_f32_16x16x32_bf16 v[72:75], a[20:23], a[64:67], v[72:75]
  ds_read_b64_tr_b16 a[56:57], v110 offset:25344
  v_mfma_f32_16x16x32_bf16 v[76:79], a[20:23], a[68:71], v[76:79]
  ds_read_b64_tr_b16 a[58:59], v110 offset:26368
  v_mfma_f32_16x16x32_bf16 v[80:83], a[20:23], a[72:75], v[80:83]
  ds_read_b64_tr_b16 a[60:61], v110 offset:25352
  v_mfma_f32_16x16x32_bf16 v[84:87], a[24:27], a[64:67], v[84:87]
  ds_read_b64_tr_b16 a[62:63], v110 offset:26376
  v_mfma_f32_16x16x32_bf16 v[88:91], a[24:27], a[68:71], v[88:91]
  v_mfma_f32_16x16x32_bf16 v[92:95], a[24:27], a[72:75], v[92:95]
  v_mfma_f32_16x16x32_bf16 v[96:99], a[28:31], a[64:67], v[96:99]
  v_mfma_f32_16x16x32_bf16 v[100:103], a[28:31], a[68:71], v[100:103]
  v_mfma_f32_16x16x32_bf16 v[104:107], a[28:31], a[72:75], v[104:107]
  s_waitcnt vmcnt(6) lgkmcnt(15)
  s_barrier
  s_waitcnt lgkmcnt(14)
  v_mfma_f32_16x16x32_bf16 v[12:15], a[32:35], a[76:79], v[12:15]
  ds_read_b128 a[64:67], v5 offset:0
  s_add_u32 s35, s35, 262144
  s_cmp_eq_u32 s35, 5242880
  s_cselect_b32 s35, 0, s35
  s_add_u32 m0, s32, 57344
  s_nop 0
  buffer_load_dwordx4 v108, s[20:23], s35 offen lds
  v_mfma_f32_16x16x32_bf16 v[16:19], a[32:35], a[80:83], v[16:19]
  ds_read_b128 a[68:71], v5 offset:8192
  v_mfma_f32_16x16x32_bf16 v[20:23], a[32:35], a[84:87], v[20:23]
  ds_read_b128 a[72:75], v5 offset:32768
  s_add_u32 m0, s32, 58368
  s_add_u32 s38, s35, 32768
  buffer_load_dwordx4 v108, s[20:23], s38 offen lds
  s_waitcnt lgkmcnt(15)
  v_mfma_f32_16x16x32_bf16 v[24:27], a[36:39], a[76:79], v[24:27]
  ds_read_b64_tr_b16 a[0:1], v111 offset:0
  v_mfma_f32_16x16x32_bf16 v[28:31], a[36:39], a[80:83], v[28:31]
  ds_read_b64_tr_b16 a[2:3], v111 offset:1024
  s_add_u32 s52, s52, 128
  s_cmp_eq_u32 s52, 1280
  s_cselect_b32 s52, 0, s52
  s_add_u32 m0, s33, 40960
  s_add_u32 s38, s52, 0
  buffer_load_dwordx4 v109, s[16:19], s38 offen lds
  v_mfma_f32_16x16x32_bf16 v[32:35], a[36:39], a[84:87], v[32:35]
  ds_read_b64_tr_b16 a[4:5], v111 offset:8
  s_waitcnt lgkmcnt(15)
  v_mfma_f32_16x16x32_bf16 v[36:39], a[40:43], a[76:79], v[36:39]
  ds_read_b64_tr_b16 a[6:7], v111 offset:1032
  s_add_u32 m0, s33, 16384
  s_add_u32 s38, s52, 20480
  buffer_load_dwordx4 v109, s[16:19], s38 offen lds
  v_mfma_f32_16x16x32_bf16 v[40:43], a[40:43], a[80:83], v[40:43]
  ds_read_b64_tr_b16 a[8:9], v111 offset:256
  v_mfma_f32_16x16x32_bf16 v[44:47], a[40:43], a[84:87], v[44:47]
  ds_read_b64_tr_b16 a[10:11], v111 offset:1280
  s_add_u32 m0, s33, 49152
  s_add_u32 s38, s52, 40960
  buffer_load_dwordx4 v109, s[16:19], s38 offen lds
  s_waitcnt lgkmcnt(15)
  v_mfma_f32_16x16x32_bf16 v[48:51], a[44:47], a[76:79], v[48:51]
  ds_read_b64_tr_b16 a[12:13], v111 offset:264
  v_mfma_f32_16x16x32_bf16 v[52:55], a[44:47], a[80:83], v[52:55]
  ds_read_b64_tr_b16 a[14:15], v111 offset:1288
  v_mfma_f32_16x16x32_bf16 v[56:59], a[44:47], a[84:87], v[56:59]
  ds_read_b64_tr_b16 a[16:17], v111 offset:512
  v_mfma_f32_16x16x32_bf16 v[60:63], a[48:51], a[76:79], v[60:63]
  ds_read_b64_tr_b16 a[18:19], v111 offset:1536
  v_mfma_f32_16x16x32_bf16 v[64:67], a[48:51], a[80:83], v[64:67]
  ds_read_b64_tr_b16 a[20:21], v111 offset:520
  v_mfma_f32_16x16x32_bf16 v[68:71], a[48:51], a[84:87], v[68:71]
  ds_read_b64_tr_b16 a[22:23], v111 offset:1544
  s_waitcnt lgkmcnt(15)
  v_mfma_f32_16x16x32_bf16 v[72:75], a[52:55], a[76:79], v[72:75]
  ds_read_b64_tr_b16 a[24:25], v111 offset:768
  v_mfma_f32_16x16x32_bf16 v[76:79], a[52:55], a[80:83], v[76:79]
  ds_read_b64_tr_b16 a[26:27], v111 offset:1792
  v_mfma_f32_16x16x32_bf16 v[80:83], a[52:55], a[84:87], v[80:83]
  ds_read_b64_tr_b16 a[28:29], v111 offset:776
  v_mfma_f32_16x16x32_bf16 v[84:87], a[56:59], a[76:79], v[84:87]
  ds_read_b64_tr_b16 a[30:31], v111 offset:1800
  v_mfma_f32_16x16x32_bf16 v[88:91], a[56:59], a[80:83], v[88:91]
  v_mfma_f32_16x16x32_bf16 v[92:95], a[56:59], a[84:87], v[92:95]
  v_mfma_f32_16x16x32_bf16 v[96:99], a[60:63], a[76:79], v[96:99]
  v_mfma_f32_16x16x32_bf16 v[100:103], a[60:63], a[80:83], v[100:103]
  v_mfma_f32_16x16x32_bf16 v[104:107], a[60:63], a[84:87], v[104:107]
  s_waitcnt vmcnt(5)
  s_barrier
  s_waitcnt lgkmcnt(14)
  v_mfma_f32_16x16x32_bf16 v[12:15], a[0:3], a[64:67], v[12:15]
  ds_read_b128 a[76:79], v5 offset:512
  s_add_u32 s35, s35, 262144
  s_add_u32 m0, s32, 24576
  s_nop 0
  buffer_load_dwordx4 v108, s[20:23], s35 offen lds
  v_mfma_f32_16x16x32_bf16 v[16:19], a[0:3], a[68:71], v[16:19]
  ds_read_b128 a[80:83], v5 offset:8704
  v_mfma_f32_16x16x32_bf16 v[20:23], a[0:3], a[72:75], v[20:23]
  ds_read_b128 a[84:87], v5 offset:33280
  s_add_u32 m0, s32, 25600
  s_add_u32 s38, s35, 32768
  buffer_load_dwordx4 v108, s[20:23], s38 offen lds
  s_waitcnt lgkmcnt(15)
  v_mfma_f32_16x16x32_bf16 v[24:27], a[4:7], a[64:67], v[24:27]
  ds_read_b64_tr_b16 a[32:33], v111 offset:8192
  v_mfma_f32_16x16x32_bf16 v[28:31], a[4:7], a[68:71], v[28:31]
  ds_read_b64_tr_b16 a[34:35], v111 offset:9216
  v_mfma_f32_16x16x32_bf16 v[32:35], a[4:7], a[72:75], v[32:35]
  ds_read_b64_tr_b16 a[36:37], v111 offset:8200
  s_waitcnt lgkmcnt(15)
  v_mfma_f32_16x16x32_bf16 v[36:39], a[8:11], a[64:67], v[36:39]
  ds_read_b64_tr_b16 a[38:39], v111 offset:9224
  v_mfma_f32_16x16x32_bf16 v[40:43], a[8:11], a[68:71], v[40:43]
  ds_read_b64_tr_b16 a[40:41], v111 offset:8448
  v_mfma_f32_16x16x32_bf16 v[44:47], a[8:11], a[72:75], v[44:47]
  ds_read_b64_tr_b16 a[42:43], v111 offset:9472
  s_waitcnt lgkmcnt(15)
  v_mfma_f32_16x16x32_bf16 v[48:51], a[12:15], a[64:67], v[48:51]
  ds_read_b64_tr_b16 a[44:45], v111 offset:8456
  v_mfma_f32_16x16x32_bf16 v[52:55], a[12:15], a[68:71], v[52:55]
  ds_read_b64_tr_b16 a[46:47], v111 offset:9480
  v_mfma_f32_16x16x32_bf16 v[56:59], a[12:15], a[72:75], v[56:59]
  ds_read_b64_tr_b16 a[48:49], v111 offset:8704
  v_mfma_f32_16x16x32_bf16 v[60:63], a[16:19], a[64:67], v[60:63]
  ds_read_b64_tr_b16 a[50:51], v111 offset:9728
  v_mfma_f32_16x16x32_bf16 v[64:67], a[16:19], a[68:71], v[64:67]
  ds_read_b64_tr_b16 a[52:53], v111 offset:8712
  v_mfma_f32_16x16x32_bf16 v[68:71], a[16:19], a[72:75], v[68:71]
  ds_read_b64_tr_b16 a[54:55], v111 offset:9736
  s_waitcnt lgkmcnt(15)
  v_mfma_f32_16x16x32_bf16 v[72:75], a[20:23], a[64:67], v[72:75]
  ds_read_b64_tr_b16 a[56:57], v111 offset:8960
  v_mfma_f32_16x16x32_bf16 v[76:79], a[20:23], a[68:71], v[76:79]
  ds_read_b64_tr_b16 a[58:59], v111 offset:9984
  v_mfma_f32_16x16x32_bf16 v[80:83], a[20:23], a[72:75], v[80:83]
  ds_read_b64_tr_b16 a[60:61], v111 offset:8968
  v_mfma_f32_16x16x32_bf16 v[84:87], a[24:27], a[64:67], v[84:87]
  ds_read_b64_tr_b16 a[62:63], v111 offset:9992
  v_mfma_f32_16x16x32_bf16 v[88:91], a[24:27], a[68:71], v[88:91]
  v_mfma_f32_16x16x32_bf16 v[92:95], a[24:27], a[72:75], v[92:95]
  v_mfma_f32_16x16x32_bf16 v[96:99], a[28:31], a[64:67], v[96:99]
  v_mfma_f32_16x16x32_bf16 v[100:103], a[28:31], a[68:71], v[100:103]
  v_mfma_f32_16x16x32_bf16 v[104:107], a[28:31], a[72:75], v[104:107]
  s_waitcnt vmcnt(5) lgkmcnt(15)
  s_barrier
  s_waitcnt lgkmcnt(14)
  v_mfma_f32_16x16x32_bf16 v[12:15], a[32:35], a[76:79], v[12:15]
  ds_read_b128 a[64:67], v6 offset:0
  s_add_u32 s35, s35, 262144
  s_cmp_eq_u32 s35, 5242880
  s_cselect_b32 s35, 0, s35
  s_add_u32 m0, s32, 65536
  s_nop 0
  buffer_load_dwordx4 v108, s[20:23], s35 offen lds
  v_mfma_f32_16x16x32_bf16 v[16:19], a[32:35], a[80:83], v[16:19]
  ds_read_b128 a[68:71], v6 offset:8192
  v_mfma_f32_16x16x32_bf16 v[20:23], a[32:35], a[84:87], v[20:23]
  ds_read_b128 a[72:75], v6 offset:32768
  s_add_u32 m0, s32, 66560
  s_add_u32 s38, s35, 32768
  buffer_load_dwordx4 v108, s[20:23], s38 offen lds
  s_waitcnt lgkmcnt(15)
  v_mfma_f32_16x16x32_bf16 v[24:27], a[36:39], a[76:79], v[24:27]
  ds_read_b64_tr_b16 a[0:1], v110 offset:57344
  v_mfma_f32_16x16x32_bf16 v[28:31], a[36:39], a[80:83], v[28:31]
  ds_read_b64_tr_b16 a[2:3], v110 offset:58368
  s_add_u32 s52, s52, 128
  s_cmp_eq_u32 s52, 1280
  s_cselect_b32 s52, 0, s52
  s_add_u32 m0, s33, 122880
  s_add_u32 s38, s52, 0
  buffer_load_dwordx4 v109, s[16:19], s38 offen lds
  v_mfma_f32_16x16x32_bf16 v[32:35], a[36:39], a[84:87], v[32:35]
  ds_read_b64_tr_b16 a[4:5], v110 offset:57352
  s_waitcnt lgkmcnt(15)
  v_mfma_f32_16x16x32_bf16 v[36:39], a[40:43], a[76:79], v[36:39]
  ds_read_b64_tr_b16 a[6:7], v110 offset:58376
  s_add_u32 m0, s33, 98304
  s_add_u32 s38, s52, 20480
  buffer_load_dwordx4 v109, s[16:19], s38 offen lds
  v_mfma_f32_16x16x32_bf16 v[40:43], a[40:43], a[80:83], v[40:43]
  ds_read_b64_tr_b16 a[8:9], v110 offset:57600
  v_mfma_f32_16x16x32_bf16 v[44:47], a[40:43], a[84:87], v[44:47]
  ds_read_b64_tr_b16 a[10:11], v110 offset:58624
  s_add_u32 m0, s33, 131072
  s_add_u32 s38, s52, 40960
  buffer_load_dwordx4 v109, s[16:19], s38 offen lds
  s_waitcnt lgkmcnt(15)
  v_mfma_f32_16x16x32_bf16 v[48:51], a[44:47], a[76:79], v[48:51]
  ds_read_b64_tr_b16 a[12:13], v110 offset:57608
  v_mfma_f32_16x16x32_bf16 v[52:55], a[44:47], a[80:83], v[52:55]
  ds_read_b64_tr_b16 a[14:15], v110 offset:58632
  v_mfma_f32_16x16x32_bf16 v[56:59], a[44:47], a[84:87], v[56:59]
  ds_read_b64_tr_b16 a[16:17], v110 offset:57856
  v_mfma_f32_16x16x32_bf16 v[60:63], a[48:51], a[76:79], v[60:63]
  ds_read_b64_tr_b16 a[18:19], v110 offset:58880
  s_mov_b32 s38, 2048
  buffer_load_dwordx4 a[96:99], v4, s[68:71], s38 offen
  v_mfma_f32_16x16x32_bf16 v[64:67], a[48:51], a[80:83], v[64:67]
  ds_read_b64_tr_b16 a[20:21], v110 offset:57864
  v_mfma_f32_16x16x32_bf16 v[68:71], a[48:51], a[84:87], v[68:71]
  ds_read_b64_tr_b16 a[22:23], v110 offset:58888
  s_waitcnt lgkmcnt(15)
  v_mfma_f32_16x16x32_bf16 v[72:75], a[52:55], a[76:79], v[72:75]
  ds_read_b64_tr_b16 a[24:25], v110 offset:58112
  v_mfma_f32_16x16x32_bf16 v[76:79], a[52:55], a[80:83], v[76:79]
  ds_read_b64_tr_b16 a[26:27], v110 offset:59136
  v_mfma_f32_16x16x32_bf16 v[80:83], a[52:55], a[84:87], v[80:83]
  ds_read_b64_tr_b16 a[28:29], v110 offset:58120
  v_mfma_f32_16x16x32_bf16 v[84:87], a[56:59], a[76:79], v[84:87]
  ds_read_b64_tr_b16 a[30:31], v110 offset:59144
  v_mfma_f32_16x16x32_bf16 v[88:91], a[56:59], a[80:83], v[88:91]
  v_mfma_f32_16x16x32_bf16 v[92:95], a[56:59], a[84:87], v[92:95]
  v_mfma_f32_16x16x32_bf16 v[96:99], a[60:63], a[76:79], v[96:99]
  v_mfma_f32_16x16x32_bf16 v[100:103], a[60:63], a[80:83], v[100:103]
  v_mfma_f32_16x16x32_bf16 v[104:107], a[60:63], a[84:87], v[104:107]
  s_waitcnt vmcnt(6)
  s_barrier
  s_waitcnt lgkmcnt(14)
  v_mfma_f32_16x16x32_bf16 v[12:15], a[0:3], a[64:67], v[12:15]
  ds_read_b128 a[76:79], v6 offset:512
  s_add_u32 s35, s35, 262144
  s_add_u32 m0, s32, 73728
  s_nop 0
  buffer_load_dwordx4 v108, s[20:23], s35 offen lds
  v_mfma_f32_16x16x32_bf16 v[16:19], a[0:3], a[68:71], v[16:19]
  ds_read_b128 a[80:83], v6 offset:8704
  v_mfma_f32_16x16x32_bf16 v[20:23], a[0:3], a[72:75], v[20:23]
  ds_read_b128 a[84:87], v6 offset:33280
  s_add_u32 m0, s32, 74752
  s_add_u32 s38, s35, 32768
  buffer_load_dwordx4 v108, s[20:23], s38 offen lds
  s_waitcnt lgkmcnt(15)
  v_mfma_f32_16x16x32_bf16 v[24:27], a[4:7], a[64:67], v[24:27]
  ds_read_b64_tr_b16 a[32:33], v110 offset:24576
  v_mfma_f32_16x16x32_bf16 v[28:31], a[4:7], a[68:71], v[28:31]
  ds_read_b64_tr_b16 a[34:35], v110 offset:25600
  v_mfma_f32_16x16x32_bf16 v[32:35], a[4:7], a[72:75], v[32:35]
  ds_read_b64_tr_b16 a[36:37], v110 offset:24584
  s_waitcnt lgkmcnt(15)
  v_mfma_f32_16x16x32_bf16 v[36:39], a[8:11], a[64:67], v[36:39]
  ds_read_b64_tr_b16 a[38:39], v110 offset:25608
  v_mfma_f32_16x16x32_bf16 v[40:43], a[8:11], a[68:71], v[40:43]
  ds_read_b64_tr_b16 a[40:41], v110 offset:24832
  v_mfma_f32_16x16x32_bf16 v[44:47], a[8:11], a[72:75], v[44:47]
  ds_read_b64_tr_b16 a[42:43], v110 offset:25856
  s_waitcnt lgkmcnt(15)
  v_mfma_f32_16x16x32_bf16 v[48:51], a[12:15], a[64:67], v[48:51]
  ds_read_b64_tr_b16 a[44:45], v110 offset:24840
  v_mfma_f32_16x16x32_bf16 v[52:55], a[12:15], a[68:71], v[52:55]
  ds_read_b64_tr_b16 a[46:47], v110 offset:25864
  v_mfma_f32_16x16x32_bf16 v[56:59], a[12:15], a[72:75], v[56:59]
  ds_read_b64_tr_b16 a[48:49], v110 offset:25088
  v_mfma_f32_16x16x32_bf16 v[60:63], a[16:19], a[64:67], v[60:63]
  ds_read_b64_tr_b16 a[50:51], v110 offset:26112
  v_mfma_f32_16x16x32_bf16 v[64:67], a[16:19], a[68:71], v[64:67]
  ds_read_b64_tr_b16 a[52:53], v110 offset:25096
  v_mfma_f32_16x16x32_bf16 v[68:71], a[16:19], a[72:75], v[68:71]
  ds_read_b64_tr_b16 a[54:55], v110 offset:26120
  s_waitcnt lgkmcnt(15)
  v_mfma_f32_16x16x32_bf16 v[72:75], a[20:23], a[64:67], v[72:75]
  ds_read_b64_tr_b16 a[56:57], v110 offset:25344
  v_mfma_f32_16x16x32_bf16 v[76:79], a[20:23], a[68:71], v[76:79]
  ds_read_b64_tr_b16 a[58:59], v110 offset:26368
  v_mfma_f32_16x16x32_bf16 v[80:83], a[20:23], a[72:75], v[80:83]
  ds_read_b64_tr_b16 a[60:61], v110 offset:25352
  v_mfma_f32_16x16x32_bf16 v[84:87], a[24:27], a[64:67], v[84:87]
  ds_read_b64_tr_b16 a[62:63], v110 offset:26376
  v_mfma_f32_16x16x32_bf16 v[88:91], a[24:27], a[68:71], v[88:91]
  v_mfma_f32_16x16x32_bf16 v[92:95], a[24:27], a[72:75], v[92:95]
  v_mfma_f32_16x16x32_bf16 v[96:99], a[28:31], a[64:67], v[96:99]
  v_mfma_f32_16x16x32_bf16 v[100:103], a[28:31], a[68:71], v[100:103]
  v_mfma_f32_16x16x32_bf16 v[104:107], a[28:31], a[72:75], v[104:107]
  s_waitcnt vmcnt(6) lgkmcnt(15)
  s_barrier
  s_waitcnt lgkmcnt(14)
  v_mfma_f32_16x16x32_bf16 v[12:15], a[32:35], a[76:79], v[12:15]
  ds_read_b128 a[64:67], v5 offset:40960
  s_add_u32 s35, s35, 262144
  s_cmp_eq_u32 s35, 5242880
  s_cselect_b32 s35, 0, s35
  s_add_u32 m0, s32, 57344
  s_nop 0
  buffer_load_dwordx4 v108, s[20:23], s35 offen lds
  v_mfma_f32_16x16x32_bf16 v[16:19], a[32:35], a[80:83], v[16:19]
  ds_read_b128 a[68:71], v5 offset:16384
  v_mfma_f32_16x16x32_bf16 v[20:23], a[32:35], a[84:87], v[20:23]
  ds_read_b128 a[72:75], v5 offset:49152
  s_add_u32 m0, s32, 58368
  s_add_u32 s38, s35, 32768
  buffer_load_dwordx4 v108, s[20:23], s38 offen lds
  s_waitcnt lgkmcnt(15)
  v_mfma_f32_16x16x32_bf16 v[24:27], a[36:39], a[76:79], v[24:27]
  ds_read_b64_tr_b16 a[0:1], v111 offset:0
  v_mfma_f32_16x16x32_bf16 v[28:31], a[36:39], a[80:83], v[28:31]
  ds_read_b64_tr_b16 a[2:3], v111 offset:1024
  s_add_u32 s52, s52, 128
  s_cmp_eq_u32 s52, 1280
  s_cselect_b32 s52, 0, s52
  s_add_u32 m0, s33, 0
  s_add_u32 s38, s52, 0
  buffer_load_dwordx4 v109, s[16:19], s38 offen lds
  v_mfma_f32_16x16x32_bf16 v[32:35], a[36:39], a[84:87], v[32:35]
  ds_read_b64_tr_b16 a[4:5], v111 offset:8
  s_waitcnt lgkmcnt(15)
  v_mfma_f32_16x16x32_bf16 v[36:39], a[40:43], a[76:79], v[36:39]
  ds_read_b64_tr_b16 a[6:7], v111 offset:1032
  s_add_u32 m0, s33, 8192
  s_add_u32 s38, s52, 20480
  buffer_load_dwordx4 v109, s[16:19], s38 offen lds
  v_mfma_f32_16x16x32_bf16 v[40:43], a[40:43], a[80:83], v[40:43]
  ds_read_b64_tr_b16 a[8:9], v111 offset:256
  v_mfma_f32_16x16x32_bf16 v[44:47], a[40:43], a[84:87], v[44:47]
  ds_read_b64_tr_b16 a[10:11], v111 offset:1280
  s_add_u32 m0, s33, 32768
  s_add_u32 s38, s52, 40960
  buffer_load_dwordx4 v109, s[16:19], s38 offen lds
  s_waitcnt lgkmcnt(15)
  v_mfma_f32_16x16x32_bf16 v[48:51], a[44:47], a[76:79], v[48:51]
  ds_read_b64_tr_b16 a[12:13], v111 offset:264
  v_mfma_f32_16x16x32_bf16 v[52:55], a[44:47], a[80:83], v[52:55]
  ds_read_b64_tr_b16 a[14:15], v111 offset:1288
  v_mfma_f32_16x16x32_bf16 v[56:59], a[44:47], a[84:87], v[56:59]
  ds_read_b64_tr_b16 a[16:17], v111 offset:512
  v_mfma_f32_16x16x32_bf16 v[60:63], a[48:51], a[76:79], v[60:63]
  ds_read_b64_tr_b16 a[18:19], v111 offset:1536
  v_mfma_f32_16x16x32_bf16 v[64:67], a[48:51], a[80:83], v[64:67]
  ds_read_b64_tr_b16 a[20:21], v111 offset:520
  v_mfma_f32_16x16x32_bf16 v[68:71], a[48:51], a[84:87], v[68:71]
  ds_read_b64_tr_b16 a[22:23], v111 offset:1544
  s_waitcnt lgkmcnt(15)
  v_mfma_f32_16x16x32_bf16 v[72:75], a[52:55], a[76:79], v[72:75]
  ds_read_b64_tr_b16 a[24:25], v111 offset:768
  v_mfma_f32_16x16x32_bf16 v[76:79], a[52:55], a[80:83], v[76:79]
  ds_read_b64_tr_b16 a[26:27], v111 offset:1792
  v_mfma_f32_16x16x32_bf16 v[80:83], a[52:55], a[84:87], v[80:83]
  ds_read_b64_tr_b16 a[28:29], v111 offset:776
  v_mfma_f32_16x16x32_bf16 v[84:87], a[56:59], a[76:79], v[84:87]
  ds_read_b64_tr_b16 a[30:31], v111 offset:1800
  v_mfma_f32_16x16x32_bf16 v[88:91], a[56:59], a[80:83], v[88:91]
  v_mfma_f32_16x16x32_bf16 v[92:95], a[56:59], a[84:87], v[92:95]
  v_mfma_f32_16x16x32_bf16 v[96:99], a[60:63], a[76:79], v[96:99]
  v_mfma_f32_16x16x32_bf16 v[100:103], a[60:63], a[80:83], v[100:103]
  v_mfma_f32_16x16x32_bf16 v[104:107], a[60:63], a[84:87], v[104:107]
  s_waitcnt vmcnt(5)
  s_barrier
  s_waitcnt lgkmcnt(14)
  v_mfma_f32_16x16x32_bf16 v[12:15], a[0:3], a[64:67], v[12:15]
  ds_read_b128 a[76:79], v5 offset:41472
  s_add_u32 s35, s35, 262144
  s_add_u32 m0, s32, 24576
  s_nop 0
  buffer_load_dwordx4 v108, s[20:23], s35 offen lds
  v_mfma_f32_16x16x32_bf16 v[16:19], a[0:3], a[68:71], v[16:19]
  ds_read_b128 a[80:83], v5 offset:16896
  v_mfma_f32_16x16x32_bf16 v[20:23], a[0:3], a[72:75], v[20:23]
  ds_read_b128 a[84:87], v5 offset:49664
  s_add_u32 m0, s32, 25600
  s_add_u32 s38, s35, 32768
  buffer_load_dwordx4 v108, s[20:23], s38 offen lds
  s_waitcnt lgkmcnt(15)
  v_mfma_f32_16x16x32_bf16 v[24:27], a[4:7], a[64:67], v[24:27]
  ds_read_b64_tr_b16 a[32:33], v111 offset:8192
  v_mfma_f32_16x16x32_bf16 v[28:31], a[4:7], a[68:71], v[28:31]
  ds_read_b64_tr_b16 a[34:35], v111 offset:9216
  v_mfma_f32_16x16x32_bf16 v[32:35], a[4:7], a[72:75], v[32:35]
  ds_read_b64_tr_b16 a[36:37], v111 offset:8200
  s_waitcnt lgkmcnt(15)
  v_mfma_f32_16x16x32_bf16 v[36:39], a[8:11], a[64:67], v[36:39]
  ds_read_b64_tr_b16 a[38:39], v111 offset:9224
  v_mfma_f32_16x16x32_bf16 v[40:43], a[8:11], a[68:71], v[40:43]
  ds_read_b64_tr_b16 a[40:41], v111 offset:8448
  v_mfma_f32_16x16x32_bf16 v[44:47], a[8:11], a[72:75], v[44:47]
  ds_read_b64_tr_b16 a[42:43], v111 offset:9472
  s_waitcnt lgkmcnt(15)
  v_mfma_f32_16x16x32_bf16 v[48:51], a[12:15], a[64:67], v[48:51]
  ds_read_b64_tr_b16 a[44:45], v111 offset:8456
  v_mfma_f32_16x16x32_bf16 v[52:55], a[12:15], a[68:71], v[52:55]
  ds_read_b64_tr_b16 a[46:47], v111 offset:9480
  v_mfma_f32_16x16x32_bf16 v[56:59], a[12:15], a[72:75], v[56:59]
  ds_read_b64_tr_b16 a[48:49], v111 offset:8704
  v_mfma_f32_16x16x32_bf16 v[60:63], a[16:19], a[64:67], v[60:63]
  ds_read_b64_tr_b16 a[50:51], v111 offset:9728
  v_mfma_f32_16x16x32_bf16 v[64:67], a[16:19], a[68:71], v[64:67]
  ds_read_b64_tr_b16 a[52:53], v111 offset:8712
  v_mfma_f32_16x16x32_bf16 v[68:71], a[16:19], a[72:75], v[68:71]
  ds_read_b64_tr_b16 a[54:55], v111 offset:9736
  s_waitcnt lgkmcnt(15)
  v_mfma_f32_16x16x32_bf16 v[72:75], a[20:23], a[64:67], v[72:75]
  ds_read_b64_tr_b16 a[56:57], v111 offset:8960
  v_mfma_f32_16x16x32_bf16 v[76:79], a[20:23], a[68:71], v[76:79]
  ds_read_b64_tr_b16 a[58:59], v111 offset:9984
  v_mfma_f32_16x16x32_bf16 v[80:83], a[20:23], a[72:75], v[80:83]
  ds_read_b64_tr_b16 a[60:61], v111 offset:8968
  v_mfma_f32_16x16x32_bf16 v[84:87], a[24:27], a[64:67], v[84:87]
  ds_read_b64_tr_b16 a[62:63], v111 offset:9992
  v_mfma_f32_16x16x32_bf16 v[88:91], a[24:27], a[68:71], v[88:91]
  v_mfma_f32_16x16x32_bf16 v[92:95], a[24:27], a[72:75], v[92:95]
  v_mfma_f32_16x16x32_bf16 v[96:99], a[28:31], a[64:67], v[96:99]
  v_mfma_f32_16x16x32_bf16 v[100:103], a[28:31], a[68:71], v[100:103]
  v_mfma_f32_16x16x32_bf16 v[104:107], a[28:31], a[72:75], v[104:107]
  s_waitcnt vmcnt(5) lgkmcnt(15)
  s_barrier
  s_waitcnt lgkmcnt(14)
  v_mfma_f32_16x16x32_bf16 v[12:15], a[32:35], a[76:79], v[12:15]
  ds_read_b128 a[64:67], v6 offset:40960
  s_add_u32 s35, s35, 262144
  s_cmp_eq_u32 s35, 5242880
  s_cselect_b32 s35, 0, s35
  s_add_u32 m0, s32, 65536
  s_nop 0
  buffer_load_dwordx4 v108, s[20:23], s35 offen lds
  v_mfma_f32_16x16x32_bf16 v[16:19], a[32:35], a[80:83], v[16:19]
  ds_read_b128 a[68:71], v6 offset:16384
  v_mfma_f32_16x16x32_bf16 v[20:23], a[32:35], a[84:87], v[20:23]
  ds_read_b128 a[72:75], v6 offset:49152
  s_add_u32 m0, s32, 66560
  s_add_u32 s38, s35, 32768
  buffer_load_dwordx4 v108, s[20:23], s38 offen lds
  s_waitcnt lgkmcnt(15)
  v_mfma_f32_16x16x32_bf16 v[24:27], a[36:39], a[76:79], v[24:27]
  ds_read_b64_tr_b16 a[0:1], v110 offset:57344
  v_mfma_f32_16x16x32_bf16 v[28:31], a[36:39], a[80:83], v[28:31]
  ds_read_b64_tr_b16 a[2:3], v110 offset:58368
  s_add_u32 s52, s52, 128
  s_cmp_eq_u32 s52, 1280
  s_cselect_b32 s52, 0, s52
  s_add_u32 m0, s33, 81920
  s_add_u32 s38, s52, 0
  buffer_load_dwordx4 v109, s[16:19], s38 offen lds
  v_mfma_f32_16x16x32_bf16 v[32:35], a[36:39], a[84:87], v[32:35]
  ds_read_b64_tr_b16 a[4:5], v110 offset:57352
  s_waitcnt lgkmcnt(15)
  v_mfma_f32_16x16x32_bf16 v[36:39], a[40:43], a[76:79], v[36:39]
  ds_read_b64_tr_b16 a[6:7], v110 offset:58376
  s_add_u32 m0, s33, 90112
  s_add_u32 s38, s52, 20480
  buffer_load_dwordx4 v109, s[16:19], s38 offen lds
  v_mfma_f32_16x16x32_bf16 v[40:43], a[40:43], a[80:83], v[40:43]
  ds_read_b64_tr_b16 a[8:9], v110 offset:57600
  v_mfma_f32_16x16x32_bf16 v[44:47], a[40:43], a[84:87], v[44:47]
  ds_read_b64_tr_b16 a[10:11], v110 offset:58624
  s_add_u32 m0, s33, 114688
  s_add_u32 s38, s52, 40960
  buffer_load_dwordx4 v109, s[16:19], s38 offen lds
  s_waitcnt lgkmcnt(15)
  v_mfma_f32_16x16x32_bf16 v[48:51], a[44:47], a[76:79], v[48:51]
  ds_read_b64_tr_b16 a[12:13], v110 offset:57608
  v_mfma_f32_16x16x32_bf16 v[52:55], a[44:47], a[80:83], v[52:55]
  ds_read_b64_tr_b16 a[14:15], v110 offset:58632
  v_mfma_f32_16x16x32_bf16 v[56:59], a[44:47], a[84:87], v[56:59]
  ds_read_b64_tr_b16 a[16:17], v110 offset:57856
  v_mfma_f32_16x16x32_bf16 v[60:63], a[48:51], a[76:79], v[60:63]
  ds_read_b64_tr_b16 a[18:19], v110 offset:58880
  s_mov_b32 s38, 3072
  buffer_load_dwordx4 a[96:99], v4, s[68:71], s38 offen
  v_mfma_f32_16x16x32_bf16 v[64:67], a[48:51], a[80:83], v[64:67]
  ds_read_b64_tr_b16 a[20:21], v110 offset:57864
  v_mfma_f32_16x16x32_bf16 v[68:71], a[48:51], a[84:87], v[68:71]
  ds_read_b64_tr_b16 a[22:23], v110 offset:58888
  s_waitcnt lgkmcnt(15)
  v_mfma_f32_16x16x32_bf16 v[72:75], a[52:55], a[76:79], v[72:75]
  ds_read_b64_tr_b16 a[24:25], v110 offset:58112
  v_mfma_f32_16x16x32_bf16 v[76:79], a[52:55], a[80:83], v[76:79]
  ds_read_b64_tr_b16 a[26:27], v110 offset:59136
  v_mfma_f32_16x16x32_bf16 v[80:83], a[52:55], a[84:87], v[80:83]
  ds_read_b64_tr_b16 a[28:29], v110 offset:58120
  v_mfma_f32_16x16x32_bf16 v[84:87], a[56:59], a[76:79], v[84:87]
  ds_read_b64_tr_b16 a[30:31], v110 offset:59144
  v_mfma_f32_16x16x32_bf16 v[88:91], a[56:59], a[80:83], v[88:91]
  v_mfma_f32_16x16x32_bf16 v[92:95], a[56:59], a[84:87], v[92:95]
  v_mfma_f32_16x16x32_bf16 v[96:99], a[60:63], a[76:79], v[96:99]
  v_mfma_f32_16x16x32_bf16 v[100:103], a[60:63], a[80:83], v[100:103]
  v_mfma_f32_16x16x32_bf16 v[104:107], a[60:63], a[84:87], v[104:107]
  s_waitcnt vmcnt(6)
  s_barrier
  s_waitcnt lgkmcnt(14)
  v_mfma_f32_16x16x32_bf16 v[12:15], a[0:3], a[64:67], v[12:15]
  ds_read_b128 a[76:79], v6 offset:41472
  s_add_u32 s35, s35, 262144
  s_add_u32 m0, s32, 73728
  s_nop 0
  buffer_load_dwordx4 v108, s[20:23], s35 offen lds
  v_mfma_f32_16x16x32_bf16 v[16:19], a[0:3], a[68:71], v[16:19]
  ds_read_b128 a[80:83], v6 offset:16896
  v_mfma_f32_16x16x32_bf16 v[20:23], a[0:3], a[72:75], v[20:23]
  ds_read_b128 a[84:87], v6 offset:49664
  s_add_u32 m0, s32, 74752
  s_add_u32 s38, s35, 32768
  buffer_load_dwordx4 v108, s[20:23], s38 offen lds
  s_waitcnt lgkmcnt(15)
  v_mfma_f32_16x16x32_bf16 v[24:27], a[4:7], a[64:67], v[24:27]
  ds_read_b64_tr_b16 a[32:33], v110 offset:24576
  v_mfma_f32_16x16x32_bf16 v[28:31], a[4:7], a[68:71], v[28:31]
  ds_read_b64_tr_b16 a[34:35], v110 offset:25600
  v_mfma_f32_16x16x32_bf16 v[32:35], a[4:7], a[72:75], v[32:35]
  ds_read_b64_tr_b16 a[36:37], v110 offset:24584
  s_waitcnt lgkmcnt(15)
  v_mfma_f32_16x16x32_bf16 v[36:39], a[8:11], a[64:67], v[36:39]
  ds_read_b64_tr_b16 a[38:39], v110 offset:25608
  v_mfma_f32_16x16x32_bf16 v[40:43], a[8:11], a[68:71], v[40:43]
  ds_read_b64_tr_b16 a[40:41], v110 offset:24832
  v_mfma_f32_16x16x32_bf16 v[44:47], a[8:11], a[72:75], v[44:47]
  ds_read_b64_tr_b16 a[42:43], v110 offset:25856
  s_waitcnt lgkmcnt(15)
  v_mfma_f32_16x16x32_bf16 v[48:51], a[12:15], a[64:67], v[48:51]
  ds_read_b64_tr_b16 a[44:45], v110 offset:24840
  v_mfma_f32_16x16x32_bf16 v[52:55], a[12:15], a[68:71], v[52:55]
  ds_read_b64_tr_b16 a[46:47], v110 offset:25864
  v_mfma_f32_16x16x32_bf16 v[56:59], a[12:15], a[72:75], v[56:59]
  ds_read_b64_tr_b16 a[48:49], v110 offset:25088
  v_mfma_f32_16x16x32_bf16 v[60:63], a[16:19], a[64:67], v[60:63]
  ds_read_b64_tr_b16 a[50:51], v110 offset:26112
  v_mfma_f32_16x16x32_bf16 v[64:67], a[16:19], a[68:71], v[64:67]
  ds_read_b64_tr_b16 a[52:53], v110 offset:25096
  v_mfma_f32_16x16x32_bf16 v[68:71], a[16:19], a[72:75], v[68:71]
  ds_read_b64_tr_b16 a[54:55], v110 offset:26120
  s_waitcnt lgkmcnt(15)
  v_mfma_f32_16x16x32_bf16 v[72:75], a[20:23], a[64:67], v[72:75]
  ds_read_b64_tr_b16 a[56:57], v110 offset:25344
  v_mfma_f32_16x16x32_bf16 v[76:79], a[20:23], a[68:71], v[76:79]
  ds_read_b64_tr_b16 a[58:59], v110 offset:26368
  v_mfma_f32_16x16x32_bf16 v[80:83], a[20:23], a[72:75], v[80:83]
  ds_read_b64_tr_b16 a[60:61], v110 offset:25352
  v_mfma_f32_16x16x32_bf16 v[84:87], a[24:27], a[64:67], v[84:87]
  ds_read_b64_tr_b16 a[62:63], v110 offset:26376
  v_mfma_f32_16x16x32_bf16 v[88:91], a[24:27], a[68:71], v[88:91]
  v_mfma_f32_16x16x32_bf16 v[92:95], a[24:27], a[72:75], v[92:95]
  v_mfma_f32_16x16x32_bf16 v[96:99], a[28:31], a[64:67], v[96:99]
  v_mfma_f32_16x16x32_bf16 v[100:103], a[28:31], a[68:71], v[100:103]
  v_mfma_f32_16x16x32_bf16 v[104:107], a[28:31], a[72:75], v[104:107]
  s_waitcnt vmcnt(6) lgkmcnt(15)
  s_barrier
  s_waitcnt lgkmcnt(14)
  v_mfma_f32_16x16x32_bf16 v[12:15], a[32:35], a[76:79], v[12:15]
  ds_read_b128 a[64:67], v5 offset:0
  s_add_u32 s35, s35, 262144
  s_cmp_eq_u32 s35, 5242880
  s_cselect_b32 s35, 0, s35
  s_add_u32 m0, s32, 57344
  s_nop 0
  buffer_load_dwordx4 v108, s[20:23], s35 offen lds
  v_mfma_f32_16x16x32_bf16 v[16:19], a[32:35], a[80:83], v[16:19]
  ds_read_b128 a[68:71], v5 offset:8192
  v_mfma_f32_16x16x32_bf16 v[20:23], a[32:35], a[84:87], v[20:23]
  ds_read_b128 a[72:75], v5 offset:32768
  s_add_u32 m0, s32, 58368
  s_add_u32 s38, s35, 32768
  buffer_load_dwordx4 v108, s[20:23], s38 offen lds
  s_waitcnt lgkmcnt(15)
  v_mfma_f32_16x16x32_bf16 v[24:27], a[36:39], a[76:79], v[24:27]
  ds_read_b64_tr_b16 a[0:1], v111 offset:0
  v_mfma_f32_16x16x32_bf16 v[28:31], a[36:39], a[80:83], v[28:31]
  ds_read_b64_tr_b16 a[2:3], v111 offset:1024
  s_add_u32 s52, s52, 128
  s_cmp_eq_u32 s52, 1280
  s_cselect_b32 s52, 0, s52
  s_add_u32 m0, s33, 40960
  s_add_u32 s38, s52, 0
  buffer_load_dwordx4 v109, s[16:19], s38 offen lds
  v_mfma_f32_16x16x32_bf16 v[32:35], a[36:39], a[84:87], v[32:35]
  ds_read_b64_tr_b16 a[4:5], v111 offset:8
  s_waitcnt lgkmcnt(15)
  v_mfma_f32_16x16x32_bf16 v[36:39], a[40:43], a[76:79], v[36:39]
  ds_read_b64_tr_b16 a[6:7], v111 offset:1032
  s_add_u32 m0, s33, 16384
  s_add_u32 s38, s52, 20480
  buffer_load_dwordx4 v109, s[16:19], s38 offen lds
  v_mfma_f32_16x16x32_bf16 v[40:43], a[40:43], a[80:83], v[40:43]
  ds_read_b64_tr_b16 a[8:9], v111 offset:256
  v_mfma_f32_16x16x32_bf16 v[44:47], a[40:43], a[84:87], v[44:47]
  ds_read_b64_tr_b16 a[10:11], v111 offset:1280
  s_add_u32 m0, s33, 49152
  s_add_u32 s38, s52, 40960
  buffer_load_dwordx4 v109, s[16:19], s38 offen lds
  s_waitcnt lgkmcnt(15)
  v_mfma_f32_16x16x32_bf16 v[48:51], a[44:47], a[76:79], v[48:51]
  ds_read_b64_tr_b16 a[12:13], v111 offset:264
  v_mfma_f32_16x16x32_bf16 v[52:55], a[44:47], a[80:83], v[52:55]
  ds_read_b64_tr_b16 a[14:15], v111 offset:1288
  v_mfma_f32_16x16x32_bf16 v[56:59], a[44:47], a[84:87], v[56:59]
  ds_read_b64_tr_b16 a[16:17], v111 offset:512
  v_mfma_f32_16x16x32_bf16 v[60:63], a[48:51], a[76:79], v[60:63]
  ds_read_b64_tr_b16 a[18:19], v111 offset:1536
  v_mfma_f32_16x16x32_bf16 v[64:67], a[48:51], a[80:83], v[64:67]
  ds_read_b64_tr_b16 a[20:21], v111 offset:520
  v_mfma_f32_16x16x32_bf16 v[68:71], a[48:51], a[84:87], v[68:71]
  ds_read_b64_tr_b16 a[22:23], v111 offset:1544
  s_waitcnt lgkmcnt(15)
  v_mfma_f32_16x16x32_bf16 v[72:75], a[52:55], a[76:79], v[72:75]
  ds_read_b64_tr_b16 a[24:25], v111 offset:768
  v_mfma_f32_16x16x32_bf16 v[76:79], a[52:55], a[80:83], v[76:79]
  ds_read_b64_tr_b16 a[26:27], v111 offset:1792
  v_mfma_f32_16x16x32_bf16 v[80:83], a[52:55], a[84:87], v[80:83]
  ds_read_b64_tr_b16 a[28:29], v111 offset:776
  v_mfma_f32_16x16x32_bf16 v[84:87], a[56:59], a[76:79], v[84:87]
  ds_read_b64_tr_b16 a[30:31], v111 offset:1800
  v_mfma_f32_16x16x32_bf16 v[88:91], a[56:59], a[80:83], v[88:91]
  v_mfma_f32_16x16x32_bf16 v[92:95], a[56:59], a[84:87], v[92:95]
  v_mfma_f32_16x16x32_bf16 v[96:99], a[60:63], a[76:79], v[96:99]
  v_mfma_f32_16x16x32_bf16 v[100:103], a[60:63], a[80:83], v[100:103]
  v_mfma_f32_16x16x32_bf16 v[104:107], a[60:63], a[84:87], v[104:107]
  s_waitcnt vmcnt(5)
  s_barrier
  s_waitcnt lgkmcnt(14)
  v_mfma_f32_16x16x32_bf16 v[12:15], a[0:3], a[64:67], v[12:15]
  ds_read_b128 a[76:79], v5 offset:512
  s_add_u32 s35, s35, 262144
  s_add_u32 m0, s32, 24576
  s_nop 0
  buffer_load_dwordx4 v108, s[20:23], s35 offen lds
  v_mfma_f32_16x16x32_bf16 v[16:19], a[0:3], a[68:71], v[16:19]
  ds_read_b128 a[80:83], v5 offset:8704
  v_mfma_f32_16x16x32_bf16 v[20:23], a[0:3], a[72:75], v[20:23]
  ds_read_b128 a[84:87], v5 offset:33280
  s_add_u32 m0, s32, 25600
  s_add_u32 s38, s35, 32768
  buffer_load_dwordx4 v108, s[20:23], s38 offen lds
  s_waitcnt lgkmcnt(15)
  v_mfma_f32_16x16x32_bf16 v[24:27], a[4:7], a[64:67], v[24:27]
  ds_read_b64_tr_b16 a[32:33], v111 offset:8192
  v_mfma_f32_16x16x32_bf16 v[28:31], a[4:7], a[68:71], v[28:31]
  ds_read_b64_tr_b16 a[34:35], v111 offset:9216
  v_mfma_f32_16x16x32_bf16 v[32:35], a[4:7], a[72:75], v[32:35]
  ds_read_b64_tr_b16 a[36:37], v111 offset:8200
  s_waitcnt lgkmcnt(15)
  v_mfma_f32_16x16x32_bf16 v[36:39], a[8:11], a[64:67], v[36:39]
  ds_read_b64_tr_b16 a[38:39], v111 offset:9224
  v_mfma_f32_16x16x32_bf16 v[40:43], a[8:11], a[68:71], v[40:43]
  ds_read_b64_tr_b16 a[40:41], v111 offset:8448
  v_mfma_f32_16x16x32_bf16 v[44:47], a[8:11], a[72:75], v[44:47]
  ds_read_b64_tr_b16 a[42:43], v111 offset:9472
  s_waitcnt lgkmcnt(15)
  v_mfma_f32_16x16x32_bf16 v[48:51], a[12:15], a[64:67], v[48:51]
  ds_read_b64_tr_b16 a[44:45], v111 offset:8456
  v_mfma_f32_16x16x32_bf16 v[52:55], a[12:15], a[68:71], v[52:55]
  ds_read_b64_tr_b16 a[46:47], v111 offset:9480
  v_mfma_f32_16x16x32_bf16 v[56:59], a[12:15], a[72:75], v[56:59]
  ds_read_b64_tr_b16 a[48:49], v111 offset:8704
  v_mfma_f32_16x16x32_bf16 v[60:63], a[16:19], a[64:67], v[60:63]
  ds_read_b64_tr_b16 a[50:51], v111 offset:9728
  v_mfma_f32_16x16x32_bf16 v[64:67], a[16:19], a[68:71], v[64:67]
  ds_read_b64_tr_b16 a[52:53], v111 offset:8712
  v_mfma_f32_16x16x32_bf16 v[68:71], a[16:19], a[72:75], v[68:71]
  ds_read_b64_tr_b16 a[54:55], v111 offset:9736
  s_waitcnt lgkmcnt(15)
  v_mfma_f32_16x16x32_bf16 v[72:75], a[20:23], a[64:67], v[72:75]
  ds_read_b64_tr_b16 a[56:57], v111 offset:8960
  v_mfma_f32_16x16x32_bf16 v[76:79], a[20:23], a[68:71], v[76:79]
  ds_read_b64_tr_b16 a[58:59], v111 offset:9984
  v_mfma_f32_16x16x32_bf16 v[80:83], a[20:23], a[72:75], v[80:83]
  ds_read_b64_tr_b16 a[60:61], v111 offset:8968
  v_mfma_f32_16x16x32_bf16 v[84:87], a[24:27], a[64:67], v[84:87]
  ds_read_b64_tr_b16 a[62:63], v111 offset:9992
  v_mfma_f32_16x16x32_bf16 v[88:91], a[24:27], a[68:71], v[88:91]
  v_mfma_f32_16x16x32_bf16 v[92:95], a[24:27], a[72:75], v[92:95]
  v_mfma_f32_16x16x32_bf16 v[96:99], a[28:31], a[64:67], v[96:99]
  v_mfma_f32_16x16x32_bf16 v[100:103], a[28:31], a[68:71], v[100:103]
  v_mfma_f32_16x16x32_bf16 v[104:107], a[28:31], a[72:75], v[104:107]
  s_waitcnt vmcnt(5) lgkmcnt(15)
  s_barrier
  s_waitcnt lgkmcnt(14)
  v_mfma_f32_16x16x32_bf16 v[12:15], a[32:35], a[76:79], v[12:15]
  ds_read_b128 a[64:67], v6 offset:0
  s_add_u32 s35, s35, 262144
  s_cmp_eq_u32 s35, 5242880
  s_cselect_b32 s35, 0, s35
  s_add_u32 m0, s32, 65536
  s_nop 0
  buffer_load_dwordx4 v108, s[20:23], s35 offen lds
  v_mfma_f32_16x16x32_bf16 v[16:19], a[32:35], a[80:83], v[16:19]
  ds_read_b128 a[68:71], v6 offset:8192
  v_mfma_f32_16x16x32_bf16 v[20:23], a[32:35], a[84:87], v[20:23]
  ds_read_b128 a[72:75], v6 offset:32768
  s_add_u32 m0, s32, 66560
  s_add_u32 s38, s35, 32768
  buffer_load_dwordx4 v108, s[20:23], s38 offen lds
  s_waitcnt lgkmcnt(15)
  v_mfma_f32_16x16x32_bf16 v[24:27], a[36:39], a[76:79], v[24:27]
  ds_read_b64_tr_b16 a[0:1], v110 offset:57344
  v_mfma_f32_16x16x32_bf16 v[28:31], a[36:39], a[80:83], v[28:31]
  ds_read_b64_tr_b16 a[2:3], v110 offset:58368
  s_add_u32 s52, s52, 128
  s_cmp_eq_u32 s52, 1280
  s_cselect_b32 s52, 0, s52
  s_add_u32 m0, s33, 122880
  s_add_u32 s38, s52, 0
  buffer_load_dwordx4 v109, s[16:19], s38 offen lds
  v_mfma_f32_16x16x32_bf16 v[32:35], a[36:39], a[84:87], v[32:35]
  ds_read_b64_tr_b16 a[4:5], v110 offset:57352
  s_waitcnt lgkmcnt(15)
  v_mfma_f32_16x16x32_bf16 v[36:39], a[40:43], a[76:79], v[36:39]
  ds_read_b64_tr_b16 a[6:7], v110 offset:58376
  s_add_u32 m0, s33, 98304
  s_add_u32 s38, s52, 20480
  buffer_load_dwordx4 v109, s[16:19], s38 offen lds
  v_mfma_f32_16x16x32_bf16 v[40:43], a[40:43], a[80:83], v[40:43]
  ds_read_b64_tr_b16 a[8:9], v110 offset:57600
  v_mfma_f32_16x16x32_bf16 v[44:47], a[40:43], a[84:87], v[44:47]
  ds_read_b64_tr_b16 a[10:11], v110 offset:58624
  s_add_u32 m0, s33, 131072
  s_add_u32 s38, s52, 40960
  buffer_load_dwordx4 v109, s[16:19], s38 offen lds
  s_waitcnt lgkmcnt(15)
  v_mfma_f32_16x16x32_bf16 v[48:51], a[44:47], a[76:79], v[48:51]
  ds_read_b64_tr_b16 a[12:13], v110 offset:57608
  v_mfma_f32_16x16x32_bf16 v[52:55], a[44:47], a[80:83], v[52:55]
  ds_read_b64_tr_b16 a[14:15], v110 offset:58632
  v_mfma_f32_16x16x32_bf16 v[56:59], a[44:47], a[84:87], v[56:59]
  ds_read_b64_tr_b16 a[16:17], v110 offset:57856
  v_mfma_f32_16x16x32_bf16 v[60:63], a[48:51], a[76:79], v[60:63]
  ds_read_b64_tr_b16 a[18:19], v110 offset:58880
  s_mov_b32 s38, 4096
  buffer_load_dwordx4 a[96:99], v4, s[68:71], s38 offen
  v_mfma_f32_16x16x32_bf16 v[64:67], a[48:51], a[80:83], v[64:67]
  ds_read_b64_tr_b16 a[20:21], v110 offset:57864
  v_mfma_f32_16x16x32_bf16 v[68:71], a[48:51], a[84:87], v[68:71]
  ds_read_b64_tr_b16 a[22:23], v110 offset:58888
  s_waitcnt lgkmcnt(15)
  v_mfma_f32_16x16x32_bf16 v[72:75], a[52:55], a[76:79], v[72:75]
  ds_read_b64_tr_b16 a[24:25], v110 offset:58112
  v_mfma_f32_16x16x32_bf16 v[76:79], a[52:55], a[80:83], v[76:79]
  ds_read_b64_tr_b16 a[26:27], v110 offset:59136
  v_mfma_f32_16x16x32_bf16 v[80:83], a[52:55], a[84:87], v[80:83]
  ds_read_b64_tr_b16 a[28:29], v110 offset:58120
  v_mfma_f32_16x16x32_bf16 v[84:87], a[56:59], a[76:79], v[84:87]
  ds_read_b64_tr_b16 a[30:31], v110 offset:59144
  v_mfma_f32_16x16x32_bf16 v[88:91], a[56:59], a[80:83], v[88:91]
  v_mfma_f32_16x16x32_bf16 v[92:95], a[56:59], a[84:87], v[92:95]
  v_mfma_f32_16x16x32_bf16 v[96:99], a[60:63], a[76:79], v[96:99]
  v_mfma_f32_16x16x32_bf16 v[100:103], a[60:63], a[80:83], v[100:103]
  v_mfma_f32_16x16x32_bf16 v[104:107], a[60:63], a[84:87], v[104:107]
  s_waitcnt vmcnt(6)
  s_barrier
  s_waitcnt lgkmcnt(14)
  v_mfma_f32_16x16x32_bf16 v[12:15], a[0:3], a[64:67], v[12:15]
  ds_read_b128 a[76:79], v6 offset:512
  s_add_u32 s35, s35, 262144
  s_add_u32 m0, s32, 73728
  s_nop 0
  buffer_load_dwordx4 v108, s[20:23], s35 offen lds
  v_mfma_f32_16x16x32_bf16 v[16:19], a[0:3], a[68:71], v[16:19]
  ds_read_b128 a[80:83], v6 offset:8704
  v_mfma_f32_16x16x32_bf16 v[20:23], a[0:3], a[72:75], v[20:23]
  ds_read_b128 a[84:87], v6 offset:33280
  s_add_u32 m0, s32, 74752
  s_add_u32 s38, s35, 32768
  buffer_load_dwordx4 v108, s[20:23], s38 offen lds
  s_waitcnt lgkmcnt(15)
  v_mfma_f32_16x16x32_bf16 v[24:27], a[4:7], a[64:67], v[24:27]
  ds_read_b64_tr_b16 a[32:33], v110 offset:24576
  v_mfma_f32_16x16x32_bf16 v[28:31], a[4:7], a[68:71], v[28:31]
  ds_read_b64_tr_b16 a[34:35], v110 offset:25600
  v_mfma_f32_16x16x32_bf16 v[32:35], a[4:7], a[72:75], v[32:35]
  ds_read_b64_tr_b16 a[36:37], v110 offset:24584
  s_waitcnt lgkmcnt(15)
  v_mfma_f32_16x16x32_bf16 v[36:39], a[8:11], a[64:67], v[36:39]
  ds_read_b64_tr_b16 a[38:39], v110 offset:25608
  v_mfma_f32_16x16x32_bf16 v[40:43], a[8:11], a[68:71], v[40:43]
  ds_read_b64_tr_b16 a[40:41], v110 offset:24832
  v_mfma_f32_16x16x32_bf16 v[44:47], a[8:11], a[72:75], v[44:47]
  ds_read_b64_tr_b16 a[42:43], v110 offset:25856
  s_waitcnt lgkmcnt(15)
  v_mfma_f32_16x16x32_bf16 v[48:51], a[12:15], a[64:67], v[48:51]
  ds_read_b64_tr_b16 a[44:45], v110 offset:24840
  v_mfma_f32_16x16x32_bf16 v[52:55], a[12:15], a[68:71], v[52:55]
  ds_read_b64_tr_b16 a[46:47], v110 offset:25864
  v_mfma_f32_16x16x32_bf16 v[56:59], a[12:15], a[72:75], v[56:59]
  ds_read_b64_tr_b16 a[48:49], v110 offset:25088
  v_mfma_f32_16x16x32_bf16 v[60:63], a[16:19], a[64:67], v[60:63]
  ds_read_b64_tr_b16 a[50:51], v110 offset:26112
  v_mfma_f32_16x16x32_bf16 v[64:67], a[16:19], a[68:71], v[64:67]
  ds_read_b64_tr_b16 a[52:53], v110 offset:25096
  v_mfma_f32_16x16x32_bf16 v[68:71], a[16:19], a[72:75], v[68:71]
  ds_read_b64_tr_b16 a[54:55], v110 offset:26120
  s_waitcnt lgkmcnt(15)
  v_mfma_f32_16x16x32_bf16 v[72:75], a[20:23], a[64:67], v[72:75]
  ds_read_b64_tr_b16 a[56:57], v110 offset:25344
  v_mfma_f32_16x16x32_bf16 v[76:79], a[20:23], a[68:71], v[76:79]
  ds_read_b64_tr_b16 a[58:59], v110 offset:26368
  v_mfma_f32_16x16x32_bf16 v[80:83], a[20:23], a[72:75], v[80:83]
  ds_read_b64_tr_b16 a[60:61], v110 offset:25352
  v_mfma_f32_16x16x32_bf16 v[84:87], a[24:27], a[64:67], v[84:87]
  ds_read_b64_tr_b16 a[62:63], v110 offset:26376
  v_mfma_f32_16x16x32_bf16 v[88:91], a[24:27], a[68:71], v[88:91]
  v_mfma_f32_16x16x32_bf16 v[92:95], a[24:27], a[72:75], v[92:95]
  v_mfma_f32_16x16x32_bf16 v[96:99], a[28:31], a[64:67], v[96:99]
  v_mfma_f32_16x16x32_bf16 v[100:103], a[28:31], a[68:71], v[100:103]
  v_mfma_f32_16x16x32_bf16 v[104:107], a[28:31], a[72:75], v[104:107]
  s_waitcnt vmcnt(6) lgkmcnt(15)
  s_barrier
  s_waitcnt lgkmcnt(14)
  v_mfma_f32_16x16x32_bf16 v[12:15], a[32:35], a[76:79], v[12:15]
  ds_read_b128 a[64:67], v5 offset:40960
  s_add_u32 s35, s35, 262144
  s_cmp_eq_u32 s35, 5242880
  s_cselect_b32 s35, 0, s35
  s_add_u32 m0, s32, 57344
  s_nop 0
  buffer_load_dwordx4 v108, s[20:23], s35 offen lds
  v_mfma_f32_16x16x32_bf16 v[16:19], a[32:35], a[80:83], v[16:19]
  ds_read_b128 a[68:71], v5 offset:16384
  v_mfma_f32_16x16x32_bf16 v[20:23], a[32:35], a[84:87], v[20:23]
  ds_read_b128 a[72:75], v5 offset:49152
  s_add_u32 m0, s32, 58368
  s_add_u32 s38, s35, 32768
  buffer_load_dwordx4 v108, s[20:23], s38 offen lds
  s_waitcnt lgkmcnt(15)
  v_mfma_f32_16x16x32_bf16 v[24:27], a[36:39], a[76:79], v[24:27]
  ds_read_b64_tr_b16 a[0:1], v111 offset:0
  v_mfma_f32_16x16x32_bf16 v[28:31], a[36:39], a[80:83], v[28:31]
  ds_read_b64_tr_b16 a[2:3], v111 offset:1024
  v_mfma_f32_16x16x32_bf16 v[32:35], a[36:39], a[84:87], v[32:35]
  ds_read_b64_tr_b16 a[4:5], v111 offset:8
  s_waitcnt lgkmcnt(15)
  v_mfma_f32_16x16x32_bf16 v[36:39], a[40:43], a[76:79], v[36:39]
  ds_read_b64_tr_b16 a[6:7], v111 offset:1032
  v_mfma_f32_16x16x32_bf16 v[40:43], a[40:43], a[80:83], v[40:43]
  ds_read_b64_tr_b16 a[8:9], v111 offset:256
  v_mfma_f32_16x16x32_bf16 v[44:47], a[40:43], a[84:87], v[44:47]
  ds_read_b64_tr_b16 a[10:11], v111 offset:1280
  s_waitcnt lgkmcnt(15)
  v_mfma_f32_16x16x32_bf16 v[48:51], a[44:47], a[76:79], v[48:51]
  ds_read_b64_tr_b16 a[12:13], v111 offset:264
  v_mfma_f32_16x16x32_bf16 v[52:55], a[44:47], a[80:83], v[52:55]
  ds_read_b64_tr_b16 a[14:15], v111 offset:1288
  v_mfma_f32_16x16x32_bf16 v[56:59], a[44:47], a[84:87], v[56:59]
  ds_read_b64_tr_b16 a[16:17], v111 offset:512
  v_mfma_f32_16x16x32_bf16 v[60:63], a[48:51], a[76:79], v[60:63]
  ds_read_b64_tr_b16 a[18:19], v111 offset:1536
  v_mfma_f32_16x16x32_bf16 v[64:67], a[48:51], a[80:83], v[64:67]
  ds_read_b64_tr_b16 a[20:21], v111 offset:520
  v_mfma_f32_16x16x32_bf16 v[68:71], a[48:51], a[84:87], v[68:71]
  ds_read_b64_tr_b16 a[22:23], v111 offset:1544
  s_waitcnt lgkmcnt(15)
  v_mfma_f32_16x16x32_bf16 v[72:75], a[52:55], a[76:79], v[72:75]
  ds_read_b64_tr_b16 a[24:25], v111 offset:768
  v_mfma_f32_16x16x32_bf16 v[76:79], a[52:55], a[80:83], v[76:79]
  ds_read_b64_tr_b16 a[26:27], v111 offset:1792
  v_mfma_f32_16x16x32_bf16 v[80:83], a[52:55], a[84:87], v[80:83]
  ds_read_b64_tr_b16 a[28:29], v111 offset:776
  v_mfma_f32_16x16x32_bf16 v[84:87], a[56:59], a[76:79], v[84:87]
  ds_read_b64_tr_b16 a[30:31], v111 offset:1800
  v_mfma_f32_16x16x32_bf16 v[88:91], a[56:59], a[80:83], v[88:91]
  v_mfma_f32_16x16x32_bf16 v[92:95], a[56:59], a[84:87], v[92:95]
  v_mfma_f32_16x16x32_bf16 v[96:99], a[60:63], a[76:79], v[96:99]
  v_mfma_f32_16x16x32_bf16 v[100:103], a[60:63], a[80:83], v[100:103]
  v_mfma_f32_16x16x32_bf16 v[104:107], a[60:63], a[84:87], v[104:107]
  s_waitcnt vmcnt(2)
  s_barrier
  s_waitcnt lgkmcnt(14)
  v_mfma_f32_16x16x32_bf16 v[12:15], a[0:3], a[64:67], v[12:15]
  ds_read_b128 a[76:79], v5 offset:41472
  s_add_u32 s35, s35, 262144
  s_add_u32 m0, s32, 24576
  s_nop 0
  buffer_load_dwordx4 v108, s[20:23], s35 offen lds
  v_mfma_f32_16x16x32_bf16 v[16:19], a[0:3], a[68:71], v[16:19]
  ds_read_b128 a[80:83], v5 offset:16896
  v_mfma_f32_16x16x32_bf16 v[20:23], a[0:3], a[72:75], v[20:23]
  ds_read_b128 a[84:87], v5 offset:49664
  s_add_u32 m0, s32, 25600
  s_add_u32 s38, s35, 32768
  buffer_load_dwordx4 v108, s[20:23], s38 offen lds
  s_mov_b32 s38, 0
  buffer_load_dwordx4 a[96:99], v4, s[68:71], s38 offen
  s_waitcnt lgkmcnt(15)
  v_mfma_f32_16x16x32_bf16 v[24:27], a[4:7], a[64:67], v[24:27]
  ds_read_b64_tr_b16 a[32:33], v111 offset:8192
  s_add_u32 s38, s53, 0
  s_and_b32 s38, s38, 0x3ffff
  s_add_u32 m0, s32, 0
  s_nop 0
  buffer_load_dwordx4 v4, s[8:11], s38 offen nt lds
  buffer_load_dwordx4 v0, s[8:11], s38 offen offset:1024 nt lds
  v_mfma_f32_16x16x32_bf16 v[28:31], a[4:7], a[68:71], v[28:31]
  ds_read_b64_tr_b16 a[34:35], v111 offset:9216
  v_mfma_f32_16x16x32_bf16 v[32:35], a[4:7], a[72:75], v[32:35]
  ds_read_b64_tr_b16 a[36:37], v111 offset:8200
  s_waitcnt lgkmcnt(15)
  v_mfma_f32_16x16x32_bf16 v[36:39], a[8:11], a[64:67], v[36:39]
  ds_read_b64_tr_b16 a[38:39], v111 offset:9224
  v_mfma_f32_16x16x32_bf16 v[40:43], a[8:11], a[68:71], v[40:43]
  ds_read_b64_tr_b16 a[40:41], v111 offset:8448
  s_add_u32 s38, s53, 8192
  s_and_b32 s38, s38, 0x3ffff
  s_add_u32 m0, s32, 8192
  s_nop 0
  buffer_load_dwordx4 v4, s[8:11], s38 offen nt lds
  buffer_load_dwordx4 v0, s[8:11], s38 offen offset:1024 nt lds
  v_mfma_f32_16x16x32_bf16 v[44:47], a[8:11], a[72:75], v[44:47]
  ds_read_b64_tr_b16 a[42:43], v111 offset:9472
  s_waitcnt lgkmcnt(15)
  v_mfma_f32_16x16x32_bf16 v[48:51], a[12:15], a[64:67], v[48:51]
  ds_read_b64_tr_b16 a[44:45], v111 offset:8456
  v_mfma_f32_16x16x32_bf16 v[52:55], a[12:15], a[68:71], v[52:55]
  ds_read_b64_tr_b16 a[46:47], v111 offset:9480
  v_mfma_f32_16x16x32_bf16 v[56:59], a[12:15], a[72:75], v[56:59]
  ds_read_b64_tr_b16 a[48:49], v111 offset:8704
  s_add_u32 s38, s53, 0
  s_and_b32 s38, s38, 0x3ffff
  s_add_u32 m0, s32, 32768
  s_nop 0
  buffer_load_dwordx4 v4, s[12:15], s38 offen nt lds
  buffer_load_dwordx4 v0, s[12:15], s38 offen offset:1024 nt lds
  v_mfma_f32_16x16x32_bf16 v[60:63], a[16:19], a[64:67], v[60:63]
  ds_read_b64_tr_b16 a[50:51], v111 offset:9728
  v_mfma_f32_16x16x32_bf16 v[64:67], a[16:19], a[68:71], v[64:67]
  ds_read_b64_tr_b16 a[52:53], v111 offset:8712
  v_mfma_f32_16x16x32_bf16 v[68:71], a[16:19], a[72:75], v[68:71]
  ds_read_b64_tr_b16 a[54:55], v111 offset:9736
  s_waitcnt lgkmcnt(15)
  v_mfma_f32_16x16x32_bf16 v[72:75], a[20:23], a[64:67], v[72:75]
  ds_read_b64_tr_b16 a[56:57], v111 offset:8960
  v_mfma_f32_16x16x32_bf16 v[76:79], a[20:23], a[68:71], v[76:79]
  ds_read_b64_tr_b16 a[58:59], v111 offset:9984
  v_mfma_f32_16x16x32_bf16 v[80:83], a[20:23], a[72:75], v[80:83]
  ds_read_b64_tr_b16 a[60:61], v111 offset:8968
  v_mfma_f32_16x16x32_bf16 v[84:87], a[24:27], a[64:67], v[84:87]
  ds_read_b64_tr_b16 a[62:63], v111 offset:9992
  v_mfma_f32_16x16x32_bf16 v[88:91], a[24:27], a[68:71], v[88:91]
  v_mfma_f32_16x16x32_bf16 v[92:95], a[24:27], a[72:75], v[92:95]
  v_mfma_f32_16x16x32_bf16 v[96:99], a[28:31], a[64:67], v[96:99]
  v_mfma_f32_16x16x32_bf16 v[100:103], a[28:31], a[68:71], v[100:103]
  v_mfma_f32_16x16x32_bf16 v[104:107], a[28:31], a[72:75], v[104:107]
  s_waitcnt vmcnt(9) lgkmcnt(15)
  s_barrier
  s_waitcnt lgkmcnt(14)
  v_mfma_f32_16x16x32_bf16 v[12:15], a[32:35], a[76:79], v[12:15]
  ds_read_b128 a[64:67], v6 offset:40960
  v_mfma_f32_16x16x32_bf16 v[16:19], a[32:35], a[80:83], v[16:19]
  ds_read_b128 a[68:71], v6 offset:16384
  v_mfma_f32_16x16x32_bf16 v[20:23], a[32:35], a[84:87], v[20:23]
  ds_read_b128 a[72:75], v6 offset:49152
  s_waitcnt lgkmcnt(15)
  v_mfma_f32_16x16x32_bf16 v[24:27], a[36:39], a[76:79], v[24:27]
  ds_read_b64_tr_b16 a[0:1], v110 offset:57344
  v_mfma_f32_16x16x32_bf16 v[28:31], a[36:39], a[80:83], v[28:31]
  ds_read_b64_tr_b16 a[2:3], v110 offset:58368
  v_mfma_f32_16x16x32_bf16 v[32:35], a[36:39], a[84:87], v[32:35]
  ds_read_b64_tr_b16 a[4:5], v110 offset:57352
  s_waitcnt lgkmcnt(15)
  v_mfma_f32_16x16x32_bf16 v[36:39], a[40:43], a[76:79], v[36:39]
  ds_read_b64_tr_b16 a[6:7], v110 offset:58376
  v_mfma_f32_16x16x32_bf16 v[40:43], a[40:43], a[80:83], v[40:43]
  ds_read_b64_tr_b16 a[8:9], v110 offset:57600
  v_mfma_f32_16x16x32_bf16 v[44:47], a[40:43], a[84:87], v[44:47]
  ds_read_b64_tr_b16 a[10:11], v110 offset:58624
  s_waitcnt lgkmcnt(15)
  v_mfma_f32_16x16x32_bf16 v[48:51], a[44:47], a[76:79], v[48:51]
  ds_read_b64_tr_b16 a[12:13], v110 offset:57608
  v_mfma_f32_16x16x32_bf16 v[52:55], a[44:47], a[80:83], v[52:55]
  ds_read_b64_tr_b16 a[14:15], v110 offset:58632
  v_mfma_f32_16x16x32_bf16 v[56:59], a[44:47], a[84:87], v[56:59]
  ds_read_b64_tr_b16 a[16:17], v110 offset:57856
  v_mfma_f32_16x16x32_bf16 v[60:63], a[48:51], a[76:79], v[60:63]
  ds_read_b64_tr_b16 a[18:19], v110 offset:58880
  v_mfma_f32_16x16x32_bf16 v[64:67], a[48:51], a[80:83], v[64:67]
  ds_read_b64_tr_b16 a[20:21], v110 offset:57864
  v_mfma_f32_16x16x32_bf16 v[68:71], a[48:51], a[84:87], v[68:71]
  ds_read_b64_tr_b16 a[22:23], v110 offset:58888
  s_waitcnt lgkmcnt(15)
  v_mfma_f32_16x16x32_bf16 v[72:75], a[52:55], a[76:79], v[72:75]
  ds_read_b64_tr_b16 a[24:25], v110 offset:58112
  v_mfma_f32_16x16x32_bf16 v[76:79], a[52:55], a[80:83], v[76:79]
  ds_read_b64_tr_b16 a[26:27], v110 offset:59136
  v_mfma_f32_16x16x32_bf16 v[80:83], a[52:55], a[84:87], v[80:83]
  ds_read_b64_tr_b16 a[28:29], v110 offset:58120
  v_mfma_f32_16x16x32_bf16 v[84:87], a[56:59], a[76:79], v[84:87]
  ds_read_b64_tr_b16 a[30:31], v110 offset:59144
  v_mfma_f32_16x16x32_bf16 v[88:91], a[56:59], a[80:83], v[88:91]
  v_mfma_f32_16x16x32_bf16 v[92:95], a[56:59], a[84:87], v[92:95]
  v_mfma_f32_16x16x32_bf16 v[96:99], a[60:63], a[76:79], v[96:99]
  v_mfma_f32_16x16x32_bf16 v[100:103], a[60:63], a[80:83], v[100:103]
  v_mfma_f32_16x16x32_bf16 v[104:107], a[60:63], a[84:87], v[104:107]
  s_waitcnt vmcnt(7)
  s_barrier
  s_waitcnt lgkmcnt(14)
  v_mfma_f32_16x16x32_bf16 v[12:15], a[0:3], a[64:67], v[12:15]
  ds_read_b128 a[76:79], v6 offset:41472
  v_mfma_f32_16x16x32_bf16 v[16:19], a[0:3], a[68:71], v[16:19]
  ds_read_b128 a[80:83], v6 offset:16896
  v_mfma_f32_16x16x32_bf16 v[20:23], a[0:3], a[72:75], v[20:23]
  ds_read_b128 a[84:87], v6 offset:49664
  s_waitcnt lgkmcnt(15)
  v_mfma_f32_16x16x32_bf16 v[24:27], a[4:7], a[64:67], v[24:27]
  ds_read_b64_tr_b16 a[32:33], v110 offset:24576
  v_mfma_f32_16x16x32_bf16 v[28:31], a[4:7], a[68:71], v[28:31]
  ds_read_b64_tr_b16 a[34:35], v110 offset:25600
  v_mfma_f32_16x16x32_bf16 v[32:35], a[4:7], a[72:75], v[32:35]
  ds_read_b64_tr_b16 a[36:37], v110 offset:24584
  s_waitcnt lgkmcnt(15)
  v_mfma_f32_16x16x32_bf16 v[36:39], a[8:11], a[64:67], v[36:39]
  ds_read_b64_tr_b16 a[38:39], v110 offset:25608
  v_mfma_f32_16x16x32_bf16 v[40:43], a[8:11], a[68:71], v[40:43]
  ds_read_b64_tr_b16 a[40:41], v110 offset:24832
  v_mfma_f32_16x16x32_bf16 v[44:47], a[8:11], a[72:75], v[44:47]
  ds_read_b64_tr_b16 a[42:43], v110 offset:25856
  s_waitcnt lgkmcnt(15)
  v_mfma_f32_16x16x32_bf16 v[48:51], a[12:15], a[64:67], v[48:51]
  ds_read_b64_tr_b16 a[44:45], v110 offset:24840
  v_mfma_f32_16x16x32_bf16 v[52:55], a[12:15], a[68:71], v[52:55]
  ds_read_b64_tr_b16 a[46:47], v110 offset:25864
  v_mfma_f32_16x16x32_bf16 v[56:59], a[12:15], a[72:75], v[56:59]
  ds_read_b64_tr_b16 a[48:49], v110 offset:25088
  v_mfma_f32_16x16x32_bf16 v[60:63], a[16:19], a[64:67], v[60:63]
  ds_read_b64_tr_b16 a[50:51], v110 offset:26112
  v_mfma_f32_16x16x32_bf16 v[64:67], a[16:19], a[68:71], v[64:67]
  ds_read_b64_tr_b16 a[52:53], v110 offset:25096
  v_mfma_f32_16x16x32_bf16 v[68:71], a[16:19], a[72:75], v[68:71]
  ds_read_b64_tr_b16 a[54:55], v110 offset:26120
  s_waitcnt lgkmcnt(15)
  v_mfma_f32_16x16x32_bf16 v[72:75], a[20:23], a[64:67], v[72:75]
  ds_read_b64_tr_b16 a[56:57], v110 offset:25344
  v_mfma_f32_16x16x32_bf16 v[76:79], a[20:23], a[68:71], v[76:79]
  ds_read_b64_tr_b16 a[58:59], v110 offset:26368
  v_mfma_f32_16x16x32_bf16 v[80:83], a[20:23], a[72:75], v[80:83]
  ds_read_b64_tr_b16 a[60:61], v110 offset:25352
  v_mfma_f32_16x16x32_bf16 v[84:87], a[24:27], a[64:67], v[84:87]
  ds_read_b64_tr_b16 a[62:63], v110 offset:26376
  v_mfma_f32_16x16x32_bf16 v[88:91], a[24:27], a[68:71], v[88:91]
  v_mfma_f32_16x16x32_bf16 v[92:95], a[24:27], a[72:75], v[92:95]
  v_mfma_f32_16x16x32_bf16 v[96:99], a[28:31], a[64:67], v[96:99]
  v_mfma_f32_16x16x32_bf16 v[100:103], a[28:31], a[68:71], v[100:103]
  v_mfma_f32_16x16x32_bf16 v[104:107], a[28:31], a[72:75], v[104:107]
  s_waitcnt lgkmcnt(15)
  s_barrier
  s_waitcnt lgkmcnt(14)
  v_mfma_f32_16x16x32_bf16 v[12:15], a[32:35], a[76:79], v[12:15]
  v_mfma_f32_16x16x32_bf16 v[16:19], a[32:35], a[80:83], v[16:19]
  v_mfma_f32_16x16x32_bf16 v[20:23], a[32:35], a[84:87], v[20:23]
  s_waitcnt lgkmcnt(12)
  v_mfma_f32_16x16x32_bf16 v[24:27], a[36:39], a[76:79], v[24:27]
  s_add_u32 s38, s53, 8192
  s_and_b32 s38, s38, 0x3ffff
  s_add_u32 m0, s32, 40960
  s_nop 0
  buffer_load_dwordx4 v4, s[12:15], s38 offen nt lds
  buffer_load_dwordx4 v0, s[12:15], s38 offen offset:1024 nt lds
  v_mfma_f32_16x16x32_bf16 v[28:31], a[36:39], a[80:83], v[28:31]
  v_mfma_f32_16x16x32_bf16 v[32:35], a[36:39], a[84:87], v[32:35]
  s_waitcnt lgkmcnt(10)
  v_mfma_f32_16x16x32_bf16 v[36:39], a[40:43], a[76:79], v[36:39]
  v_mfma_f32_16x16x32_bf16 v[40:43], a[40:43], a[80:83], v[40:43]
  s_add_u32 s38, s53, 16384
  s_and_b32 s38, s38, 0x3ffff
  s_add_u32 m0, s32, 16384
  s_nop 0
  buffer_load_dwordx4 v4, s[8:11], s38 offen nt lds
  buffer_load_dwordx4 v0, s[8:11], s38 offen offset:1024 nt lds
  v_mfma_f32_16x16x32_bf16 v[44:47], a[40:43], a[84:87], v[44:47]
  s_waitcnt lgkmcnt(8)
  v_mfma_f32_16x16x32_bf16 v[48:51], a[44:47], a[76:79], v[48:51]
  v_mfma_f32_16x16x32_bf16 v[52:55], a[44:47], a[80:83], v[52:55]
  v_mfma_f32_16x16x32_bf16 v[56:59], a[44:47], a[84:87], v[56:59]
  s_waitcnt lgkmcnt(6)
  v_mfma_f32_16x16x32_bf16 v[60:63], a[48:51], a[76:79], v[60:63]
  v_mfma_f32_16x16x32_bf16 v[64:67], a[48:51], a[80:83], v[64:67]
  v_mfma_f32_16x16x32_bf16 v[68:71], a[48:51], a[84:87], v[68:71]
  s_waitcnt lgkmcnt(4)
  v_mfma_f32_16x16x32_bf16 v[72:75], a[52:55], a[76:79], v[72:75]
  v_mfma_f32_16x16x32_bf16 v[76:79], a[52:55], a[80:83], v[76:79]
  v_mfma_f32_16x16x32_bf16 v[80:83], a[52:55], a[84:87], v[80:83]
  s_waitcnt lgkmcnt(2)
  v_mfma_f32_16x16x32_bf16 v[84:87], a[56:59], a[76:79], v[84:87]
  v_mfma_f32_16x16x32_bf16 v[88:91], a[56:59], a[80:83], v[88:91]
  v_mfma_f32_16x16x32_bf16 v[92:95], a[56:59], a[84:87], v[92:95]
  s_waitcnt lgkmcnt(0)
  v_mfma_f32_16x16x32_bf16 v[96:99], a[60:63], a[76:79], v[96:99]
  v_mfma_f32_16x16x32_bf16 v[100:103], a[60:63], a[80:83], v[100:103]
  v_mfma_f32_16x16x32_bf16 v[104:107], a[60:63], a[84:87], v[104:107]
  s_waitcnt vmcnt(10)
  v_pk_mul_f32 v[12:13], v[12:13], s[58:59]
  v_pk_mul_f32 v[14:15], v[14:15], s[58:59]
  v_cvt_pk_bf16_f32 v12, v12, v13
  v_cvt_pk_bf16_f32 v14, v14, v15
  v_accvgpr_write_b32 a96, v12
  v_accvgpr_write_b32 a97, v14
  v_pk_mul_f32 v[16:17], v[16:17], s[58:59]
  v_pk_mul_f32 v[18:19], v[18:19], s[58:59]
  v_cvt_pk_bf16_f32 v16, v16, v17
  v_cvt_pk_bf16_f32 v18, v18, v19
  v_accvgpr_write_b32 a112, v16
  v_accvgpr_write_b32 a113, v18
  v_pk_mul_f32 v[20:21], v[20:21], s[58:59]
  v_pk_mul_f32 v[22:23], v[22:23], s[58:59]
  v_cvt_pk_bf16_f32 v20, v20, v21
  v_cvt_pk_bf16_f32 v22, v22, v23
  v_accvgpr_write_b32 a128, v20
  v_accvgpr_write_b32 a129, v22
  v_pk_mul_f32 v[24:25], v[24:25], s[58:59]
  v_pk_mul_f32 v[26:27], v[26:27], s[58:59]
  v_cvt_pk_bf16_f32 v24, v24, v25
  v_cvt_pk_bf16_f32 v26, v26, v27
  v_accvgpr_write_b32 a98, v24
  v_accvgpr_write_b32 a99, v26
  v_pk_mul_f32 v[28:29], v[28:29], s[58:59]
  v_pk_mul_f32 v[30:31], v[30:31], s[58:59]
  v_cvt_pk_bf16_f32 v28, v28, v29
  v_cvt_pk_bf16_f32 v30, v30, v31
  v_accvgpr_write_b32 a114, v28
  v_accvgpr_write_b32 a115, v30
  v_pk_mul_f32 v[32:33], v[32:33], s[58:59]
  v_pk_mul_f32 v[34:35], v[34:35], s[58:59]
  v_cvt_pk_bf16_f32 v32, v32, v33
  v_cvt_pk_bf16_f32 v34, v34, v35
  v_accvgpr_write_b32 a130, v32
  v_accvgpr_write_b32 a131, v34
  v_pk_mul_f32 v[36:37], v[36:37], s[58:59]
  v_pk_mul_f32 v[38:39], v[38:39], s[58:59]
  v_cvt_pk_bf16_f32 v36, v36, v37
  v_cvt_pk_bf16_f32 v38, v38, v39
  v_accvgpr_write_b32 a100, v36
  v_accvgpr_write_b32 a101, v38
  v_pk_mul_f32 v[40:41], v[40:41], s[58:59]
  v_pk_mul_f32 v[42:43], v[42:43], s[58:59]
  v_cvt_pk_bf16_f32 v40, v40, v41
  v_cvt_pk_bf16_f32 v42, v42, v43
  v_accvgpr_write_b32 a116, v40
  v_accvgpr_write_b32 a117, v42
  v_pk_mul_f32 v[44:45], v[44:45], s[58:59]
  v_pk_mul_f32 v[46:47], v[46:47], s[58:59]
  v_cvt_pk_bf16_f32 v44, v44, v45
  v_cvt_pk_bf16_f32 v46, v46, v47
  v_accvgpr_write_b32 a132, v44
  v_accvgpr_write_b32 a133, v46
  v_pk_mul_f32 v[48:49], v[48:49], s[58:59]
  v_pk_mul_f32 v[50:51], v[50:51], s[58:59]
  v_cvt_pk_bf16_f32 v48, v48, v49
  v_cvt_pk_bf16_f32 v50, v50, v51
  v_accvgpr_write_b32 a102, v48
  v_accvgpr_write_b32 a103, v50
  v_pk_mul_f32 v[52:53], v[52:53], s[58:59]
  v_pk_mul_f32 v[54:55], v[54:55], s[58:59]
  v_cvt_pk_bf16_f32 v52, v52, v53
  v_cvt_pk_bf16_f32 v54, v54, v55
  v_accvgpr_write_b32 a118, v52
  v_accvgpr_write_b32 a119, v54
  v_pk_mul_f32 v[56:57], v[56:57], s[58:59]
  v_pk_mul_f32 v[58:59], v[58:59], s[58:59]
  v_cvt_pk_bf16_f32 v56, v56, v57
  v_cvt_pk_bf16_f32 v58, v58, v59
  v_accvgpr_write_b32 a134, v56
  v_accvgpr_write_b32 a135, v58
  v_pk_mul_f32 v[60:61], v[60:61], s[58:59]
  v_pk_mul_f32 v[62:63], v[62:63], s[58:59]
  v_cvt_pk_bf16_f32 v60, v60, v61
  v_cvt_pk_bf16_f32 v62, v62, v63
  v_accvgpr_write_b32 a104, v60
  v_accvgpr_write_b32 a105, v62
  v_pk_mul_f32 v[64:65], v[64:65], s[58:59]
  v_pk_mul_f32 v[66:67], v[66:67], s[58:59]
  v_cvt_pk_bf16_f32 v64, v64, v65
  v_cvt_pk_bf16_f32 v66, v66, v67
  v_accvgpr_write_b32 a120, v64
  v_accvgpr_write_b32 a121, v66
  v_pk_mul_f32 v[68:69], v[68:69], s[58:59]
  v_pk_mul_f32 v[70:71], v[70:71], s[58:59]
  v_cvt_pk_bf16_f32 v68, v68, v69
  v_cvt_pk_bf16_f32 v70, v70, v71
  v_accvgpr_write_b32 a136, v68
  v_accvgpr_write_b32 a137, v70
  v_pk_mul_f32 v[72:73], v[72:73], s[58:59]
  v_pk_mul_f32 v[74:75], v[74:75], s[58:59]
  v_cvt_pk_bf16_f32 v72, v72, v73
  v_cvt_pk_bf16_f32 v74, v74, v75
  v_accvgpr_write_b32 a106, v72
  v_accvgpr_write_b32 a107, v74
  v_pk_mul_f32 v[76:77], v[76:77], s[58:59]
  v_pk_mul_f32 v[78:79], v[78:79], s[58:59]
  v_cvt_pk_bf16_f32 v76, v76, v77
  v_cvt_pk_bf16_f32 v78, v78, v79
  v_accvgpr_write_b32 a122, v76
  v_accvgpr_write_b32 a123, v78
  v_pk_mul_f32 v[80:81], v[80:81], s[58:59]
  v_pk_mul_f32 v[82:83], v[82:83], s[58:59]
  v_cvt_pk_bf16_f32 v80, v80, v81
  v_cvt_pk_bf16_f32 v82, v82, v83
  v_accvgpr_write_b32 a138, v80
  v_accvgpr_write_b32 a139, v82
  v_pk_mul_f32 v[84:85], v[84:85], s[58:59]
  v_pk_mul_f32 v[86:87], v[86:87], s[58:59]
  v_cvt_pk_bf16_f32 v84, v84, v85
  v_cvt_pk_bf16_f32 v86, v86, v87
  v_accvgpr_write_b32 a108, v84
  v_accvgpr_write_b32 a109, v86
  v_pk_mul_f32 v[88:89], v[88:89], s[58:59]
  v_pk_mul_f32 v[90:91], v[90:91], s[58:59]
  v_cvt_pk_bf16_f32 v88, v88, v89
  v_cvt_pk_bf16_f32 v90, v90, v91
  v_accvgpr_write_b32 a124, v88
  v_accvgpr_write_b32 a125, v90
  v_pk_mul_f32 v[92:93], v[92:93], s[58:59]
  v_pk_mul_f32 v[94:95], v[94:95], s[58:59]
  v_cvt_pk_bf16_f32 v92, v92, v93
  v_cvt_pk_bf16_f32 v94, v94, v95
  v_accvgpr_write_b32 a140, v92
  v_accvgpr_write_b32 a141, v94
  v_pk_mul_f32 v[96:97], v[96:97], s[58:59]
  v_pk_mul_f32 v[98:99], v[98:99], s[58:59]
  v_cvt_pk_bf16_f32 v96, v96, v97
  v_cvt_pk_bf16_f32 v98, v98, v99
  v_accvgpr_write_b32 a110, v96
  v_accvgpr_write_b32 a111, v98
  v_pk_mul_f32 v[100:101], v[100:101], s[58:59]
  v_pk_mul_f32 v[102:103], v[102:103], s[58:59]
  v_cvt_pk_bf16_f32 v100, v100, v101
  v_cvt_pk_bf16_f32 v102, v102, v103
  v_accvgpr_write_b32 a126, v100
  v_accvgpr_write_b32 a127, v102
  v_pk_mul_f32 v[104:105], v[104:105], s[58:59]
  v_pk_mul_f32 v[106:107], v[106:107], s[58:59]
  v_cvt_pk_bf16_f32 v104, v104, v105
  v_cvt_pk_bf16_f32 v106, v106, v107
  v_accvgpr_write_b32 a142, v104
  v_accvgpr_write_b32 a143, v106
  v_mov_b32 v8, 0xff800000
  v_mov_b32 v12, 0xff800000
  v_mov_b32 v16, 0xff800000
A_JOIN:
  s_waitcnt vmcnt(4)
  s_barrier
  ds_read_b128 v[44:47], v1 offset:0
  ds_read_b128 v[60:63], v1 offset:4096
  ds_read_b128 v[48:51], v1 offset:256
  ds_read_b128 v[64:67], v1 offset:4352
  ds_read_b128 v[52:55], v1 offset:512
  ds_read_b128 v[68:71], v1 offset:4608
  ds_read_b128 v[56:59], v1 offset:768
  ds_read_b128 v[72:75], v1 offset:4864
  v_mov_b32 v76, 0
  v_mov_b32 v77, 0
  v_mov_b32 v78, 0
  v_mov_b32 v79, 0
  s_nop 1
  v_mfma_f32_32x32x16_bf16 a[0:15], v[76:79], v[76:79], 0
  v_mfma_f32_32x32x16_bf16 a[16:31], v[76:79], v[76:79], 0
  v_mfma_f32_32x32x16_bf16 a[32:47], v[76:79], v[76:79], 0
  v_mfma_f32_32x32x16_bf16 a[48:63], v[76:79], v[76:79], 0
  v_mfma_f32_32x32x16_bf16 a[64:79], v[76:79], v[76:79], 0
  v_mfma_f32_32x32x16_bf16 a[80:95], v[76:79], v[76:79], 0
  v_mov_b32 v5, 0
  v_mov_b32 v6, 0
  v_mov_b32 v7, 0
  s_waitcnt lgkmcnt(7)
  v_mfma_f32_16x16x32_bf16 v[20:23], v[44:47], a[96:99], 0
  s_waitcnt lgkmcnt(6)
  v_mfma_f32_16x16x32_bf16 v[24:27], v[60:63], a[96:99], 0
  s_waitcnt lgkmcnt(5)
  v_mfma_f32_16x16x32_bf16 v[20:23], v[48:51], a[100:103], v[20:23]
  s_waitcnt lgkmcnt(4)
  v_mfma_f32_16x16x32_bf16 v[24:27], v[64:67], a[100:103], v[24:27]
  s_waitcnt lgkmcnt(3)
  v_mfma_f32_16x16x32_bf16 v[20:23], v[52:55], a[104:107], v[20:23]
  s_waitcnt lgkmcnt(2)
  v_mfma_f32_16x16x32_bf16 v[24:27], v[68:71], a[104:107], v[24:27]
  s_waitcnt lgkmcnt(1)
  v_mfma_f32_16x16x32_bf16 v[20:23], v[56:59], a[108:111], v[20:23]
  s_waitcnt lgkmcnt(0)
  v_mfma_f32_16x16x32_bf16 v[24:27], v[72:75], a[108:111], v[24:27]
  v_mfma_f32_16x16x32_bf16 v[28:31], v[44:47], a[112:115], 0
  v_mfma_f32_16x16x32_bf16 v[32:35], v[60:63], a[112:115], 0
  v_mfma_f32_16x16x32_bf16 v[28:31], v[48:51], a[116:119], v[28:31]
  v_mfma_f32_16x16x32_bf16 v[32:35], v[64:67], a[116:119], v[32:35]
  v_mfma_f32_16x16x32_bf16 v[28:31], v[52:55], a[120:123], v[28:31]
  v_mfma_f32_16x16x32_bf16 v[32:35], v[68:71], a[120:123], v[32:35]
  v_mfma_f32_16x16x32_bf16 v[28:31], v[56:59], a[124:127], v[28:31]
  v_mfma_f32_16x16x32_bf16 v[32:35], v[72:75], a[124:127], v[32:35]
  v_mfma_f32_16x16x32_bf16 v[36:39], v[44:47], a[128:131], 0
  v_mfma_f32_16x16x32_bf16 v[40:43], v[60:63], a[128:131], 0
  v_mfma_f32_16x16x32_bf16 v[36:39], v[48:51], a[132:135], v[36:39]
  v_mfma_f32_16x16x32_bf16 v[40:43], v[64:67], a[132:135], v[40:43]
  v_mfma_f32_16x16x32_bf16 v[36:39], v[52:55], a[136:139], v[36:39]
  v_mfma_f32_16x16x32_bf16 v[40:43], v[68:71], a[136:139], v[40:43]
  v_mfma_f32_16x16x32_bf16 v[36:39], v[56:59], a[140:143], v[36:39]
  v_mfma_f32_16x16x32_bf16 v[40:43], v[72:75], a[140:143], v[40:43]
  s_add_u32 s29, s53, 16384
  s_and_b32 s29, s29, 0x3ffff
  s_add_u32 s28, s53, 24576
  s_and_b32 s28, s28, 0x3ffff
  s_mov_b32 s30, 7
  ds_read_b64_tr_b16 v[76:77], v2 offset:32768
  ds_read_b64_tr_b16 v[78:79], v2 offset:36864
  ds_read_b64_tr_b16 v[80:81], v3 offset:32768
  ds_read_b64_tr_b16 v[82:83], v3 offset:36864
  ds_read_b64_tr_b16 v[84:85], v2 offset:33024
  ds_read_b64_tr_b16 v[86:87], v2 offset:37120
  ds_read_b64_tr_b16 v[88:89], v3 offset:33024
  ds_read_b64_tr_b16 v[90:91], v3 offset:37120
  ds_read_b64_tr_b16 v[92:93], v2 offset:33280
  ds_read_b64_tr_b16 v[94:95], v2 offset:37376
  ds_read_b64_tr_b16 v[96:97], v3 offset:33280
  ds_read_b64_tr_b16 v[98:99], v3 offset:37376
  ds_read_b64_tr_b16 v[100:101], v2 offset:33536
  ds_read_b64_tr_b16 v[102:103], v2 offset:37632
  ds_read_b64_tr_b16 v[104:105], v3 offset:33536
  ds_read_b64_tr_b16 v[106:107], v3 offset:37632
  ds_read_b128 v[44:47], v1 offset:8192
  ds_read_b128 v[60:63], v1 offset:12288
  ds_read_b128 v[48:51], v1 offset:8448
  ds_read_b128 v[64:67], v1 offset:12544
  ds_read_b128 v[52:55], v1 offset:8704
  ds_read_b128 v[68:71], v1 offset:12800
  ds_read_b128 v[56:59], v1 offset:8960
  ds_read_b128 v[72:75], v1 offset:13056
  v_max3_f32 v8, v20, v21, v8
  v_max3_f32 v8, v22, v23, v8
  v_max3_f32 v8, v24, v25, v8
  v_max3_f32 v8, v26, v27, v8
  v_mov_b32 v9, v8
  s_nop 1
  v_permlane16_swap_b32 v8, v9
  v_max_f32 v8, v8, v9
  v_mov_b32 v9, v8
  s_nop 1
  v_permlane32_swap_b32 v8, v9
  v_max_f32 v8, v8, v9
  v_sub_f32 v8, 0, v8
  v_mov_b32 v9, v8
  v_mov_b32 v10, v8
  v_mov_b32 v11, v8
  v_add_f32 v20, v20, v8
  v_add_f32 v21, v21, v8
  v_add_f32 v22, v22, v8
  v_add_f32 v23, v23, v8
  v_add_f32 v24, v24, v8
  v_add_f32 v25, v25, v8
  v_add_f32 v26, v26, v8
  v_add_f32 v27, v27, v8
  v_max3_f32 v12, v28, v29, v12
  v_max3_f32 v12, v30, v31, v12
  v_max3_f32 v12, v32, v33, v12
  v_max3_f32 v12, v34, v35, v12
  v_mov_b32 v13, v12
  s_nop 1
  v_permlane16_swap_b32 v12, v13
  v_max_f32 v12, v12, v13
  v_mov_b32 v13, v12
  s_nop 1
  v_permlane32_swap_b32 v12, v13
  v_max_f32 v12, v12, v13
  v_sub_f32 v12, 0, v12
  v_mov_b32 v13, v12
  v_mov_b32 v14, v12
  v_mov_b32 v15, v12
  v_add_f32 v28, v28, v12
  v_add_f32 v29, v29, v12
  v_add_f32 v30, v30, v12
  v_add_f32 v31, v31, v12
  v_add_f32 v32, v32, v12
  v_add_f32 v33, v33, v12
  v_add_f32 v34, v34, v12
  v_add_f32 v35, v35, v12
  v_max3_f32 v16, v36, v37, v16
  v_max3_f32 v16, v38, v39, v16
  v_max3_f32 v16, v40, v41, v16
  v_max3_f32 v16, v42, v43, v16
  v_mov_b32 v17, v16
  s_nop 1
  v_permlane16_swap_b32 v16, v17
  v_max_f32 v16, v16, v17
  v_mov_b32 v17, v16
  s_nop 1
  v_permlane32_swap_b32 v16, v17
  v_max_f32 v16, v16, v17
  v_sub_f32 v16, 0, v16
  v_mov_b32 v17, v16
  v_mov_b32 v18, v16
  v_mov_b32 v19, v16
  v_add_f32 v36, v36, v16
  v_add_f32 v37, v37, v16
  v_add_f32 v38, v38, v16
  v_add_f32 v39, v39, v16
  v_add_f32 v40, v40, v16
  v_add_f32 v41, v41, v16
  v_add_f32 v42, v42, v16
  v_add_f32 v43, v43, v16
  v_exp_f32 v20, v20
  s_nop 0
  v_add_f32 v5, v20, v5
  v_exp_f32 v21, v21
  s_nop 0
  v_add_f32 v5, v21, v5
  v_cvt_pk_bf16_f32 v20, v20, v21
  v_exp_f32 v22, v22
  s_nop 0
  v_add_f32 v5, v22, v5
  v_exp_f32 v23, v23
  s_nop 0
  v_add_f32 v5, v23, v5
  v_cvt_pk_bf16_f32 v21, v22, v23
  v_exp_f32 v24, v24
  s_nop 0
  v_add_f32 v5, v24, v5
  v_exp_f32 v25, v25
  s_nop 0
  v_add_f32 v5, v25, v5
  v_cvt_pk_bf16_f32 v22, v24, v25
  v_exp_f32 v26, v26
  s_nop 0
  v_add_f32 v5, v26, v5
  v_exp_f32 v27, v27
  s_nop 0
  v_add_f32 v5, v27, v5
  v_cvt_pk_bf16_f32 v23, v26, v27
  v_exp_f32 v28, v28
  s_nop 0
  v_add_f32 v6, v28, v6
  v_exp_f32 v29, v29
  s_nop 0
  v_add_f32 v6, v29, v6
  v_cvt_pk_bf16_f32 v28, v28, v29
  v_exp_f32 v30, v30
  s_nop 0
  v_add_f32 v6, v30, v6
  v_exp_f32 v31, v31
  s_nop 0
  v_add_f32 v6, v31, v6
  v_cvt_pk_bf16_f32 v29, v30, v31
  v_exp_f32 v32, v32
  s_nop 0
  v_add_f32 v6, v32, v6
  v_exp_f32 v33, v33
  s_nop 0
  v_add_f32 v6, v33, v6
  v_cvt_pk_bf16_f32 v30, v32, v33
  v_exp_f32 v34, v34
  s_nop 0
  v_add_f32 v6, v34, v6
  v_exp_f32 v35, v35
  s_nop 0
  v_add_f32 v6, v35, v6
  v_cvt_pk_bf16_f32 v31, v34, v35
  s_nop 1
.p2align 4
A_LOOP:
  s_waitcnt lgkmcnt(15)
  v_mfma_f32_16x16x32_bf16 a[0:3], v[76:79], v[20:23], a[0:3]
  v_mfma_f32_16x16x32_bf16 a[12:15], v[80:83], v[20:23], a[12:15]
  v_exp_f32 v36, v36
  v_mfma_f32_16x16x32_bf16 a[24:27], v[84:87], v[20:23], a[24:27]
  v_add_f32 v7, v36, v7
  v_mfma_f32_16x16x32_bf16 a[36:39], v[88:91], v[20:23], a[36:39]
  v_exp_f32 v37, v37
  s_waitcnt lgkmcnt(14)
  v_mfma_f32_16x16x32_bf16 a[48:51], v[92:95], v[20:23], a[48:51]
  v_add_f32 v7, v37, v7
  v_cvt_pk_bf16_f32 v36, v36, v37
  s_waitcnt lgkmcnt(12)
  v_mfma_f32_16x16x32_bf16 a[60:63], v[96:99], v[20:23], a[60:63]
  v_exp_f32 v38, v38
  s_waitcnt lgkmcnt(10)
  v_mfma_f32_16x16x32_bf16 a[72:75], v[100:103], v[20:23], a[72:75]
  v_add_f32 v7, v38, v7
  s_waitcnt lgkmcnt(8)
  v_mfma_f32_16x16x32_bf16 a[84:87], v[104:107], v[20:23], a[84:87]
  v_exp_f32 v39, v39
  s_waitcnt lgkmcnt(7)
  v_mfma_f32_16x16x32_bf16 v[20:23], v[44:47], a[96:99], v[8:11]
  v_add_f32 v7, v39, v7
  v_cvt_pk_bf16_f32 v37, v38, v39
  s_waitcnt lgkmcnt(6)
  v_mfma_f32_16x16x32_bf16 v[24:27], v[60:63], a[96:99], v[8:11]
  v_exp_f32 v40, v40
  s_waitcnt lgkmcnt(5)
  v_mfma_f32_16x16x32_bf16 v[20:23], v[48:51], a[100:103], v[20:23]
  v_add_f32 v7, v40, v7
  s_waitcnt lgkmcnt(4)
  v_mfma_f32_16x16x32_bf16 v[24:27], v[64:67], a[100:103], v[24:27]
  v_exp_f32 v41, v41
  s_waitcnt lgkmcnt(3)
  v_mfma_f32_16x16x32_bf16 v[20:23], v[52:55], a[104:107], v[20:23]
  v_add_f32 v7, v41, v7
  v_cvt_pk_bf16_f32 v38, v40, v41
  s_waitcnt lgkmcnt(2)
  v_mfma_f32_16x16x32_bf16 v[24:27], v[68:71], a[104:107], v[24:27]
  v_exp_f32 v42, v42
  s_waitcnt lgkmcnt(1)
  v_mfma_f32_16x16x32_bf16 v[20:23], v[56:59], a[108:111], v[20:23]
  v_add_f32 v7, v42, v7
  s_waitcnt lgkmcnt(0)
  v_mfma_f32_16x16x32_bf16 v[24:27], v[72:75], a[108:111], v[24:27]
  v_exp_f32 v43, v43
  s_waitcnt vmcnt(0)
  s_barrier
  v_mfma_f32_16x16x32_bf16 a[4:7], v[76:79], v[28:31], a[4:7]
  v_add_f32 v7, v43, v7
  v_cvt_pk_bf16_f32 v39, v42, v43
  v_mfma_f32_16x16x32_bf16 a[16:19], v[80:83], v[28:31], a[16:19]
  v_exp_f32 v20, v20
  v_mfma_f32_16x16x32_bf16 a[28:31], v[84:87], v[28:31], a[28:31]
  v_add_f32 v5, v20, v5
  v_mfma_f32_16x16x32_bf16 a[40:43], v[88:91], v[28:31], a[40:43]
  v_exp_f32 v21, v21
  v_mfma_f32_16x16x32_bf16 a[52:55], v[92:95], v[28:31], a[52:55]
  v_add_f32 v5, v21, v5
  v_cvt_pk_bf16_f32 v20, v20, v21
  v_mfma_f32_16x16x32_bf16 a[64:67], v[96:99], v[28:31], a[64:67]
  v_exp_f32 v22, v22
  v_mfma_f32_16x16x32_bf16 a[76:79], v[100:103], v[28:31], a[76:79]
  v_add_f32 v5, v22, v5
  s_add_u32 m0, s32, 49152
  v_mfma_f32_16x16x32_bf16 a[88:91], v[104:107], v[28:31], a[88:91]
  buffer_load_dwordx4 v4, s[12:15], s29 offen nt lds
  v_exp_f32 v23, v23
  v_mfma_f32_16x16x32_bf16 v[28:31], v[44:47], a[112:115], v[12:15]
  v_add_f32 v5, v23, v5
  v_cvt_pk_bf16_f32 v21, v22, v23
  v_mfma_f32_16x16x32_bf16 v[32:35], v[60:63], a[112:115], v[12:15]
  v_exp_f32 v24, v24
  v_mfma_f32_16x16x32_bf16 v[28:31], v[48:51], a[116:119], v[28:31]
  v_add_f32 v5, v24, v5
  v_mfma_f32_16x16x32_bf16 v[32:35], v[64:67], a[116:119], v[32:35]
  v_exp_f32 v25, v25
  v_mfma_f32_16x16x32_bf16 v[28:31], v[52:55], a[120:123], v[28:31]
  v_add_f32 v5, v25, v5
  v_cvt_pk_bf16_f32 v22, v24, v25
  v_mfma_f32_16x16x32_bf16 v[32:35], v[68:71], a[120:123], v[32:35]
  buffer_load_dwordx4 v0, s[12:15], s29 offen offset:1024 nt lds
  v_exp_f32 v26, v26
  v_mfma_f32_16x16x32_bf16 v[28:31], v[56:59], a[124:127], v[28:31]
  v_add_f32 v5, v26, v5
  v_mfma_f32_16x16x32_bf16 v[32:35], v[72:75], a[124:127], v[32:35]
  v_exp_f32 v27, v27
  v_mfma_f32_16x16x32_bf16 a[8:11], v[76:79], v[36:39], a[8:11]
  v_add_f32 v5, v27, v5
  v_cvt_pk_bf16_f32 v23, v26, v27
  ds_read_b64_tr_b16 v[76:77], v2 offset:40960
  ds_read_b64_tr_b16 v[78:79], v2 offset:45056
  v_mfma_f32_16x16x32_bf16 a[20:23], v[80:83], v[36:39], a[20:23]
  v_exp_f32 v28, v28
  s_nop 0
  v_add_f32 v6, v28, v6
  ds_read_b64_tr_b16 v[80:81], v3 offset:40960
  ds_read_b64_tr_b16 v[82:83], v3 offset:45056
  v_mfma_f32_16x16x32_bf16 a[32:35], v[84:87], v[36:39], a[32:35]
  v_exp_f32 v29, v29
  ds_read_b64_tr_b16 v[84:85], v2 offset:41216
  ds_read_b64_tr_b16 v[86:87], v2 offset:45312
  s_add_u32 m0, s32, 24576
  v_mfma_f32_16x16x32_bf16 a[44:47], v[88:91], v[36:39], a[44:47]
  buffer_load_dwordx4 v4, s[8:11], s28 offen nt lds
  v_add_f32 v6, v29, v6
  v_cvt_pk_bf16_f32 v28, v28, v29
  ds_read_b64_tr_b16 v[88:89], v3 offset:41216
  ds_read_b64_tr_b16 v[90:91], v3 offset:45312
  v_mfma_f32_16x16x32_bf16 a[56:59], v[92:95], v[36:39], a[56:59]
  v_exp_f32 v30, v30
  ds_read_b64_tr_b16 v[92:93], v2 offset:41472
  ds_read_b64_tr_b16 v[94:95], v2 offset:45568
  v_mfma_f32_16x16x32_bf16 a[68:71], v[96:99], v[36:39], a[68:71]
  v_add_f32 v6, v30, v6
  ds_read_b64_tr_b16 v[96:97], v3 offset:41472
  ds_read_b64_tr_b16 v[98:99], v3 offset:45568
  v_mfma_f32_16x16x32_bf16 a[80:83], v[100:103], v[36:39], a[80:83]
  v_exp_f32 v31, v31
  ds_read_b64_tr_b16 v[100:101], v2 offset:41728
  ds_read_b64_tr_b16 v[102:103], v2 offset:45824
  v_mfma_f32_16x16x32_bf16 a[92:95], v[104:107], v[36:39], a[92:95]
  v_add_f32 v6, v31, v6
  v_cvt_pk_bf16_f32 v29, v30, v31
  ds_read_b64_tr_b16 v[104:105], v3 offset:41728
  ds_read_b64_tr_b16 v[106:107], v3 offset:45824
  v_mfma_f32_16x16x32_bf16 v[36:39], v[44:47], a[128:131], v[16:19]
  v_exp_f32 v32, v32
  ds_read_b128 v[44:47], v1 offset:16384
  v_mfma_f32_16x16x32_bf16 v[40:43], v[60:63], a[128:131], v[16:19]
  buffer_load_dwordx4 v0, s[8:11], s28 offen offset:1024 nt lds
  v_add_f32 v6, v32, v6
  ds_read_b128 v[60:63], v1 offset:20480
  v_mfma_f32_16x16x32_bf16 v[36:39], v[48:51], a[132:135], v[36:39]
  v_exp_f32 v33, v33
  ds_read_b128 v[48:51], v1 offset:16640
  v_mfma_f32_16x16x32_bf16 v[40:43], v[64:67], a[132:135], v[40:43]
  v_add_f32 v6, v33, v6
  v_cvt_pk_bf16_f32 v30, v32, v33
  ds_read_b128 v[64:67], v1 offset:20736
  v_mfma_f32_16x16x32_bf16 v[36:39], v[52:55], a[136:139], v[36:39]
  v_exp_f32 v34, v34
  ds_read_b128 v[52:55], v1 offset:16896
  v_mfma_f32_16x16x32_bf16 v[40:43], v[68:71], a[136:139], v[40:43]
  v_add_f32 v6, v34, v6
  ds_read_b128 v[68:71], v1 offset:20992
  v_mfma_f32_16x16x32_bf16 v[36:39], v[56:59], a[140:143], v[36:39]
  v_exp_f32 v35, v35
  ds_read_b128 v[56:59], v1 offset:17152
  v_mfma_f32_16x16x32_bf16 v[40:43], v[72:75], a[140:143], v[40:43]
  v_add_f32 v6, v35, v6
  v_cvt_pk_bf16_f32 v31, v34, v35
  ds_read_b128 v[72:75], v1 offset:21248
  s_mov_b32 s29, s28
  s_add_u32 s28, s28, 8192
  s_and_b32 s28, s28, 0x3ffff
  s_waitcnt lgkmcnt(15)
  v_mfma_f32_16x16x32_bf16 a[0:3], v[76:79], v[20:23], a[0:3]
  v_mfma_f32_16x16x32_bf16 a[12:15], v[80:83], v[20:23], a[12:15]
  v_exp_f32 v36, v36
  v_mfma_f32_16x16x32_bf16 a[24:27], v[84:87], v[20:23], a[24:27]
  v_add_f32 v7, v36, v7
  v_mfma_f32_16x16x32_bf16 a[36:39], v[88:91], v[20:23], a[36:39]
  v_exp_f32 v37, v37
  s_waitcnt lgkmcnt(14)
  v_mfma_f32_16x16x32_bf16 a[48:51], v[92:95], v[20:23], a[48:51]
  v_add_f32 v7, v37, v7
  v_cvt_pk_bf16_f32 v36, v36, v37
  s_waitcnt lgkmcnt(12)
  v_mfma_f32_16x16x32_bf16 a[60:63], v[96:99], v[20:23], a[60:63]
  v_exp_f32 v38, v38
  s_waitcnt lgkmcnt(10)
  v_mfma_f32_16x16x32_bf16 a[72:75], v[100:103], v[20:23], a[72:75]
  v_add_f32 v7, v38, v7
  s_waitcnt lgkmcnt(8)
  v_mfma_f32_16x16x32_bf16 a[84:87], v[104:107], v[20:23], a[84:87]
  v_exp_f32 v39, v39
  s_waitcnt lgkmcnt(7)
  v_mfma_f32_16x16x32_bf16 v[20:23], v[44:47], a[96:99], v[8:11]
  v_add_f32 v7, v39, v7
  v_cvt_pk_bf16_f32 v37, v38, v39
  s_waitcnt lgkmcnt(6)
  v_mfma_f32_16x16x32_bf16 v[24:27], v[60:63], a[96:99], v[8:11]
  v_exp_f32 v40, v40
  s_waitcnt lgkmcnt(5)
  v_mfma_f32_16x16x32_bf16 v[20:23], v[48:51], a[100:103], v[20:23]
  v_add_f32 v7, v40, v7
  s_waitcnt lgkmcnt(4)
  v_mfma_f32_16x16x32_bf16 v[24:27], v[64:67], a[100:103], v[24:27]
  v_exp_f32 v41, v41
  s_waitcnt lgkmcnt(3)
  v_mfma_f32_16x16x32_bf16 v[20:23], v[52:55], a[104:107], v[20:23]
  v_add_f32 v7, v41, v7
  v_cvt_pk_bf16_f32 v38, v40, v41
  s_waitcnt lgkmcnt(2)
  v_mfma_f32_16x16x32_bf16 v[24:27], v[68:71], a[104:107], v[24:27]
  v_exp_f32 v42, v42
  s_waitcnt lgkmcnt(1)
  v_mfma_f32_16x16x32_bf16 v[20:23], v[56:59], a[108:111], v[20:23]
  v_add_f32 v7, v42, v7
  s_waitcnt lgkmcnt(0)
  v_mfma_f32_16x16x32_bf16 v[24:27], v[72:75], a[108:111], v[24:27]
  v_exp_f32 v43, v43
  s_waitcnt vmcnt(0)
  s_barrier
  v_mfma_f32_16x16x32_bf16 a[4:7], v[76:79], v[28:31], a[4:7]
  v_add_f32 v7, v43, v7
  v_cvt_pk_bf16_f32 v39, v42, v43
  v_mfma_f32_16x16x32_bf16 a[16:19], v[80:83], v[28:31], a[16:19]
  v_exp_f32 v20, v20
  v_mfma_f32_16x16x32_bf16 a[28:31], v[84:87], v[28:31], a[28:31]
  v_add_f32 v5, v20, v5
  v_mfma_f32_16x16x32_bf16 a[40:43], v[88:91], v[28:31], a[40:43]
  v_exp_f32 v21, v21
  v_mfma_f32_16x16x32_bf16 a[52:55], v[92:95], v[28:31], a[52:55]
  v_add_f32 v5, v21, v5
  v_cvt_pk_bf16_f32 v20, v20, v21
  v_mfma_f32_16x16x32_bf16 a[64:67], v[96:99], v[28:31], a[64:67]
  v_exp_f32 v22, v22
  v_mfma_f32_16x16x32_bf16 a[76:79], v[100:103], v[28:31], a[76:79]
  v_add_f32 v5, v22, v5
  s_add_u32 m0, s32, 57344
  v_mfma_f32_16x16x32_bf16 a[88:91], v[104:107], v[28:31], a[88:91]
  buffer_load_dwordx4 v4, s[12:15], s29 offen nt lds
  v_exp_f32 v23, v23
  v_mfma_f32_16x16x32_bf16 v[28:31], v[44:47], a[112:115], v[12:15]
  v_add_f32 v5, v23, v5
  v_cvt_pk_bf16_f32 v21, v22, v23
  v_mfma_f32_16x16x32_bf16 v[32:35], v[60:63], a[112:115], v[12:15]
  v_exp_f32 v24, v24
  v_mfma_f32_16x16x32_bf16 v[28:31], v[48:51], a[116:119], v[28:31]
  v_add_f32 v5, v24, v5
  v_mfma_f32_16x16x32_bf16 v[32:35], v[64:67], a[116:119], v[32:35]
  v_exp_f32 v25, v25
  v_mfma_f32_16x16x32_bf16 v[28:31], v[52:55], a[120:123], v[28:31]
  v_add_f32 v5, v25, v5
  v_cvt_pk_bf16_f32 v22, v24, v25
  v_mfma_f32_16x16x32_bf16 v[32:35], v[68:71], a[120:123], v[32:35]
  buffer_load_dwordx4 v0, s[12:15], s29 offen offset:1024 nt lds
  v_exp_f32 v26, v26
  v_mfma_f32_16x16x32_bf16 v[28:31], v[56:59], a[124:127], v[28:31]
  v_add_f32 v5, v26, v5
  v_mfma_f32_16x16x32_bf16 v[32:35], v[72:75], a[124:127], v[32:35]
  v_exp_f32 v27, v27
  v_mfma_f32_16x16x32_bf16 a[8:11], v[76:79], v[36:39], a[8:11]
  v_add_f32 v5, v27, v5
  v_cvt_pk_bf16_f32 v23, v26, v27
  ds_read_b64_tr_b16 v[76:77], v2 offset:49152
  ds_read_b64_tr_b16 v[78:79], v2 offset:53248
  v_mfma_f32_16x16x32_bf16 a[20:23], v[80:83], v[36:39], a[20:23]
  v_exp_f32 v28, v28
  s_nop 0
  v_add_f32 v6, v28, v6
  ds_read_b64_tr_b16 v[80:81], v3 offset:49152
  ds_read_b64_tr_b16 v[82:83], v3 offset:53248
  v_mfma_f32_16x16x32_bf16 a[32:35], v[84:87], v[36:39], a[32:35]
  v_exp_f32 v29, v29
  ds_read_b64_tr_b16 v[84:85], v2 offset:49408
  ds_read_b64_tr_b16 v[86:87], v2 offset:53504
  s_add_u32 m0, s32, 0
  v_mfma_f32_16x16x32_bf16 a[44:47], v[88:91], v[36:39], a[44:47]
  buffer_load_dwordx4 v4, s[8:11], s28 offen nt lds
  v_add_f32 v6, v29, v6
  v_cvt_pk_bf16_f32 v28, v28, v29
  ds_read_b64_tr_b16 v[88:89], v3 offset:49408
  ds_read_b64_tr_b16 v[90:91], v3 offset:53504
  v_mfma_f32_16x16x32_bf16 a[56:59], v[92:95], v[36:39], a[56:59]
  v_exp_f32 v30, v30
  ds_read_b64_tr_b16 v[92:93], v2 offset:49664
  ds_read_b64_tr_b16 v[94:95], v2 offset:53760
  v_mfma_f32_16x16x32_bf16 a[68:71], v[96:99], v[36:39], a[68:71]
  v_add_f32 v6, v30, v6
  ds_read_b64_tr_b16 v[96:97], v3 offset:49664
  ds_read_b64_tr_b16 v[98:99], v3 offset:53760
  v_mfma_f32_16x16x32_bf16 a[80:83], v[100:103], v[36:39], a[80:83]
  v_exp_f32 v31, v31
  ds_read_b64_tr_b16 v[100:101], v2 offset:49920
  ds_read_b64_tr_b16 v[102:103], v2 offset:54016
  v_mfma_f32_16x16x32_bf16 a[92:95], v[104:107], v[36:39], a[92:95]
  v_add_f32 v6, v31, v6
  v_cvt_pk_bf16_f32 v29, v30, v31
  ds_read_b64_tr_b16 v[104:105], v3 offset:49920
  ds_read_b64_tr_b16 v[106:107], v3 offset:54016
  v_mfma_f32_16x16x32_bf16 v[36:39], v[44:47], a[128:131], v[16:19]
  v_exp_f32 v32, v32
  ds_read_b128 v[44:47], v1 offset:24576
  v_mfma_f32_16x16x32_bf16 v[40:43], v[60:63], a[128:131], v[16:19]
  buffer_load_dwordx4 v0, s[8:11], s28 offen offset:1024 nt lds
  v_add_f32 v6, v32, v6
  ds_read_b128 v[60:63], v1 offset:28672
  v_mfma_f32_16x16x32_bf16 v[36:39], v[48:51], a[132:135], v[36:39]
  v_exp_f32 v33, v33
  ds_read_b128 v[48:51], v1 offset:24832
  v_mfma_f32_16x16x32_bf16 v[40:43], v[64:67], a[132:135], v[40:43]
  v_add_f32 v6, v33, v6
  v_cvt_pk_bf16_f32 v30, v32, v33
  ds_read_b128 v[64:67], v1 offset:28928
  v_mfma_f32_16x16x32_bf16 v[36:39], v[52:55], a[136:139], v[36:39]
  v_exp_f32 v34, v34
  ds_read_b128 v[52:55], v1 offset:25088
  v_mfma_f32_16x16x32_bf16 v[40:43], v[68:71], a[136:139], v[40:43]
  v_add_f32 v6, v34, v6
  ds_read_b128 v[68:71], v1 offset:29184
  v_mfma_f32_16x16x32_bf16 v[36:39], v[56:59], a[140:143], v[36:39]
  v_exp_f32 v35, v35
  ds_read_b128 v[56:59], v1 offset:25344
  v_mfma_f32_16x16x32_bf16 v[40:43], v[72:75], a[140:143], v[40:43]
  v_add_f32 v6, v35, v6
  v_cvt_pk_bf16_f32 v31, v34, v35
  ds_read_b128 v[72:75], v1 offset:29440
  s_mov_b32 s29, s28
  s_add_u32 s28, s28, 8192
  s_and_b32 s28, s28, 0x3ffff
  s_waitcnt lgkmcnt(15)
  v_mfma_f32_16x16x32_bf16 a[0:3], v[76:79], v[20:23], a[0:3]
  v_mfma_f32_16x16x32_bf16 a[12:15], v[80:83], v[20:23], a[12:15]
  v_exp_f32 v36, v36
  v_mfma_f32_16x16x32_bf16 a[24:27], v[84:87], v[20:23], a[24:27]
  v_add_f32 v7, v36, v7
  v_mfma_f32_16x16x32_bf16 a[36:39], v[88:91], v[20:23], a[36:39]
  v_exp_f32 v37, v37
  s_waitcnt lgkmcnt(14)
  v_mfma_f32_16x16x32_bf16 a[48:51], v[92:95], v[20:23], a[48:51]
  v_add_f32 v7, v37, v7
  v_cvt_pk_bf16_f32 v36, v36, v37
  s_waitcnt lgkmcnt(12)
  v_mfma_f32_16x16x32_bf16 a[60:63], v[96:99], v[20:23], a[60:63]
  v_exp_f32 v38, v38
  s_waitcnt lgkmcnt(10)
  v_mfma_f32_16x16x32_bf16 a[72:75], v[100:103], v[20:23], a[72:75]
  v_add_f32 v7, v38, v7
  s_waitcnt lgkmcnt(8)
  v_mfma_f32_16x16x32_bf16 a[84:87], v[104:107], v[20:23], a[84:87]
  v_exp_f32 v39, v39
  s_waitcnt lgkmcnt(7)
  v_mfma_f32_16x16x32_bf16 v[20:23], v[44:47], a[96:99], v[8:11]
  v_add_f32 v7, v39, v7
  v_cvt_pk_bf16_f32 v37, v38, v39
  s_waitcnt lgkmcnt(6)
  v_mfma_f32_16x16x32_bf16 v[24:27], v[60:63], a[96:99], v[8:11]
  v_exp_f32 v40, v40
  s_waitcnt lgkmcnt(5)
  v_mfma_f32_16x16x32_bf16 v[20:23], v[48:51], a[100:103], v[20:23]
  v_add_f32 v7, v40, v7
  s_waitcnt lgkmcnt(4)
  v_mfma_f32_16x16x32_bf16 v[24:27], v[64:67], a[100:103], v[24:27]
  v_exp_f32 v41, v41
  s_waitcnt lgkmcnt(3)
  v_mfma_f32_16x16x32_bf16 v[20:23], v[52:55], a[104:107], v[20:23]
  v_add_f32 v7, v41, v7
  v_cvt_pk_bf16_f32 v38, v40, v41
  s_waitcnt lgkmcnt(2)
  v_mfma_f32_16x16x32_bf16 v[24:27], v[68:71], a[104:107], v[24:27]
  v_exp_f32 v42, v42
  s_waitcnt lgkmcnt(1)
  v_mfma_f32_16x16x32_bf16 v[20:23], v[56:59], a[108:111], v[20:23]
  v_add_f32 v7, v42, v7
  s_waitcnt lgkmcnt(0)
  v_mfma_f32_16x16x32_bf16 v[24:27], v[72:75], a[108:111], v[24:27]
  v_exp_f32 v43, v43
  s_waitcnt vmcnt(0)
  s_barrier
  v_mfma_f32_16x16x32_bf16 a[4:7], v[76:79], v[28:31], a[4:7]
  v_add_f32 v7, v43, v7
  v_cvt_pk_bf16_f32 v39, v42, v43
  v_mfma_f32_16x16x32_bf16 a[16:19], v[80:83], v[28:31], a[16:19]
  v_exp_f32 v20, v20
  v_mfma_f32_16x16x32_bf16 a[28:31], v[84:87], v[28:31], a[28:31]
  v_add_f32 v5, v20, v5
  v_mfma_f32_16x16x32_bf16 a[40:43], v[88:91], v[28:31], a[40:43]
  v_exp_f32 v21, v21
  v_mfma_f32_16x16x32_bf16 a[52:55], v[92:95], v[28:31], a[52:55]
  v_add_f32 v5, v21, v5
  v_cvt_pk_bf16_f32 v20, v20, v21
  v_mfma_f32_16x16x32_bf16 a[64:67], v[96:99], v[28:31], a[64:67]
  v_exp_f32 v22, v22
  v_mfma_f32_16x16x32_bf16 a[76:79], v[100:103], v[28:31], a[76:79]
  v_add_f32 v5, v22, v5
  s_add_u32 m0, s32, 32768
  v_mfma_f32_16x16x32_bf16 a[88:91], v[104:107], v[28:31], a[88:91]
  buffer_load_dwordx4 v4, s[12:15], s29 offen nt lds
  v_exp_f32 v23, v23
  v_mfma_f32_16x16x32_bf16 v[28:31], v[44:47], a[112:115], v[12:15]
  v_add_f32 v5, v23, v5
  v_cvt_pk_bf16_f32 v21, v22, v23
  v_mfma_f32_16x16x32_bf16 v[32:35], v[60:63], a[112:115], v[12:15]
  v_exp_f32 v24, v24
  v_mfma_f32_16x16x32_bf16 v[28:31], v[48:51], a[116:119], v[28:31]
  v_add_f32 v5, v24, v5
  v_mfma_f32_16x16x32_bf16 v[32:35], v[64:67], a[116:119], v[32:35]
  v_exp_f32 v25, v25
  v_mfma_f32_16x16x32_bf16 v[28:31], v[52:55], a[120:123], v[28:31]
  v_add_f32 v5, v25, v5
  v_cvt_pk_bf16_f32 v22, v24, v25
  v_mfma_f32_16x16x32_bf16 v[32:35], v[68:71], a[120:123], v[32:35]
  buffer_load_dwordx4 v0, s[12:15], s29 offen offset:1024 nt lds
  v_exp_f32 v26, v26
  v_mfma_f32_16x16x32_bf16 v[28:31], v[56:59], a[124:127], v[28:31]
  v_add_f32 v5, v26, v5
  v_mfma_f32_16x16x32_bf16 v[32:35], v[72:75], a[124:127], v[32:35]
  v_exp_f32 v27, v27
  v_mfma_f32_16x16x32_bf16 a[8:11], v[76:79], v[36:39], a[8:11]
  v_add_f32 v5, v27, v5
  v_cvt_pk_bf16_f32 v23, v26, v27
  ds_read_b64_tr_b16 v[76:77], v2 offset:57344
  ds_read_b64_tr_b16 v[78:79], v2 offset:61440
  v_mfma_f32_16x16x32_bf16 a[20:23], v[80:83], v[36:39], a[20:23]
  v_exp_f32 v28, v28
  s_nop 0
  v_add_f32 v6, v28, v6
  ds_read_b64_tr_b16 v[80:81], v3 offset:57344
  ds_read_b64_tr_b16 v[82:83], v3 offset:61440
  v_mfma_f32_16x16x32_bf16 a[32:35], v[84:87], v[36:39], a[32:35]
  v_exp_f32 v29, v29
  ds_read_b64_tr_b16 v[84:85], v2 offset:57600
  ds_read_b64_tr_b16 v[86:87], v2 offset:61696
  s_add_u32 m0, s32, 8192
  v_mfma_f32_16x16x32_bf16 a[44:47], v[88:91], v[36:39], a[44:47]
  buffer_load_dwordx4 v4, s[8:11], s28 offen nt lds
  v_add_f32 v6, v29, v6
  v_cvt_pk_bf16_f32 v28, v28, v29
  ds_read_b64_tr_b16 v[88:89], v3 offset:57600
  ds_read_b64_tr_b16 v[90:91], v3 offset:61696
  v_mfma_f32_16x16x32_bf16 a[56:59], v[92:95], v[36:39], a[56:59]
  v_exp_f32 v30, v30
  ds_read_b64_tr_b16 v[92:93], v2 offset:57856
  ds_read_b64_tr_b16 v[94:95], v2 offset:61952
  v_mfma_f32_16x16x32_bf16 a[68:71], v[96:99], v[36:39], a[68:71]
  v_add_f32 v6, v30, v6
  ds_read_b64_tr_b16 v[96:97], v3 offset:57856
  ds_read_b64_tr_b16 v[98:99], v3 offset:61952
  v_mfma_f32_16x16x32_bf16 a[80:83], v[100:103], v[36:39], a[80:83]
  v_exp_f32 v31, v31
  ds_read_b64_tr_b16 v[100:101], v2 offset:58112
  ds_read_b64_tr_b16 v[102:103], v2 offset:62208
  v_mfma_f32_16x16x32_bf16 a[92:95], v[104:107], v[36:39], a[92:95]
  v_add_f32 v6, v31, v6
  v_cvt_pk_bf16_f32 v29, v30, v31
  ds_read_b64_tr_b16 v[104:105], v3 offset:58112
  ds_read_b64_tr_b16 v[106:107], v3 offset:62208
  v_mfma_f32_16x16x32_bf16 v[36:39], v[44:47], a[128:131], v[16:19]
  v_exp_f32 v32, v32
  ds_read_b128 v[44:47], v1 offset:0
  v_mfma_f32_16x16x32_bf16 v[40:43], v[60:63], a[128:131], v[16:19]
  buffer_load_dwordx4 v0, s[8:11], s28 offen offset:1024 nt lds
  v_add_f32 v6, v32, v6
  ds_read_b128 v[60:63], v1 offset:4096
  v_mfma_f32_16x16x32_bf16 v[36:39], v[48:51], a[132:135], v[36:39]
  v_exp_f32 v33, v33
  ds_read_b128 v[48:51], v1 offset:256
  v_mfma_f32_16x16x32_bf16 v[40:43], v[64:67], a[132:135], v[40:43]
  v_add_f32 v6, v33, v6
  v_cvt_pk_bf16_f32 v30, v32, v33
  ds_read_b128 v[64:67], v1 offset:4352
  v_mfma_f32_16x16x32_bf16 v[36:39], v[52:55], a[136:139], v[36:39]
  v_exp_f32 v34, v34
  ds_read_b128 v[52:55], v1 offset:512
  v_mfma_f32_16x16x32_bf16 v[40:43], v[68:71], a[136:139], v[40:43]
  v_add_f32 v6, v34, v6
  ds_read_b128 v[68:71], v1 offset:4608
  v_mfma_f32_16x16x32_bf16 v[36:39], v[56:59], a[140:143], v[36:39]
  v_exp_f32 v35, v35
  ds_read_b128 v[56:59], v1 offset:768
  v_mfma_f32_16x16x32_bf16 v[40:43], v[72:75], a[140:143], v[40:43]
  v_add_f32 v6, v35, v6
  v_cvt_pk_bf16_f32 v31, v34, v35
  ds_read_b128 v[72:75], v1 offset:4864
  s_mov_b32 s29, s28
  s_add_u32 s28, s28, 8192
  s_and_b32 s28, s28, 0x3ffff
  s_waitcnt lgkmcnt(15)
  v_mfma_f32_16x16x32_bf16 a[0:3], v[76:79], v[20:23], a[0:3]
  v_mfma_f32_16x16x32_bf16 a[12:15], v[80:83], v[20:23], a[12:15]
  v_exp_f32 v36, v36
  v_mfma_f32_16x16x32_bf16 a[24:27], v[84:87], v[20:23], a[24:27]
  v_add_f32 v7, v36, v7
  v_mfma_f32_16x16x32_bf16 a[36:39], v[88:91], v[20:23], a[36:39]
  v_exp_f32 v37, v37
  s_waitcnt lgkmcnt(14)
  v_mfma_f32_16x16x32_bf16 a[48:51], v[92:95], v[20:23], a[48:51]
  v_add_f32 v7, v37, v7
  v_cvt_pk_bf16_f32 v36, v36, v37
  s_waitcnt lgkmcnt(12)
  v_mfma_f32_16x16x32_bf16 a[60:63], v[96:99], v[20:23], a[60:63]
  v_exp_f32 v38, v38
  s_waitcnt lgkmcnt(10)
  v_mfma_f32_16x16x32_bf16 a[72:75], v[100:103], v[20:23], a[72:75]
  v_add_f32 v7, v38, v7
  s_waitcnt lgkmcnt(8)
  v_mfma_f32_16x16x32_bf16 a[84:87], v[104:107], v[20:23], a[84:87]
  v_exp_f32 v39, v39
  s_waitcnt lgkmcnt(7)
  v_mfma_f32_16x16x32_bf16 v[20:23], v[44:47], a[96:99], v[8:11]
  v_add_f32 v7, v39, v7
  v_cvt_pk_bf16_f32 v37, v38, v39
  s_waitcnt lgkmcnt(6)
  v_mfma_f32_16x16x32_bf16 v[24:27], v[60:63], a[96:99], v[8:11]
  v_exp_f32 v40, v40
  s_waitcnt lgkmcnt(5)
  v_mfma_f32_16x16x32_bf16 v[20:23], v[48:51], a[100:103], v[20:23]
  v_add_f32 v7, v40, v7
  s_waitcnt lgkmcnt(4)
  v_mfma_f32_16x16x32_bf16 v[24:27], v[64:67], a[100:103], v[24:27]
  v_exp_f32 v41, v41
  s_waitcnt lgkmcnt(3)
  v_mfma_f32_16x16x32_bf16 v[20:23], v[52:55], a[104:107], v[20:23]
  v_add_f32 v7, v41, v7
  v_cvt_pk_bf16_f32 v38, v40, v41
  s_waitcnt lgkmcnt(2)
  v_mfma_f32_16x16x32_bf16 v[24:27], v[68:71], a[104:107], v[24:27]
  v_exp_f32 v42, v42
  s_waitcnt lgkmcnt(1)
  v_mfma_f32_16x16x32_bf16 v[20:23], v[56:59], a[108:111], v[20:23]
  v_add_f32 v7, v42, v7
  s_waitcnt lgkmcnt(0)
  v_mfma_f32_16x16x32_bf16 v[24:27], v[72:75], a[108:111], v[24:27]
  v_exp_f32 v43, v43
  s_waitcnt vmcnt(0)
  s_barrier
  v_mfma_f32_16x16x32_bf16 a[4:7], v[76:79], v[28:31], a[4:7]
  v_add_f32 v7, v43, v7
  v_cvt_pk_bf16_f32 v39, v42, v43
  v_mfma_f32_16x16x32_bf16 a[16:19], v[80:83], v[28:31], a[16:19]
  v_exp_f32 v20, v20
  v_mfma_f32_16x16x32_bf16 a[28:31], v[84:87], v[28:31], a[28:31]
  v_add_f32 v5, v20, v5
  v_mfma_f32_16x16x32_bf16 a[40:43], v[88:91], v[28:31], a[40:43]
  v_exp_f32 v21, v21
  v_mfma_f32_16x16x32_bf16 a[52:55], v[92:95], v[28:31], a[52:55]
  v_add_f32 v5, v21, v5
  v_cvt_pk_bf16_f32 v20, v20, v21
  v_mfma_f32_16x16x32_bf16 a[64:67], v[96:99], v[28:31], a[64:67]
  v_exp_f32 v22, v22
  v_mfma_f32_16x16x32_bf16 a[76:79], v[100:103], v[28:31], a[76:79]
  v_add_f32 v5, v22, v5
  s_add_u32 m0, s32, 40960
  v_mfma_f32_16x16x32_bf16 a[88:91], v[104:107], v[28:31], a[88:91]
  buffer_load_dwordx4 v4, s[12:15], s29 offen nt lds
  v_exp_f32 v23, v23
  v_mfma_f32_16x16x32_bf16 v[28:31], v[44:47], a[112:115], v[12:15]
  v_add_f32 v5, v23, v5
  v_cvt_pk_bf16_f32 v21, v22, v23
  v_mfma_f32_16x16x32_bf16 v[32:35], v[60:63], a[112:115], v[12:15]
  v_exp_f32 v24, v24
  v_mfma_f32_16x16x32_bf16 v[28:31], v[48:51], a[116:119], v[28:31]
  v_add_f32 v5, v24, v5
  v_mfma_f32_16x16x32_bf16 v[32:35], v[64:67], a[116:119], v[32:35]
  v_exp_f32 v25, v25
  v_mfma_f32_16x16x32_bf16 v[28:31], v[52:55], a[120:123], v[28:31]
  v_add_f32 v5, v25, v5
  v_cvt_pk_bf16_f32 v22, v24, v25
  v_mfma_f32_16x16x32_bf16 v[32:35], v[68:71], a[120:123], v[32:35]
  buffer_load_dwordx4 v0, s[12:15], s29 offen offset:1024 nt lds
  v_exp_f32 v26, v26
  v_mfma_f32_16x16x32_bf16 v[28:31], v[56:59], a[124:127], v[28:31]
  v_add_f32 v5, v26, v5
  v_mfma_f32_16x16x32_bf16 v[32:35], v[72:75], a[124:127], v[32:35]
  v_exp_f32 v27, v27
  v_mfma_f32_16x16x32_bf16 a[8:11], v[76:79], v[36:39], a[8:11]
  v_add_f32 v5, v27, v5
  v_cvt_pk_bf16_f32 v23, v26, v27
  ds_read_b64_tr_b16 v[76:77], v2 offset:32768
  ds_read_b64_tr_b16 v[78:79], v2 offset:36864
  v_mfma_f32_16x16x32_bf16 a[20:23], v[80:83], v[36:39], a[20:23]
  v_exp_f32 v28, v28
  s_nop 0
  v_add_f32 v6, v28, v6
  ds_read_b64_tr_b16 v[80:81], v3 offset:32768
  ds_read_b64_tr_b16 v[82:83], v3 offset:36864
  v_mfma_f32_16x16x32_bf16 a[32:35], v[84:87], v[36:39], a[32:35]
  v_exp_f32 v29, v29
  ds_read_b64_tr_b16 v[84:85], v2 offset:33024
  ds_read_b64_tr_b16 v[86:87], v2 offset:37120
  s_add_u32 m0, s32, 16384
  v_mfma_f32_16x16x32_bf16 a[44:47], v[88:91], v[36:39], a[44:47]
  buffer_load_dwordx4 v4, s[8:11], s28 offen nt lds
  v_add_f32 v6, v29, v6
  v_cvt_pk_bf16_f32 v28, v28, v29
  ds_read_b64_tr_b16 v[88:89], v3 offset:33024
  ds_read_b64_tr_b16 v[90:91], v3 offset:37120
  v_mfma_f32_16x16x32_bf16 a[56:59], v[92:95], v[36:39], a[56:59]
  v_exp_f32 v30, v30
  ds_read_b64_tr_b16 v[92:93], v2 offset:33280
  ds_read_b64_tr_b16 v[94:95], v2 offset:37376
  v_mfma_f32_16x16x32_bf16 a[68:71], v[96:99], v[36:39], a[68:71]
  v_add_f32 v6, v30, v6
  ds_read_b64_tr_b16 v[96:97], v3 offset:33280
  ds_read_b64_tr_b16 v[98:99], v3 offset:37376
  v_mfma_f32_16x16x32_bf16 a[80:83], v[100:103], v[36:39], a[80:83]
  v_exp_f32 v31, v31
  ds_read_b64_tr_b16 v[100:101], v2 offset:33536
  ds_read_b64_tr_b16 v[102:103], v2 offset:37632
  v_mfma_f32_16x16x32_bf16 a[92:95], v[104:107], v[36:39], a[92:95]
  v_add_f32 v6, v31, v6
  v_cvt_pk_bf16_f32 v29, v30, v31
  ds_read_b64_tr_b16 v[104:105], v3 offset:33536
  ds_read_b64_tr_b16 v[106:107], v3 offset:37632
  v_mfma_f32_16x16x32_bf16 v[36:39], v[44:47], a[128:131], v[16:19]
  v_exp_f32 v32, v32
  ds_read_b128 v[44:47], v1 offset:8192
  v_mfma_f32_16x16x32_bf16 v[40:43], v[60:63], a[128:131], v[16:19]
  buffer_load_dwordx4 v0, s[8:11], s28 offen offset:1024 nt lds
  v_add_f32 v6, v32, v6
  ds_read_b128 v[60:63], v1 offset:12288
  v_mfma_f32_16x16x32_bf16 v[36:39], v[48:51], a[132:135], v[36:39]
  v_exp_f32 v33, v33
  ds_read_b128 v[48:51], v1 offset:8448
  v_mfma_f32_16x16x32_bf16 v[40:43], v[64:67], a[132:135], v[40:43]
  v_add_f32 v6, v33, v6
  v_cvt_pk_bf16_f32 v30, v32, v33
  ds_read_b128 v[64:67], v1 offset:12544
  v_mfma_f32_16x16x32_bf16 v[36:39], v[52:55], a[136:139], v[36:39]
  v_exp_f32 v34, v34
  ds_read_b128 v[52:55], v1 offset:8704
  v_mfma_f32_16x16x32_bf16 v[40:43], v[68:71], a[136:139], v[40:43]
  v_add_f32 v6, v34, v6
  ds_read_b128 v[68:71], v1 offset:12800
  v_mfma_f32_16x16x32_bf16 v[36:39], v[56:59], a[140:143], v[36:39]
  v_exp_f32 v35, v35
  ds_read_b128 v[56:59], v1 offset:8960
  v_mfma_f32_16x16x32_bf16 v[40:43], v[72:75], a[140:143], v[40:43]
  v_add_f32 v6, v35, v6
  v_cvt_pk_bf16_f32 v31, v34, v35
  ds_read_b128 v[72:75], v1 offset:13056
  s_mov_b32 s29, s28
  s_add_u32 s28, s28, 8192
  s_and_b32 s28, s28, 0x3ffff
  s_sub_u32 s30, s30, 1
  s_cmp_lg_u32 s30, 0
  s_cbranch_scc1 A_LOOP
  s_waitcnt lgkmcnt(15)
  v_mfma_f32_16x16x32_bf16 a[0:3], v[76:79], v[20:23], a[0:3]
  v_mfma_f32_16x16x32_bf16 a[12:15], v[80:83], v[20:23], a[12:15]
  v_exp_f32 v36, v36
  v_mfma_f32_16x16x32_bf16 a[24:27], v[84:87], v[20:23], a[24:27]
  v_add_f32 v7, v36, v7
  v_mfma_f32_16x16x32_bf16 a[36:39], v[88:91], v[20:23], a[36:39]
  v_exp_f32 v37, v37
  s_waitcnt lgkmcnt(14)
  v_mfma_f32_16x16x32_bf16 a[48:51], v[92:95], v[20:23], a[48:51]
  v_add_f32 v7, v37, v7
  v_cvt_pk_bf16_f32 v36, v36, v37
  s_waitcnt lgkmcnt(12)
  v_mfma_f32_16x16x32_bf16 a[60:63], v[96:99], v[20:23], a[60:63]
  v_exp_f32 v38, v38
  s_waitcnt lgkmcnt(10)
  v_mfma_f32_16x16x32_bf16 a[72:75], v[100:103], v[20:23], a[72:75]
  v_add_f32 v7, v38, v7
  s_waitcnt lgkmcnt(8)
  v_mfma_f32_16x16x32_bf16 a[84:87], v[104:107], v[20:23], a[84:87]
  v_exp_f32 v39, v39
  s_waitcnt lgkmcnt(7)
  v_mfma_f32_16x16x32_bf16 v[20:23], v[44:47], a[96:99], v[8:11]
  v_add_f32 v7, v39, v7
  v_cvt_pk_bf16_f32 v37, v38, v39
  s_waitcnt lgkmcnt(6)
  v_mfma_f32_16x16x32_bf16 v[24:27], v[60:63], a[96:99], v[8:11]
  v_exp_f32 v40, v40
  s_waitcnt lgkmcnt(5)
  v_mfma_f32_16x16x32_bf16 v[20:23], v[48:51], a[100:103], v[20:23]
  v_add_f32 v7, v40, v7
  s_waitcnt lgkmcnt(4)
  v_mfma_f32_16x16x32_bf16 v[24:27], v[64:67], a[100:103], v[24:27]
  v_exp_f32 v41, v41
  s_waitcnt lgkmcnt(3)
  v_mfma_f32_16x16x32_bf16 v[20:23], v[52:55], a[104:107], v[20:23]
  v_add_f32 v7, v41, v7
  v_cvt_pk_bf16_f32 v38, v40, v41
  s_waitcnt lgkmcnt(2)
  v_mfma_f32_16x16x32_bf16 v[24:27], v[68:71], a[104:107], v[24:27]
  v_exp_f32 v42, v42
  s_waitcnt lgkmcnt(1)
  v_mfma_f32_16x16x32_bf16 v[20:23], v[56:59], a[108:111], v[20:23]
  v_add_f32 v7, v42, v7
  s_waitcnt lgkmcnt(0)
  v_mfma_f32_16x16x32_bf16 v[24:27], v[72:75], a[108:111], v[24:27]
  v_exp_f32 v43, v43
  s_waitcnt vmcnt(0)
  s_barrier
  v_mfma_f32_16x16x32_bf16 a[4:7], v[76:79], v[28:31], a[4:7]
  v_add_f32 v7, v43, v7
  v_cvt_pk_bf16_f32 v39, v42, v43
  v_mfma_f32_16x16x32_bf16 a[16:19], v[80:83], v[28:31], a[16:19]
  v_exp_f32 v20, v20
  v_mfma_f32_16x16x32_bf16 a[28:31], v[84:87], v[28:31], a[28:31]
  v_add_f32 v5, v20, v5
  v_mfma_f32_16x16x32_bf16 a[40:43], v[88:91], v[28:31], a[40:43]
  v_exp_f32 v21, v21
  v_mfma_f32_16x16x32_bf16 a[52:55], v[92:95], v[28:31], a[52:55]
  v_add_f32 v5, v21, v5
  v_cvt_pk_bf16_f32 v20, v20, v21
  v_mfma_f32_16x16x32_bf16 a[64:67], v[96:99], v[28:31], a[64:67]
  v_exp_f32 v22, v22
  v_mfma_f32_16x16x32_bf16 a[76:79], v[100:103], v[28:31], a[76:79]
  v_add_f32 v5, v22, v5
  s_add_u32 m0, s32, 49152
  v_mfma_f32_16x16x32_bf16 a[88:91], v[104:107], v[28:31], a[88:91]
  buffer_load_dwordx4 v4, s[12:15], s29 offen nt lds
  v_exp_f32 v23, v23
  v_mfma_f32_16x16x32_bf16 v[28:31], v[44:47], a[112:115], v[12:15]
  v_add_f32 v5, v23, v5
  v_cvt_pk_bf16_f32 v21, v22, v23
  v_mfma_f32_16x16x32_bf16 v[32:35], v[60:63], a[112:115], v[12:15]
  v_exp_f32 v24, v24
  v_mfma_f32_16x16x32_bf16 v[28:31], v[48:51], a[116:119], v[28:31]
  v_add_f32 v5, v24, v5
  v_mfma_f32_16x16x32_bf16 v[32:35], v[64:67], a[116:119], v[32:35]
  v_exp_f32 v25, v25
  v_mfma_f32_16x16x32_bf16 v[28:31], v[52:55], a[120:123], v[28:31]
  v_add_f32 v5, v25, v5
  v_cvt_pk_bf16_f32 v22, v24, v25
  v_mfma_f32_16x16x32_bf16 v[32:35], v[68:71], a[120:123], v[32:35]
  buffer_load_dwordx4 v0, s[12:15], s29 offen offset:1024 nt lds
  v_exp_f32 v26, v26
  v_mfma_f32_16x16x32_bf16 v[28:31], v[56:59], a[124:127], v[28:31]
  v_add_f32 v5, v26, v5
  v_mfma_f32_16x16x32_bf16 v[32:35], v[72:75], a[124:127], v[32:35]
  v_exp_f32 v27, v27
  v_mfma_f32_16x16x32_bf16 a[8:11], v[76:79], v[36:39], a[8:11]
  v_add_f32 v5, v27, v5
  v_cvt_pk_bf16_f32 v23, v26, v27
  ds_read_b64_tr_b16 v[76:77], v2 offset:40960
  ds_read_b64_tr_b16 v[78:79], v2 offset:45056
  v_mfma_f32_16x16x32_bf16 a[20:23], v[80:83], v[36:39], a[20:23]
  v_exp_f32 v28, v28
  s_nop 0
  v_add_f32 v6, v28, v6
  ds_read_b64_tr_b16 v[80:81], v3 offset:40960
  ds_read_b64_tr_b16 v[82:83], v3 offset:45056
  v_mfma_f32_16x16x32_bf16 a[32:35], v[84:87], v[36:39], a[32:35]
  v_exp_f32 v29, v29
  ds_read_b64_tr_b16 v[84:85], v2 offset:41216
  ds_read_b64_tr_b16 v[86:87], v2 offset:45312
  s_add_u32 m0, s32, 24576
  v_mfma_f32_16x16x32_bf16 a[44:47], v[88:91], v[36:39], a[44:47]
  buffer_load_dwordx4 v4, s[8:11], s28 offen nt lds
  v_add_f32 v6, v29, v6
  v_cvt_pk_bf16_f32 v28, v28, v29
  ds_read_b64_tr_b16 v[88:89], v3 offset:41216
  ds_read_b64_tr_b16 v[90:91], v3 offset:45312
  v_mfma_f32_16x16x32_bf16 a[56:59], v[92:95], v[36:39], a[56:59]
  v_exp_f32 v30, v30
  ds_read_b64_tr_b16 v[92:93], v2 offset:41472
  ds_read_b64_tr_b16 v[94:95], v2 offset:45568
  v_mfma_f32_16x16x32_bf16 a[68:71], v[96:99], v[36:39], a[68:71]
  v_add_f32 v6, v30, v6
  ds_read_b64_tr_b16 v[96:97], v3 offset:41472
  ds_read_b64_tr_b16 v[98:99], v3 offset:45568
  v_mfma_f32_16x16x32_bf16 a[80:83], v[100:103], v[36:39], a[80:83]
  v_exp_f32 v31, v31
  ds_read_b64_tr_b16 v[100:101], v2 offset:41728
  ds_read_b64_tr_b16 v[102:103], v2 offset:45824
  v_mfma_f32_16x16x32_bf16 a[92:95], v[104:107], v[36:39], a[92:95]
  v_add_f32 v6, v31, v6
  v_cvt_pk_bf16_f32 v29, v30, v31
  ds_read_b64_tr_b16 v[104:105], v3 offset:41728
  ds_read_b64_tr_b16 v[106:107], v3 offset:45824
  v_mfma_f32_16x16x32_bf16 v[36:39], v[44:47], a[128:131], v[16:19]
  v_exp_f32 v32, v32
  ds_read_b128 v[44:47], v1 offset:16384
  v_mfma_f32_16x16x32_bf16 v[40:43], v[60:63], a[128:131], v[16:19]
  buffer_load_dwordx4 v0, s[8:11], s28 offen offset:1024 nt lds
  v_add_f32 v6, v32, v6
  ds_read_b128 v[60:63], v1 offset:20480
  v_mfma_f32_16x16x32_bf16 v[36:39], v[48:51], a[132:135], v[36:39]
  v_exp_f32 v33, v33
  ds_read_b128 v[48:51], v1 offset:16640
  v_mfma_f32_16x16x32_bf16 v[40:43], v[64:67], a[132:135], v[40:43]
  v_add_f32 v6, v33, v6
  v_cvt_pk_bf16_f32 v30, v32, v33
  ds_read_b128 v[64:67], v1 offset:20736
  v_mfma_f32_16x16x32_bf16 v[36:39], v[52:55], a[136:139], v[36:39]
  v_exp_f32 v34, v34
  ds_read_b128 v[52:55], v1 offset:16896
  v_mfma_f32_16x16x32_bf16 v[40:43], v[68:71], a[136:139], v[40:43]
  v_add_f32 v6, v34, v6
  ds_read_b128 v[68:71], v1 offset:20992
  v_mfma_f32_16x16x32_bf16 v[36:39], v[56:59], a[140:143], v[36:39]
  v_exp_f32 v35, v35
  ds_read_b128 v[56:59], v1 offset:17152
  v_mfma_f32_16x16x32_bf16 v[40:43], v[72:75], a[140:143], v[40:43]
  v_add_f32 v6, v35, v6
  v_cvt_pk_bf16_f32 v31, v34, v35
  ds_read_b128 v[72:75], v1 offset:21248
  s_mov_b32 s29, s28
  s_add_u32 s28, s28, 8192
  s_and_b32 s28, s28, 0x3ffff
  s_waitcnt lgkmcnt(15)
  v_mfma_f32_16x16x32_bf16 a[0:3], v[76:79], v[20:23], a[0:3]
  v_mfma_f32_16x16x32_bf16 a[12:15], v[80:83], v[20:23], a[12:15]
  v_exp_f32 v36, v36
  v_mfma_f32_16x16x32_bf16 a[24:27], v[84:87], v[20:23], a[24:27]
  v_add_f32 v7, v36, v7
  v_mfma_f32_16x16x32_bf16 a[36:39], v[88:91], v[20:23], a[36:39]
  v_exp_f32 v37, v37
  s_waitcnt lgkmcnt(14)
  v_mfma_f32_16x16x32_bf16 a[48:51], v[92:95], v[20:23], a[48:51]
  v_add_f32 v7, v37, v7
  v_cvt_pk_bf16_f32 v36, v36, v37
  s_waitcnt lgkmcnt(12)
  v_mfma_f32_16x16x32_bf16 a[60:63], v[96:99], v[20:23], a[60:63]
  v_exp_f32 v38, v38
  s_waitcnt lgkmcnt(10)
  v_mfma_f32_16x16x32_bf16 a[72:75], v[100:103], v[20:23], a[72:75]
  v_add_f32 v7, v38, v7
  s_waitcnt lgkmcnt(8)
  v_mfma_f32_16x16x32_bf16 a[84:87], v[104:107], v[20:23], a[84:87]
  v_exp_f32 v39, v39
  s_waitcnt lgkmcnt(7)
  v_mfma_f32_16x16x32_bf16 v[20:23], v[44:47], a[96:99], v[8:11]
  v_add_f32 v7, v39, v7
  v_cvt_pk_bf16_f32 v37, v38, v39
  s_waitcnt lgkmcnt(6)
  v_mfma_f32_16x16x32_bf16 v[24:27], v[60:63], a[96:99], v[8:11]
  v_exp_f32 v40, v40
  s_waitcnt lgkmcnt(5)
  v_mfma_f32_16x16x32_bf16 v[20:23], v[48:51], a[100:103], v[20:23]
  v_add_f32 v7, v40, v7
  s_waitcnt lgkmcnt(4)
  v_mfma_f32_16x16x32_bf16 v[24:27], v[64:67], a[100:103], v[24:27]
  v_exp_f32 v41, v41
  s_waitcnt lgkmcnt(3)
  v_mfma_f32_16x16x32_bf16 v[20:23], v[52:55], a[104:107], v[20:23]
  v_add_f32 v7, v41, v7
  v_cvt_pk_bf16_f32 v38, v40, v41
  s_waitcnt lgkmcnt(2)
  v_mfma_f32_16x16x32_bf16 v[24:27], v[68:71], a[104:107], v[24:27]
  v_exp_f32 v42, v42
  s_waitcnt lgkmcnt(1)
  v_mfma_f32_16x16x32_bf16 v[20:23], v[56:59], a[108:111], v[20:23]
  v_add_f32 v7, v42, v7
  s_waitcnt lgkmcnt(0)
  v_mfma_f32_16x16x32_bf16 v[24:27], v[72:75], a[108:111], v[24:27]
  v_exp_f32 v43, v43
  s_waitcnt vmcnt(0)
  s_barrier
  v_mfma_f32_16x16x32_bf16 a[4:7], v[76:79], v[28:31], a[4:7]
  v_add_f32 v7, v43, v7
  v_cvt_pk_bf16_f32 v39, v42, v43
  v_mfma_f32_16x16x32_bf16 a[16:19], v[80:83], v[28:31], a[16:19]
  v_exp_f32 v20, v20
  v_mfma_f32_16x16x32_bf16 a[28:31], v[84:87], v[28:31], a[28:31]
  v_add_f32 v5, v20, v5
  v_mfma_f32_16x16x32_bf16 a[40:43], v[88:91], v[28:31], a[40:43]
  v_exp_f32 v21, v21
  v_mfma_f32_16x16x32_bf16 a[52:55], v[92:95], v[28:31], a[52:55]
  v_add_f32 v5, v21, v5
  v_cvt_pk_bf16_f32 v20, v20, v21
  v_mfma_f32_16x16x32_bf16 a[64:67], v[96:99], v[28:31], a[64:67]
  v_exp_f32 v22, v22
  v_mfma_f32_16x16x32_bf16 a[76:79], v[100:103], v[28:31], a[76:79]
  v_add_f32 v5, v22, v5
  s_add_u32 m0, s32, 57344
  v_mfma_f32_16x16x32_bf16 a[88:91], v[104:107], v[28:31], a[88:91]
  buffer_load_dwordx4 v4, s[12:15], s29 offen nt lds
  v_exp_f32 v23, v23
  v_mfma_f32_16x16x32_bf16 v[28:31], v[44:47], a[112:115], v[12:15]
  v_add_f32 v5, v23, v5
  v_cvt_pk_bf16_f32 v21, v22, v23
  v_mfma_f32_16x16x32_bf16 v[32:35], v[60:63], a[112:115], v[12:15]
  v_exp_f32 v24, v24
  v_mfma_f32_16x16x32_bf16 v[28:31], v[48:51], a[116:119], v[28:31]
  v_add_f32 v5, v24, v5
  v_mfma_f32_16x16x32_bf16 v[32:35], v[64:67], a[116:119], v[32:35]
  v_exp_f32 v25, v25
  v_mfma_f32_16x16x32_bf16 v[28:31], v[52:55], a[120:123], v[28:31]
  v_add_f32 v5, v25, v5
  v_cvt_pk_bf16_f32 v22, v24, v25
  v_mfma_f32_16x16x32_bf16 v[32:35], v[68:71], a[120:123], v[32:35]
  buffer_load_dwordx4 v0, s[12:15], s29 offen offset:1024 nt lds
  v_exp_f32 v26, v26
  v_mfma_f32_16x16x32_bf16 v[28:31], v[56:59], a[124:127], v[28:31]
  v_add_f32 v5, v26, v5
  v_mfma_f32_16x16x32_bf16 v[32:35], v[72:75], a[124:127], v[32:35]
  v_exp_f32 v27, v27
  v_mfma_f32_16x16x32_bf16 a[8:11], v[76:79], v[36:39], a[8:11]
  v_add_f32 v5, v27, v5
  v_cvt_pk_bf16_f32 v23, v26, v27
  ds_read_b64_tr_b16 v[76:77], v2 offset:49152
  ds_read_b64_tr_b16 v[78:79], v2 offset:53248
  v_mfma_f32_16x16x32_bf16 a[20:23], v[80:83], v[36:39], a[20:23]
  v_exp_f32 v28, v28
  s_nop 0
  v_add_f32 v6, v28, v6
  ds_read_b64_tr_b16 v[80:81], v3 offset:49152
  ds_read_b64_tr_b16 v[82:83], v3 offset:53248
  v_mfma_f32_16x16x32_bf16 a[32:35], v[84:87], v[36:39], a[32:35]
  v_exp_f32 v29, v29
  ds_read_b64_tr_b16 v[84:85], v2 offset:49408
  ds_read_b64_tr_b16 v[86:87], v2 offset:53504
  v_mfma_f32_16x16x32_bf16 a[44:47], v[88:91], v[36:39], a[44:47]
  v_add_f32 v6, v29, v6
  v_cvt_pk_bf16_f32 v28, v28, v29
  ds_read_b64_tr_b16 v[88:89], v3 offset:49408
  ds_read_b64_tr_b16 v[90:91], v3 offset:53504
  v_mfma_f32_16x16x32_bf16 a[56:59], v[92:95], v[36:39], a[56:59]
  v_exp_f32 v30, v30
  ds_read_b64_tr_b16 v[92:93], v2 offset:49664
  ds_read_b64_tr_b16 v[94:95], v2 offset:53760
  v_mfma_f32_16x16x32_bf16 a[68:71], v[96:99], v[36:39], a[68:71]
  v_add_f32 v6, v30, v6
  ds_read_b64_tr_b16 v[96:97], v3 offset:49664
  ds_read_b64_tr_b16 v[98:99], v3 offset:53760
  v_mfma_f32_16x16x32_bf16 a[80:83], v[100:103], v[36:39], a[80:83]
  v_exp_f32 v31, v31
  ds_read_b64_tr_b16 v[100:101], v2 offset:49920
  ds_read_b64_tr_b16 v[102:103], v2 offset:54016
  v_mfma_f32_16x16x32_bf16 a[92:95], v[104:107], v[36:39], a[92:95]
  v_add_f32 v6, v31, v6
  v_cvt_pk_bf16_f32 v29, v30, v31
  ds_read_b64_tr_b16 v[104:105], v3 offset:49920
  ds_read_b64_tr_b16 v[106:107], v3 offset:54016
  v_mfma_f32_16x16x32_bf16 v[36:39], v[44:47], a[128:131], v[16:19]
  v_exp_f32 v32, v32
  ds_read_b128 v[44:47], v1 offset:24576
  v_mfma_f32_16x16x32_bf16 v[40:43], v[60:63], a[128:131], v[16:19]
  v_add_f32 v6, v32, v6
  ds_read_b128 v[60:63], v1 offset:28672
  v_mfma_f32_16x16x32_bf16 v[36:39], v[48:51], a[132:135], v[36:39]
  v_exp_f32 v33, v33
  ds_read_b128 v[48:51], v1 offset:24832
  v_mfma_f32_16x16x32_bf16 v[40:43], v[64:67], a[132:135], v[40:43]
  v_add_f32 v6, v33, v6
  v_cvt_pk_bf16_f32 v30, v32, v33
  ds_read_b128 v[64:67], v1 offset:28928
  v_mfma_f32_16x16x32_bf16 v[36:39], v[52:55], a[136:139], v[36:39]
  v_exp_f32 v34, v34
  ds_read_b128 v[52:55], v1 offset:25088
  v_mfma_f32_16x16x32_bf16 v[40:43], v[68:71], a[136:139], v[40:43]
  v_add_f32 v6, v34, v6
  ds_read_b128 v[68:71], v1 offset:29184
  v_mfma_f32_16x16x32_bf16 v[36:39], v[56:59], a[140:143], v[36:39]
  v_exp_f32 v35, v35
  ds_read_b128 v[56:59], v1 offset:25344
  v_mfma_f32_16x16x32_bf16 v[40:43], v[72:75], a[140:143], v[40:43]
  v_add_f32 v6, v35, v6
  v_cvt_pk_bf16_f32 v31, v34, v35
  ds_read_b128 v[72:75], v1 offset:29440
  s_mov_b32 s29, s28
  s_add_u32 s28, s28, 8192
  s_and_b32 s28, s28, 0x3ffff
  s_waitcnt lgkmcnt(15)
  v_mfma_f32_16x16x32_bf16 a[0:3], v[76:79], v[20:23], a[0:3]
  v_mfma_f32_16x16x32_bf16 a[12:15], v[80:83], v[20:23], a[12:15]
  v_exp_f32 v36, v36
  v_mfma_f32_16x16x32_bf16 a[24:27], v[84:87], v[20:23], a[24:27]
  v_add_f32 v7, v36, v7
  v_mfma_f32_16x16x32_bf16 a[36:39], v[88:91], v[20:23], a[36:39]
  v_exp_f32 v37, v37
  s_waitcnt lgkmcnt(14)
  v_mfma_f32_16x16x32_bf16 a[48:51], v[92:95], v[20:23], a[48:51]
  v_add_f32 v7, v37, v7
  v_cvt_pk_bf16_f32 v36, v36, v37
  s_waitcnt lgkmcnt(12)
  v_mfma_f32_16x16x32_bf16 a[60:63], v[96:99], v[20:23], a[60:63]
  v_exp_f32 v38, v38
  s_waitcnt lgkmcnt(10)
  v_mfma_f32_16x16x32_bf16 a[72:75], v[100:103], v[20:23], a[72:75]
  v_add_f32 v7, v38, v7
  s_waitcnt lgkmcnt(8)
  v_mfma_f32_16x16x32_bf16 a[84:87], v[104:107], v[20:23], a[84:87]
  v_exp_f32 v39, v39
  s_waitcnt lgkmcnt(7)
  v_mfma_f32_16x16x32_bf16 v[20:23], v[44:47], a[96:99], v[8:11]
  v_add_f32 v7, v39, v7
  v_cvt_pk_bf16_f32 v37, v38, v39
  s_waitcnt lgkmcnt(6)
  v_mfma_f32_16x16x32_bf16 v[24:27], v[60:63], a[96:99], v[8:11]
  v_exp_f32 v40, v40
  s_waitcnt lgkmcnt(5)
  v_mfma_f32_16x16x32_bf16 v[20:23], v[48:51], a[100:103], v[20:23]
  v_add_f32 v7, v40, v7
  s_waitcnt lgkmcnt(4)
  v_mfma_f32_16x16x32_bf16 v[24:27], v[64:67], a[100:103], v[24:27]
  v_exp_f32 v41, v41
  s_waitcnt lgkmcnt(3)
  v_mfma_f32_16x16x32_bf16 v[20:23], v[52:55], a[104:107], v[20:23]
  v_add_f32 v7, v41, v7
  v_cvt_pk_bf16_f32 v38, v40, v41
  s_waitcnt lgkmcnt(2)
  v_mfma_f32_16x16x32_bf16 v[24:27], v[68:71], a[104:107], v[24:27]
  v_exp_f32 v42, v42
  s_waitcnt lgkmcnt(1)
  v_mfma_f32_16x16x32_bf16 v[20:23], v[56:59], a[108:111], v[20:23]
  v_add_f32 v7, v42, v7
  s_waitcnt lgkmcnt(0)
  v_mfma_f32_16x16x32_bf16 v[24:27], v[72:75], a[108:111], v[24:27]
  v_exp_f32 v43, v43
  s_waitcnt vmcnt(0)
  s_barrier
  v_mfma_f32_16x16x32_bf16 a[4:7], v[76:79], v[28:31], a[4:7]
  v_add_f32 v7, v43, v7
  v_cvt_pk_bf16_f32 v39, v42, v43
  v_mfma_f32_16x16x32_bf16 a[16:19], v[80:83], v[28:31], a[16:19]
  v_exp_f32 v20, v20
  v_mfma_f32_16x16x32_bf16 a[28:31], v[84:87], v[28:31], a[28:31]
  v_add_f32 v5, v20, v5
  v_mfma_f32_16x16x32_bf16 a[40:43], v[88:91], v[28:31], a[40:43]
  v_exp_f32 v21, v21
  v_mfma_f32_16x16x32_bf16 a[52:55], v[92:95], v[28:31], a[52:55]
  v_add_f32 v5, v21, v5
  v_cvt_pk_bf16_f32 v20, v20, v21
  v_mfma_f32_16x16x32_bf16 a[64:67], v[96:99], v[28:31], a[64:67]
  v_exp_f32 v22, v22
  v_mfma_f32_16x16x32_bf16 a[76:79], v[100:103], v[28:31], a[76:79]
  v_add_f32 v5, v22, v5
  v_mfma_f32_16x16x32_bf16 a[88:91], v[104:107], v[28:31], a[88:91]
  v_exp_f32 v23, v23
  v_mfma_f32_16x16x32_bf16 v[28:31], v[44:47], a[112:115], v[12:15]
  v_add_f32 v5, v23, v5
  v_cvt_pk_bf16_f32 v21, v22, v23
  v_mfma_f32_16x16x32_bf16 v[32:35], v[60:63], a[112:115], v[12:15]
  v_exp_f32 v24, v24
  v_mfma_f32_16x16x32_bf16 v[28:31], v[48:51], a[116:119], v[28:31]
  v_add_f32 v5, v24, v5
  v_mfma_f32_16x16x32_bf16 v[32:35], v[64:67], a[116:119], v[32:35]
  v_exp_f32 v25, v25
  v_mfma_f32_16x16x32_bf16 v[28:31], v[52:55], a[120:123], v[28:31]
  v_add_f32 v5, v25, v5
  v_cvt_pk_bf16_f32 v22, v24, v25
  v_mfma_f32_16x16x32_bf16 v[32:35], v[68:71], a[120:123], v[32:35]
  v_exp_f32 v26, v26
  v_mfma_f32_16x16x32_bf16 v[28:31], v[56:59], a[124:127], v[28:31]
  v_add_f32 v5, v26, v5
  v_mfma_f32_16x16x32_bf16 v[32:35], v[72:75], a[124:127], v[32:35]
  v_exp_f32 v27, v27
  v_mfma_f32_16x16x32_bf16 a[8:11], v[76:79], v[36:39], a[8:11]
  v_add_f32 v5, v27, v5
  v_cvt_pk_bf16_f32 v23, v26, v27
  ds_read_b64_tr_b16 v[76:77], v2 offset:57344
  ds_read_b64_tr_b16 v[78:79], v2 offset:61440
  v_mfma_f32_16x16x32_bf16 a[20:23], v[80:83], v[36:39], a[20:23]
  v_exp_f32 v28, v28
  s_nop 0
  v_add_f32 v6, v28, v6
  ds_read_b64_tr_b16 v[80:81], v3 offset:57344
  ds_read_b64_tr_b16 v[82:83], v3 offset:61440
  v_mfma_f32_16x16x32_bf16 a[32:35], v[84:87], v[36:39], a[32:35]
  v_exp_f32 v29, v29
  ds_read_b64_tr_b16 v[84:85], v2 offset:57600
  ds_read_b64_tr_b16 v[86:87], v2 offset:61696
  v_mfma_f32_16x16x32_bf16 a[44:47], v[88:91], v[36:39], a[44:47]
  v_add_f32 v6, v29, v6
  v_cvt_pk_bf16_f32 v28, v28, v29
  ds_read_b64_tr_b16 v[88:89], v3 offset:57600
  ds_read_b64_tr_b16 v[90:91], v3 offset:61696
  v_mfma_f32_16x16x32_bf16 a[56:59], v[92:95], v[36:39], a[56:59]
  v_exp_f32 v30, v30
  ds_read_b64_tr_b16 v[92:93], v2 offset:57856
  ds_read_b64_tr_b16 v[94:95], v2 offset:61952
  v_mfma_f32_16x16x32_bf16 a[68:71], v[96:99], v[36:39], a[68:71]
  v_add_f32 v6, v30, v6
  ds_read_b64_tr_b16 v[96:97], v3 offset:57856
  ds_read_b64_tr_b16 v[98:99], v3 offset:61952
  v_mfma_f32_16x16x32_bf16 a[80:83], v[100:103], v[36:39], a[80:83]
  v_exp_f32 v31, v31
  ds_read_b64_tr_b16 v[100:101], v2 offset:58112
  ds_read_b64_tr_b16 v[102:103], v2 offset:62208
  v_mfma_f32_16x16x32_bf16 a[92:95], v[104:107], v[36:39], a[92:95]
  v_add_f32 v6, v31, v6
  v_cvt_pk_bf16_f32 v29, v30, v31
  ds_read_b64_tr_b16 v[104:105], v3 offset:58112
  ds_read_b64_tr_b16 v[106:107], v3 offset:62208
  v_mfma_f32_16x16x32_bf16 v[36:39], v[44:47], a[128:131], v[16:19]
  v_exp_f32 v32, v32
  v_mfma_f32_16x16x32_bf16 v[40:43], v[60:63], a[128:131], v[16:19]
  v_add_f32 v6, v32, v6
  v_mfma_f32_16x16x32_bf16 v[36:39], v[48:51], a[132:135], v[36:39]
  v_exp_f32 v33, v33
  v_mfma_f32_16x16x32_bf16 v[40:43], v[64:67], a[132:135], v[40:43]
  v_add_f32 v6, v33, v6
  v_cvt_pk_bf16_f32 v30, v32, v33
  v_mfma_f32_16x16x32_bf16 v[36:39], v[52:55], a[136:139], v[36:39]
  v_exp_f32 v34, v34
  v_mfma_f32_16x16x32_bf16 v[40:43], v[68:71], a[136:139], v[40:43]
  v_add_f32 v6, v34, v6
  v_mfma_f32_16x16x32_bf16 v[36:39], v[56:59], a[140:143], v[36:39]
  v_exp_f32 v35, v35
  v_mfma_f32_16x16x32_bf16 v[40:43], v[72:75], a[140:143], v[40:43]
  v_add_f32 v6, v35, v6
  v_cvt_pk_bf16_f32 v31, v34, v35
  s_waitcnt lgkmcnt(14)
  v_mfma_f32_16x16x32_bf16 a[0:3], v[76:79], v[20:23], a[0:3]
  s_waitcnt lgkmcnt(12)
  v_mfma_f32_16x16x32_bf16 a[12:15], v[80:83], v[20:23], a[12:15]
  v_exp_f32 v36, v36
  s_waitcnt lgkmcnt(10)
  v_mfma_f32_16x16x32_bf16 a[24:27], v[84:87], v[20:23], a[24:27]
  v_add_f32 v7, v36, v7
  s_waitcnt lgkmcnt(8)
  v_mfma_f32_16x16x32_bf16 a[36:39], v[88:91], v[20:23], a[36:39]
  v_exp_f32 v37, v37
  s_waitcnt lgkmcnt(6)
  v_mfma_f32_16x16x32_bf16 a[48:51], v[92:95], v[20:23], a[48:51]
  v_add_f32 v7, v37, v7
  v_cvt_pk_bf16_f32 v36, v36, v37
  s_waitcnt lgkmcnt(4)
  v_mfma_f32_16x16x32_bf16 a[60:63], v[96:99], v[20:23], a[60:63]
  v_exp_f32 v38, v38
  s_waitcnt lgkmcnt(2)
  v_mfma_f32_16x16x32_bf16 a[72:75], v[100:103], v[20:23], a[72:75]
  v_add_f32 v7, v38, v7
  s_waitcnt lgkmcnt(0)
  v_mfma_f32_16x16x32_bf16 a[84:87], v[104:107], v[20:23], a[84:87]
  v_exp_f32 v39, v39
  s_nop 0
  v_add_f32 v7, v39, v7
  v_cvt_pk_bf16_f32 v37, v38, v39
  v_exp_f32 v40, v40
  s_nop 0
  v_add_f32 v7, v40, v7
  v_exp_f32 v41, v41
  s_nop 0
  v_add_f32 v7, v41, v7
  v_cvt_pk_bf16_f32 v38, v40, v41
  v_exp_f32 v42, v42
  s_nop 0
  v_add_f32 v7, v42, v7
  v_exp_f32 v43, v43
  v_mfma_f32_16x16x32_bf16 a[4:7], v[76:79], v[28:31], a[4:7]
  v_add_f32 v7, v43, v7
  v_cvt_pk_bf16_f32 v39, v42, v43
  v_mfma_f32_16x16x32_bf16 a[16:19], v[80:83], v[28:31], a[16:19]
  v_mfma_f32_16x16x32_bf16 a[28:31], v[84:87], v[28:31], a[28:31]
  v_mfma_f32_16x16x32_bf16 a[40:43], v[88:91], v[28:31], a[40:43]
  v_mfma_f32_16x16x32_bf16 a[52:55], v[92:95], v[28:31], a[52:55]
  v_mfma_f32_16x16x32_bf16 a[64:67], v[96:99], v[28:31], a[64:67]
  v_mfma_f32_16x16x32_bf16 a[76:79], v[100:103], v[28:31], a[76:79]
  v_mfma_f32_16x16x32_bf16 a[88:91], v[104:107], v[28:31], a[88:91]
  v_mfma_f32_16x16x32_bf16 a[8:11], v[76:79], v[36:39], a[8:11]
  v_mfma_f32_16x16x32_bf16 a[20:23], v[80:83], v[36:39], a[20:23]
  v_mfma_f32_16x16x32_bf16 a[32:35], v[84:87], v[36:39], a[32:35]
  v_mfma_f32_16x16x32_bf16 a[44:47], v[88:91], v[36:39], a[44:47]
  v_mfma_f32_16x16x32_bf16 a[56:59], v[92:95], v[36:39], a[56:59]
  v_mfma_f32_16x16x32_bf16 a[68:71], v[96:99], v[36:39], a[68:71]
  v_mfma_f32_16x16x32_bf16 a[80:83], v[100:103], v[36:39], a[80:83]
  v_mfma_f32_16x16x32_bf16 a[92:95], v[104:107], v[36:39], a[92:95]
  v_mov_b32 v108, v5
  s_nop 1
  v_permlane16_swap_b32 v5, v108
  v_add_f32 v5, v5, v108
  v_mov_b32 v108, v5
  s_nop 1
  v_permlane32_swap_b32 v5, v108
  v_add_f32 v5, v5, v108
  v_mov_b32 v108, v6
  s_nop 1
  v_permlane16_swap_b32 v6, v108
  v_add_f32 v6, v6, v108
  v_mov_b32 v108, v6
  s_nop 1
  v_permlane32_swap_b32 v6, v108
  v_add_f32 v6, v6, v108
  v_mov_b32 v108, v7
  s_nop 1
  v_permlane16_swap_b32 v7, v108
  v_add_f32 v7, v7, v108
  v_mov_b32 v108, v7
  s_nop 1
  v_permlane32_swap_b32 v7, v108
  v_add_f32 v7, v7, v108
  s_cmp_lg_u32 s31, 0
  s_cbranch_scc1 A_STORE
  s_mov_b32 s38, 0x5d800000
  v_max3_f32 v108, v5, v6, v7
  v_add_f32 v109, v5, v6
  v_add_f32 v109, v109, v7
  v_cmp_ngt_f32 vcc, s38, v109
  s_nop 1
  s_cmp_lg_u64 vcc, 0
  s_cselect_b32 s38, 1, 0
  s_lshl_b32 s39, s3, 11
  s_sub_u32 s29, s32, s39
  s_add_u32 s29, s29, 0x10000
  s_lshl_b32 s39, s3, 2
  s_add_u32 s39, s39, s29
  v_mov_b32 v108, s39
  v_mov_b32 v109, s38
  ds_write_b32 v108, v109
  v_mov_b32 v108, s29
  s_waitcnt lgkmcnt(0)
  s_barrier
  ds_read_b128 v[20:23], v108
  s_waitcnt lgkmcnt(0)
  v_or_b32 v20, v20, v21
  v_or3_b32 v20, v20, v22, v23
  s_nop 0
  v_readfirstlane_b32 s38, v20
  s_nop 1
  s_cmp_lg_u32 s38, 0
  s_cbranch_scc1 A_FALLBACK
A_STORE:
  v_mbcnt_lo_u32_b32 v0, -1, 0
  v_mbcnt_hi_u32_b32 v0, -1, v0
  v_lshlrev_b32 v0, 4, v0
  v_rcp_f32 v8, v5
  s_nop 0
  v_mov_b32 v9, v8
  v_rcp_f32 v10, v6
  s_nop 0
  v_mov_b32 v11, v10
  v_rcp_f32 v12, v7
  s_nop 0
  v_mov_b32 v13, v12
  v_accvgpr_read_b32 v20, a0
  v_accvgpr_read_b32 v21, a1
  v_accvgpr_read_b32 v22, a2
  v_accvgpr_read_b32 v23, a3
  v_accvgpr_read_b32 v24, a12
  v_accvgpr_read_b32 v25, a13
  v_accvgpr_read_b32 v26, a14
  v_accvgpr_read_b32 v27, a15
  v_pk_mul_f32 v[20:21], v[20:21], v[8:9]
  v_pk_mul_f32 v[22:23], v[22:23], v[8:9]
  v_pk_mul_f32 v[24:25], v[24:25], v[8:9]
  v_pk_mul_f32 v[26:27], v[26:27], v[8:9]
  v_cvt_pk_bf16_f32 v20, v20, v21
  v_cvt_pk_bf16_f32 v21, v22, v23
  v_cvt_pk_bf16_f32 v22, v24, v25
  v_cvt_pk_bf16_f32 v23, v26, v27
  buffer_store_dwordx4 v[20:23], v0, s[24:27], 0 offen offset:0
  v_accvgpr_read_b32 v28, a24
  v_accvgpr_read_b32 v29, a25
  v_accvgpr_read_b32 v30, a26
  v_accvgpr_read_b32 v31, a27
  v_accvgpr_read_b32 v32, a36
  v_accvgpr_read_b32 v33, a37
  v_accvgpr_read_b32 v34, a38
  v_accvgpr_read_b32 v35, a39
  v_pk_mul_f32 v[28:29], v[28:29], v[8:9]
  v_pk_mul_f32 v[30:31], v[30:31], v[8:9]
  v_pk_mul_f32 v[32:33], v[32:33], v[8:9]
  v_pk_mul_f32 v[34:35], v[34:35], v[8:9]
  v_cvt_pk_bf16_f32 v28, v28, v29
  v_cvt_pk_bf16_f32 v29, v30, v31
  v_cvt_pk_bf16_f32 v30, v32, v33
  v_cvt_pk_bf16_f32 v31, v34, v35
  buffer_store_dwordx4 v[28:31], v0, s[24:27], 0 offen offset:1024
  v_accvgpr_read_b32 v36, a48
  v_accvgpr_read_b32 v37, a49
  v_accvgpr_read_b32 v38, a50
  v_accvgpr_read_b32 v39, a51
  v_accvgpr_read_b32 v40, a60
  v_accvgpr_read_b32 v41, a61
  v_accvgpr_read_b32 v42, a62
  v_accvgpr_read_b32 v43, a63
  v_pk_mul_f32 v[36:37], v[36:37], v[8:9]
  v_pk_mul_f32 v[38:39], v[38:39], v[8:9]
  v_pk_mul_f32 v[40:41], v[40:41], v[8:9]
  v_pk_mul_f32 v[42:43], v[42:43], v[8:9]
  v_cvt_pk_bf16_f32 v36, v36, v37
  v_cvt_pk_bf16_f32 v37, v38, v39
  v_cvt_pk_bf16_f32 v38, v40, v41
  v_cvt_pk_bf16_f32 v39, v42, v43
  buffer_store_dwordx4 v[36:39], v0, s[24:27], 0 offen offset:2048
  v_accvgpr_read_b32 v44, a72
  v_accvgpr_read_b32 v45, a73
  v_accvgpr_read_b32 v46, a74
  v_accvgpr_read_b32 v47, a75
  v_accvgpr_read_b32 v48, a84
  v_accvgpr_read_b32 v49, a85
  v_accvgpr_read_b32 v50, a86
  v_accvgpr_read_b32 v51, a87
  v_pk_mul_f32 v[44:45], v[44:45], v[8:9]
  v_pk_mul_f32 v[46:47], v[46:47], v[8:9]
  v_pk_mul_f32 v[48:49], v[48:49], v[8:9]
  v_pk_mul_f32 v[50:51], v[50:51], v[8:9]
  v_cvt_pk_bf16_f32 v44, v44, v45
  v_cvt_pk_bf16_f32 v45, v46, v47
  v_cvt_pk_bf16_f32 v46, v48, v49
  v_cvt_pk_bf16_f32 v47, v50, v51
  buffer_store_dwordx4 v[44:47], v0, s[24:27], 0 offen offset:3072
  v_accvgpr_read_b32 v52, a4
  v_accvgpr_read_b32 v53, a5
  v_accvgpr_read_b32 v54, a6
  v_accvgpr_read_b32 v55, a7
  v_accvgpr_read_b32 v56, a16
  v_accvgpr_read_b32 v57, a17
  v_accvgpr_read_b32 v58, a18
  v_accvgpr_read_b32 v59, a19
  v_pk_mul_f32 v[52:53], v[52:53], v[10:11]
  v_pk_mul_f32 v[54:55], v[54:55], v[10:11]
  v_pk_mul_f32 v[56:57], v[56:57], v[10:11]
  v_pk_mul_f32 v[58:59], v[58:59], v[10:11]
  v_cvt_pk_bf16_f32 v52, v52, v53
  v_cvt_pk_bf16_f32 v53, v54, v55
  v_cvt_pk_bf16_f32 v54, v56, v57
  v_cvt_pk_bf16_f32 v55, v58, v59
  buffer_store_dwordx4 v[52:55], v0, s[24:27], s36 offen offset:0
  v_accvgpr_read_b32 v60, a28
  v_accvgpr_read_b32 v61, a29
  v_accvgpr_read_b32 v62, a30
  v_accvgpr_read_b32 v63, a31
  v_accvgpr_read_b32 v64, a40
  v_accvgpr_read_b32 v65, a41
  v_accvgpr_read_b32 v66, a42
  v_accvgpr_read_b32 v67, a43
  v_pk_mul_f32 v[60:61], v[60:61], v[10:11]
  v_pk_mul_f32 v[62:63], v[62:63], v[10:11]
  v_pk_mul_f32 v[64:65], v[64:65], v[10:11]
  v_pk_mul_f32 v[66:67], v[66:67], v[10:11]
  v_cvt_pk_bf16_f32 v60, v60, v61
  v_cvt_pk_bf16_f32 v61, v62, v63
  v_cvt_pk_bf16_f32 v62, v64, v65
  v_cvt_pk_bf16_f32 v63, v66, v67
  buffer_store_dwordx4 v[60:63], v0, s[24:27], s36 offen offset:1024
  v_accvgpr_read_b32 v68, a52
  v_accvgpr_read_b32 v69, a53
  v_accvgpr_read_b32 v70, a54
  v_accvgpr_read_b32 v71, a55
  v_accvgpr_read_b32 v72, a64
  v_accvgpr_read_b32 v73, a65
  v_accvgpr_read_b32 v74, a66
  v_accvgpr_read_b32 v75, a67
  v_pk_mul_f32 v[68:69], v[68:69], v[10:11]
  v_pk_mul_f32 v[70:71], v[70:71], v[10:11]
  v_pk_mul_f32 v[72:73], v[72:73], v[10:11]
  v_pk_mul_f32 v[74:75], v[74:75], v[10:11]
  v_cvt_pk_bf16_f32 v68, v68, v69
  v_cvt_pk_bf16_f32 v69, v70, v71
  v_cvt_pk_bf16_f32 v70, v72, v73
  v_cvt_pk_bf16_f32 v71, v74, v75
  buffer_store_dwordx4 v[68:71], v0, s[24:27], s36 offen offset:2048
  v_accvgpr_read_b32 v76, a76
  v_accvgpr_read_b32 v77, a77
  v_accvgpr_read_b32 v78, a78
  v_accvgpr_read_b32 v79, a79
  v_accvgpr_read_b32 v80, a88
  v_accvgpr_read_b32 v81, a89
  v_accvgpr_read_b32 v82, a90
  v_accvgpr_read_b32 v83, a91
  v_pk_mul_f32 v[76:77], v[76:77], v[10:11]
  v_pk_mul_f32 v[78:79], v[78:79], v[10:11]
  v_pk_mul_f32 v[80:81], v[80:81], v[10:11]
  v_pk_mul_f32 v[82:83], v[82:83], v[10:11]
  v_cvt_pk_bf16_f32 v76, v76, v77
  v_cvt_pk_bf16_f32 v77, v78, v79
  v_cvt_pk_bf16_f32 v78, v80, v81
  v_cvt_pk_bf16_f32 v79, v82, v83
  buffer_store_dwordx4 v[76:79], v0, s[24:27], s36 offen offset:3072
  v_accvgpr_read_b32 v84, a8
  v_accvgpr_read_b32 v85, a9
  v_accvgpr_read_b32 v86, a10
  v_accvgpr_read_b32 v87, a11
  v_accvgpr_read_b32 v88, a20
  v_accvgpr_read_b32 v89, a21
  v_accvgpr_read_b32 v90, a22
  v_accvgpr_read_b32 v91, a23
  v_pk_mul_f32 v[84:85], v[84:85], v[12:13]
  v_pk_mul_f32 v[86:87], v[86:87], v[12:13]
  v_pk_mul_f32 v[88:89], v[88:89], v[12:13]
  v_pk_mul_f32 v[90:91], v[90:91], v[12:13]
  v_cvt_pk_bf16_f32 v84, v84, v85
  v_cvt_pk_bf16_f32 v85, v86, v87
  v_cvt_pk_bf16_f32 v86, v88, v89
  v_cvt_pk_bf16_f32 v87, v90, v91
  buffer_store_dwordx4 v[84:87], v0, s[24:27], s37 offen offset:0
  v_accvgpr_read_b32 v92, a32
  v_accvgpr_read_b32 v93, a33
  v_accvgpr_read_b32 v94, a34
  v_accvgpr_read_b32 v95, a35
  v_accvgpr_read_b32 v96, a44
  v_accvgpr_read_b32 v97, a45
  v_accvgpr_read_b32 v98, a46
  v_accvgpr_read_b32 v99, a47
  v_pk_mul_f32 v[92:93], v[92:93], v[12:13]
  v_pk_mul_f32 v[94:95], v[94:95], v[12:13]
  v_pk_mul_f32 v[96:97], v[96:97], v[12:13]
  v_pk_mul_f32 v[98:99], v[98:99], v[12:13]
  v_cvt_pk_bf16_f32 v92, v92, v93
  v_cvt_pk_bf16_f32 v93, v94, v95
  v_cvt_pk_bf16_f32 v94, v96, v97
  v_cvt_pk_bf16_f32 v95, v98, v99
  buffer_store_dwordx4 v[92:95], v0, s[24:27], s37 offen offset:1024
  v_accvgpr_read_b32 v20, a56
  v_accvgpr_read_b32 v21, a57
  v_accvgpr_read_b32 v22, a58
  v_accvgpr_read_b32 v23, a59
  v_accvgpr_read_b32 v24, a68
  v_accvgpr_read_b32 v25, a69
  v_accvgpr_read_b32 v26, a70
  v_accvgpr_read_b32 v27, a71
  v_pk_mul_f32 v[20:21], v[20:21], v[12:13]
  v_pk_mul_f32 v[22:23], v[22:23], v[12:13]
  v_pk_mul_f32 v[24:25], v[24:25], v[12:13]
  v_pk_mul_f32 v[26:27], v[26:27], v[12:13]
  v_cvt_pk_bf16_f32 v20, v20, v21
  v_cvt_pk_bf16_f32 v21, v22, v23
  v_cvt_pk_bf16_f32 v22, v24, v25
  v_cvt_pk_bf16_f32 v23, v26, v27
  buffer_store_dwordx4 v[20:23], v0, s[24:27], s37 offen offset:2048
  v_accvgpr_read_b32 v28, a80
  v_accvgpr_read_b32 v29, a81
  v_accvgpr_read_b32 v30, a82
  v_accvgpr_read_b32 v31, a83
  v_accvgpr_read_b32 v32, a92
  v_accvgpr_read_b32 v33, a93
  v_accvgpr_read_b32 v34, a94
  v_accvgpr_read_b32 v35, a95
  v_pk_mul_f32 v[28:29], v[28:29], v[12:13]
  v_pk_mul_f32 v[30:31], v[30:31], v[12:13]
  v_pk_mul_f32 v[32:33], v[32:33], v[12:13]
  v_pk_mul_f32 v[34:35], v[34:35], v[12:13]
  v_cvt_pk_bf16_f32 v28, v28, v29
  v_cvt_pk_bf16_f32 v29, v30, v31
  v_cvt_pk_bf16_f32 v30, v32, v33
  v_cvt_pk_bf16_f32 v31, v34, v35
  buffer_store_dwordx4 v[28:31], v0, s[24:27], s37 offen offset:3072
A_END:
  s_endpgm
A_FALLBACK:
  s_mov_b32 s31, 1
  s_mov_b32 s39, 0
  v_mov_b32 v8, 0xff800000
  v_mov_b32 v12, 0xff800000
  v_mov_b32 v16, 0xff800000
A_FB_LOOP:
  s_add_u32 m0, s32, 0
  s_nop 0
  buffer_load_dwordx4 v4, s[8:11], s39 offen nt lds
  buffer_load_dwordx4 v0, s[8:11], s39 offen offset:1024 nt lds
  s_waitcnt vmcnt(0) lgkmcnt(0)
  s_barrier
  ds_read_b128 v[44:47], v1 offset:0
  ds_read_b128 v[60:63], v1 offset:4096
  ds_read_b128 v[48:51], v1 offset:256
  ds_read_b128 v[64:67], v1 offset:4352
  ds_read_b128 v[52:55], v1 offset:512
  ds_read_b128 v[68:71], v1 offset:4608
  ds_read_b128 v[56:59], v1 offset:768
  ds_read_b128 v[72:75], v1 offset:4864
  s_waitcnt lgkmcnt(7)
  v_mfma_f32_16x16x32_bf16 v[20:23], v[44:47], a[96:99], 0
  s_waitcnt lgkmcnt(6)
  v_mfma_f32_16x16x32_bf16 v[24:27], v[60:63], a[96:99], 0
  s_waitcnt lgkmcnt(5)
  v_mfma_f32_16x16x32_bf16 v[20:23], v[48:51], a[100:103], v[20:23]
  s_waitcnt lgkmcnt(4)
  v_mfma_f32_16x16x32_bf16 v[24:27], v[64:67], a[100:103], v[24:27]
  s_waitcnt lgkmcnt(3)
  v_mfma_f32_16x16x32_bf16 v[20:23], v[52:55], a[104:107], v[20:23]
  s_waitcnt lgkmcnt(2)
  v_mfma_f32_16x16x32_bf16 v[24:27], v[68:71], a[104:107], v[24:27]
  s_waitcnt lgkmcnt(1)
  v_mfma_f32_16x16x32_bf16 v[20:23], v[56:59], a[108:111], v[20:23]
  s_waitcnt lgkmcnt(0)
  v_mfma_f32_16x16x32_bf16 v[24:27], v[72:75], a[108:111], v[24:27]
  v_mfma_f32_16x16x32_bf16 v[28:31], v[44:47], a[112:115], 0
  v_mfma_f32_16x16x32_bf16 v[32:35], v[60:63], a[112:115], 0
  v_mfma_f32_16x16x32_bf16 v[28:31], v[48:51], a[116:119], v[28:31]
  v_mfma_f32_16x16x32_bf16 v[32:35], v[64:67], a[116:119], v[32:35]
  v_mfma_f32_16x16x32_bf16 v[28:31], v[52:55], a[120:123], v[28:31]
  v_mfma_f32_16x16x32_bf16 v[32:35], v[68:71], a[120:123], v[32:35]
  v_mfma_f32_16x16x32_bf16 v[28:31], v[56:59], a[124:127], v[28:31]
  v_mfma_f32_16x16x32_bf16 v[32:35], v[72:75], a[124:127], v[32:35]
  v_mfma_f32_16x16x32_bf16 v[36:39], v[44:47], a[128:131], 0
  v_mfma_f32_16x16x32_bf16 v[40:43], v[60:63], a[128:131], 0
  v_mfma_f32_16x16x32_bf16 v[36:39], v[48:51], a[132:135], v[36:39]
  v_mfma_f32_16x16x32_bf16 v[40:43], v[64:67], a[132:135], v[40:43]
  v_mfma_f32_16x16x32_bf16 v[36:39], v[52:55], a[136:139], v[36:39]
  v_mfma_f32_16x16x32_bf16 v[40:43], v[68:71], a[136:139], v[40:43]
  v_mfma_f32_16x16x32_bf16 v[36:39], v[56:59], a[140:143], v[36:39]
  v_mfma_f32_16x16x32_bf16 v[40:43], v[72:75], a[140:143], v[40:43]
  v_max3_f32 v8, v20, v21, v8
  v_max3_f32 v8, v22, v23, v8
  v_max3_f32 v8, v24, v25, v8
  v_max3_f32 v8, v26, v27, v8
  v_max3_f32 v12, v28, v29, v12
  v_max3_f32 v12, v30, v31, v12
  v_max3_f32 v12, v32, v33, v12
  v_max3_f32 v12, v34, v35, v12
  v_max3_f32 v16, v36, v37, v16
  v_max3_f32 v16, v38, v39, v16
  v_max3_f32 v16, v40, v41, v16
  v_max3_f32 v16, v42, v43, v16
  s_barrier
  s_add_u32 s39, s39, 8192
  s_cmp_lt_u32 s39, 262144
  s_cbranch_scc1 A_FB_LOOP
  s_add_u32 s38, s53, 0
  s_and_b32 s38, s38, 0x3ffff
  s_add_u32 m0, s32, 0
  s_nop 0
  buffer_load_dwordx4 v4, s[8:11], s38 offen nt lds
  buffer_load_dwordx4 v0, s[8:11], s38 offen offset:1024 nt lds
  s_add_u32 s38, s53, 8192
  s_and_b32 s38, s38, 0x3ffff
  s_add_u32 m0, s32, 8192
  s_nop 0
  buffer_load_dwordx4 v4, s[8:11], s38 offen nt lds
  buffer_load_dwordx4 v0, s[8:11], s38 offen offset:1024 nt lds
  s_add_u32 s38, s53, 0
  s_and_b32 s38, s38, 0x3ffff
  s_add_u32 m0, s32, 32768
  s_nop 0
  buffer_load_dwordx4 v4, s[12:15], s38 offen nt lds
  buffer_load_dwordx4 v0, s[12:15], s38 offen offset:1024 nt lds
  s_add_u32 s38, s53, 8192
  s_and_b32 s38, s38, 0x3ffff
  s_add_u32 m0, s32, 40960
  s_nop 0
  buffer_load_dwordx4 v4, s[12:15], s38 offen nt lds
  buffer_load_dwordx4 v0, s[12:15], s38 offen offset:1024 nt lds
  s_add_u32 s38, s53, 16384
  s_and_b32 s38, s38, 0x3ffff
  s_add_u32 m0, s32, 16384
  s_nop 0
  buffer_load_dwordx4 v4, s[8:11], s38 offen nt lds
  buffer_load_dwordx4 v0, s[8:11], s38 offen offset:1024 nt lds
  s_branch A_JOIN
.globl oproj_kernel
.p2align 8
.type oproj_kernel,@function
oproj_kernel:
  s_cmp_ge_u32 s2, 240
  s_cbranch_scc1 O_END
  s_load_dwordx2 s[40:41], s[0:1], 32
  s_load_dwordx4 s[44:47], s[0:1], 72
  s_load_dwordx2 s[42:43], s[0:1], 96
  v_lshrrev_b32 v1, 6, v0
  v_and_b32 v0, 63, v0
  v_readfirstlane_b32 s3, v1
  s_and_b32 s4, s2, 7
  s_lshr_b32 s5, s2, 3
  s_lshr_b32 s6, s4, 2
  s_and_b32 s4, s4, 3
  s_mul_i32 s4, s4, 3
  s_mul_i32 s7, s5, 26
  s_lshr_b32 s7, s7, 8
  s_add_u32 s4, s4, s7
  s_mul_i32 s7, s7, 10
  s_sub_u32 s5, s5, s7
  s_mul_i32 s34, s4, 1
  s_mul_i32 s38, s5, 1
  s_add_u32 s34, s34, s38
  s_mul_i32 s38, s34, 16384
  s_lshr_b32 s38, s38, 16
  s_mul_i32 s38, s38, 4
  s_sub_u32 s34, s34, s38
  s_mul_i32 s34, s34, 1
  s_mov_b32 s49, 131072
  s_mov_b32 s50, 262144
  s_mov_b32 s51, 393216
  s_mov_b32 s52, 524288
  s_mov_b32 s53, 655360
  s_mov_b32 s54, 786432
  s_mov_b32 s55, 917504
  s_mov_b32 s57, 10240
  s_mov_b32 s58, 20480
  s_mov_b32 s59, 30720
  s_lshl_b32 s32, s3, 14
  v_and_b32 v6, 15, v0
  v_lshrrev_b32 v7, 4, v0
  v_bfe_u32 v8, v0, 2, 3
  v_lshrrev_b32 v9, 5, v0
  v_and_b32 v10, 3, v0
  v_lshlrev_b32 v1, 4, v0
  v_mul_u32_u24 v11, 1280, v8
  v_lshl_add_u32 v11, v9, 6, v11
  v_lshl_add_u32 v2, v10, 4, v11
  v_lshrrev_b32 v11, 2, v6
  v_lshlrev_b32 v11, 6, v11
  v_lshl_add_u32 v11, v10, 4, v11
  v_and_b32 v12, 1, v7
  v_lshl_add_u32 v11, v12, 8, v11
  v_lshl_add_u32 v11, v9, 10, v11
  v_add_u32 v3, s32, v11
  s_mul_i32 s38, s3, 81920
  v_mul_u32_u24 v11, 2560, v6
  v_lshl_add_u32 v11, v7, 4, v11
  v_add_u32 v4, s38, v11
  s_waitcnt lgkmcnt(0)
  s_cmp_eq_u32 s6, 0
  s_cselect_b32 s40, s40, s44
  s_cselect_b32 s41, s41, s45
  s_mul_i32 s38, s6, 12582912
  s_lshl_b32 s39, s4, 20
  s_add_u32 s38, s38, s39
  s_lshl_b32 s39, s3, 15
  s_add_u32 s38, s38, s39
  s_add_u32 s8, s42, s38
  s_addc_u32 s9, s43, 0
  s_mov_b32 s10, 950272
  s_mov_b32 s11, 0x20000
  s_mul_i32 s38, s3, 1310720
  s_lshl_b32 s39, s5, 7
  s_add_u32 s38, s38, s39
  s_add_u32 s12, s40, s38
  s_addc_u32 s13, s41, 0
  s_sub_u32 s14, 5242880, s38
  s_mov_b32 s15, 0x20000
  s_mul_i32 s38, s4, 327680
  s_mul_i32 s33, s6, 1280
  s_add_u32 s38, s38, s33
  s_add_u32 s38, s38, s39
  s_add_u32 s16, s46, s38
  s_addc_u32 s17, s47, 0
  s_sub_u32 s18, 3932160, s38
  s_mov_b32 s19, 0x20000
  v_mov_b32 v6, v2
  v_mov_b32 v7, v1
  s_add_u32 s35, s34, 0
  s_and_b32 s35, s35, 3
  s_add_u32 s35, s35, 0
  s_mul_i32 s35, s35, 40960
  v_add_u32 v2, s35, v6
  s_add_u32 m0, s32, 0
  s_nop 0
  buffer_load_dwordx4 v2, s[12:15], 0 offen lds
  s_add_u32 m0, s32, 1024
  s_nop 0
  buffer_load_dwordx4 v2, s[12:15], s57 offen lds
  s_add_u32 m0, s32, 2048
  s_nop 0
  buffer_load_dwordx4 v2, s[12:15], s58 offen lds
  s_add_u32 m0, s32, 3072
  s_nop 0
  buffer_load_dwordx4 v2, s[12:15], s59 offen lds
  s_add_u32 s35, s34, 0
  s_and_b32 s35, s35, 3
  s_add_u32 s35, s35, 0
  s_lshl_b32 s35, s35, 10
  v_add_u32 v1, s35, v7
  buffer_load_dwordx4 v[8:11], v1, s[8:11], 0 offen
  buffer_load_dwordx4 v[12:15], v1, s[8:11], s49 offen
  buffer_load_dwordx4 v[16:19], v1, s[8:11], s50 offen
  buffer_load_dwordx4 v[20:23], v1, s[8:11], s51 offen
  buffer_load_dwordx4 v[24:27], v1, s[8:11], s52 offen
  buffer_load_dwordx4 v[28:31], v1, s[8:11], s53 offen
  buffer_load_dwordx4 v[32:35], v1, s[8:11], s54 offen
  buffer_load_dwordx4 v[36:39], v1, s[8:11], s55 offen
  s_add_u32 s35, s34, 1
  s_and_b32 s35, s35, 3
  s_add_u32 s35, s35, 0
  s_mul_i32 s35, s35, 40960
  v_add_u32 v2, s35, v6
  s_add_u32 m0, s32, 4096
  s_nop 0
  buffer_load_dwordx4 v2, s[12:15], 0 offen lds
  s_add_u32 m0, s32, 5120
  s_nop 0
  buffer_load_dwordx4 v2, s[12:15], s57 offen lds
  s_add_u32 m0, s32, 6144
  s_nop 0
  buffer_load_dwordx4 v2, s[12:15], s58 offen lds
  s_add_u32 m0, s32, 7168
  s_nop 0
  buffer_load_dwordx4 v2, s[12:15], s59 offen lds
  s_add_u32 s35, s34, 1
  s_and_b32 s35, s35, 3
  s_add_u32 s35, s35, 0
  s_lshl_b32 s35, s35, 10
  v_add_u32 v1, s35, v7
  buffer_load_dwordx4 v[40:43], v1, s[8:11], 0 offen
  buffer_load_dwordx4 v[44:47], v1, s[8:11], s49 offen
  buffer_load_dwordx4 v[48:51], v1, s[8:11], s50 offen
  buffer_load_dwordx4 v[52:55], v1, s[8:11], s51 offen
  buffer_load_dwordx4 v[56:59], v1, s[8:11], s52 offen
  buffer_load_dwordx4 v[60:63], v1, s[8:11], s53 offen
  buffer_load_dwordx4 v[64:67], v1, s[8:11], s54 offen
  buffer_load_dwordx4 v[68:71], v1, s[8:11], s55 offen
  s_waitcnt vmcnt(20)
  ds_read_b64_tr_b16 v[104:105], v3 offset:0
  ds_read_b64_tr_b16 v[106:107], v3 offset:2048
  ds_read_b64_tr_b16 v[108:109], v3 offset:8
  ds_read_b64_tr_b16 v[110:111], v3 offset:2056
  ds_read_b64_tr_b16 v[112:113], v3 offset:512
  ds_read_b64_tr_b16 v[114:115], v3 offset:2560
  ds_read_b64_tr_b16 v[116:117], v3 offset:520
  ds_read_b64_tr_b16 v[118:119], v3 offset:2568
  s_waitcnt vmcnt(8)
  s_waitcnt lgkmcnt(6)
  v_mfma_f32_16x16x32_bf16 a[0:3], v[104:107], v[8:11], 0
  s_add_u32 s35, s34, 2
  s_and_b32 s35, s35, 3
  s_add_u32 s35, s35, 0
  s_mul_i32 s35, s35, 40960
  v_add_u32 v2, s35, v6
  s_add_u32 m0, s32, 8192
  s_nop 0
  buffer_load_dwordx4 v2, s[12:15], 0 offen lds
  v_mfma_f32_16x16x32_bf16 a[4:7], v[104:107], v[12:15], 0
  v_mfma_f32_16x16x32_bf16 a[8:11], v[104:107], v[16:19], 0
  s_add_u32 m0, s32, 9216
  s_nop 0
  buffer_load_dwordx4 v2, s[12:15], s57 offen lds
  v_mfma_f32_16x16x32_bf16 a[12:15], v[104:107], v[20:23], 0
  v_mfma_f32_16x16x32_bf16 a[16:19], v[104:107], v[24:27], 0
  s_add_u32 m0, s32, 10240
  s_nop 0
  buffer_load_dwordx4 v2, s[12:15], s58 offen lds
  v_mfma_f32_16x16x32_bf16 a[20:23], v[104:107], v[28:31], 0
  v_mfma_f32_16x16x32_bf16 a[24:27], v[104:107], v[32:35], 0
  s_add_u32 m0, s32, 11264
  s_nop 0
  buffer_load_dwordx4 v2, s[12:15], s59 offen lds
  v_mfma_f32_16x16x32_bf16 a[28:31], v[104:107], v[36:39], 0
  ds_read_b64_tr_b16 v[104:105], v3 offset:4096
  ds_read_b64_tr_b16 v[106:107], v3 offset:6144
  s_waitcnt lgkmcnt(6)
  v_mfma_f32_16x16x32_bf16 a[32:35], v[108:111], v[8:11], 0
  s_add_u32 s35, s34, 2
  s_and_b32 s35, s35, 3
  s_add_u32 s35, s35, 0
  s_lshl_b32 s35, s35, 10
  v_add_u32 v1, s35, v7
  buffer_load_dwordx4 v[72:75], v1, s[8:11], 0 offen
  v_mfma_f32_16x16x32_bf16 a[36:39], v[108:111], v[12:15], 0
  v_mfma_f32_16x16x32_bf16 a[40:43], v[108:111], v[16:19], 0
  buffer_load_dwordx4 v[76:79], v1, s[8:11], s49 offen
  v_mfma_f32_16x16x32_bf16 a[44:47], v[108:111], v[20:23], 0
  v_mfma_f32_16x16x32_bf16 a[48:51], v[108:111], v[24:27], 0
  buffer_load_dwordx4 v[80:83], v1, s[8:11], s50 offen
  v_mfma_f32_16x16x32_bf16 a[52:55], v[108:111], v[28:31], 0
  v_mfma_f32_16x16x32_bf16 a[56:59], v[108:111], v[32:35], 0
  buffer_load_dwordx4 v[84:87], v1, s[8:11], s51 offen
  v_mfma_f32_16x16x32_bf16 a[60:63], v[108:111], v[36:39], 0
  ds_read_b64_tr_b16 v[108:109], v3 offset:4104
  ds_read_b64_tr_b16 v[110:111], v3 offset:6152
  s_waitcnt lgkmcnt(6)
  v_mfma_f32_16x16x32_bf16 a[64:67], v[112:115], v[8:11], 0
  buffer_load_dwordx4 v[88:91], v1, s[8:11], s52 offen
  v_mfma_f32_16x16x32_bf16 a[68:71], v[112:115], v[12:15], 0
  v_mfma_f32_16x16x32_bf16 a[72:75], v[112:115], v[16:19], 0
  buffer_load_dwordx4 v[92:95], v1, s[8:11], s53 offen
  v_mfma_f32_16x16x32_bf16 a[76:79], v[112:115], v[20:23], 0
  v_mfma_f32_16x16x32_bf16 a[80:83], v[112:115], v[24:27], 0
  buffer_load_dwordx4 v[96:99], v1, s[8:11], s54 offen
  v_mfma_f32_16x16x32_bf16 a[84:87], v[112:115], v[28:31], 0
  v_mfma_f32_16x16x32_bf16 a[88:91], v[112:115], v[32:35], 0
  buffer_load_dwordx4 v[100:103], v1, s[8:11], s55 offen
  v_mfma_f32_16x16x32_bf16 a[92:95], v[112:115], v[36:39], 0
  ds_read_b64_tr_b16 v[112:113], v3 offset:4608
  ds_read_b64_tr_b16 v[114:115], v3 offset:6656
  s_waitcnt lgkmcnt(6)
  v_mfma_f32_16x16x32_bf16 a[96:99], v[116:119], v[8:11], 0
  v_mfma_f32_16x16x32_bf16 a[100:103], v[116:119], v[12:15], 0
  v_mfma_f32_16x16x32_bf16 a[104:107], v[116:119], v[16:19], 0
  v_mfma_f32_16x16x32_bf16 a[108:111], v[116:119], v[20:23], 0
  v_mfma_f32_16x16x32_bf16 a[112:115], v[116:119], v[24:27], 0
  v_mfma_f32_16x16x32_bf16 a[116:119], v[116:119], v[28:31], 0
  v_mfma_f32_16x16x32_bf16 a[120:123], v[116:119], v[32:35], 0
  v_mfma_f32_16x16x32_bf16 a[124:127], v[116:119], v[36:39], 0
  ds_read_b64_tr_b16 v[116:117], v3 offset:4616
  ds_read_b64_tr_b16 v[118:119], v3 offset:6664
  s_waitcnt vmcnt(8)
  s_waitcnt lgkmcnt(6)
  v_mfma_f32_16x16x32_bf16 a[0:3], v[104:107], v[40:43], a[0:3]
  s_add_u32 s35, s34, 3
  s_and_b32 s35, s35, 3
  s_add_u32 s35, s35, 0
  s_mul_i32 s35, s35, 40960
  v_add_u32 v2, s35, v6
  s_add_u32 m0, s32, 12288
  s_nop 0
  buffer_load_dwordx4 v2, s[12:15], 0 offen lds
  v_mfma_f32_16x16x32_bf16 a[4:7], v[104:107], v[44:47], a[4:7]
  v_mfma_f32_16x16x32_bf16 a[8:11], v[104:107], v[48:51], a[8:11]
  s_add_u32 m0, s32, 13312
  s_nop 0
  buffer_load_dwordx4 v2, s[12:15], s57 offen lds
  v_mfma_f32_16x16x32_bf16 a[12:15], v[104:107], v[52:55], a[12:15]
  v_mfma_f32_16x16x32_bf16 a[16:19], v[104:107], v[56:59], a[16:19]
  s_add_u32 m0, s32, 14336
  s_nop 0
  buffer_load_dwordx4 v2, s[12:15], s58 offen lds
  v_mfma_f32_16x16x32_bf16 a[20:23], v[104:107], v[60:63], a[20:23]
  v_mfma_f32_16x16x32_bf16 a[24:27], v[104:107], v[64:67], a[24:27]
  s_add_u32 m0, s32, 15360
  s_nop 0
  buffer_load_dwordx4 v2, s[12:15], s59 offen lds
  v_mfma_f32_16x16x32_bf16 a[28:31], v[104:107], v[68:71], a[28:31]
  ds_read_b64_tr_b16 v[104:105], v3 offset:8192
  ds_read_b64_tr_b16 v[106:107], v3 offset:10240
  s_waitcnt lgkmcnt(6)
  v_mfma_f32_16x16x32_bf16 a[32:35], v[108:111], v[40:43], a[32:35]
  s_add_u32 s35, s34, 3
  s_and_b32 s35, s35, 3
  s_add_u32 s35, s35, 0
  s_lshl_b32 s35, s35, 10
  v_add_u32 v1, s35, v7
  buffer_load_dwordx4 v[8:11], v1, s[8:11], 0 offen
  v_mfma_f32_16x16x32_bf16 a[36:39], v[108:111], v[44:47], a[36:39]
  v_mfma_f32_16x16x32_bf16 a[40:43], v[108:111], v[48:51], a[40:43]
  buffer_load_dwordx4 v[12:15], v1, s[8:11], s49 offen
  v_mfma_f32_16x16x32_bf16 a[44:47], v[108:111], v[52:55], a[44:47]
  v_mfma_f32_16x16x32_bf16 a[48:51], v[108:111], v[56:59], a[48:51]
  buffer_load_dwordx4 v[16:19], v1, s[8:11], s50 offen
  v_mfma_f32_16x16x32_bf16 a[52:55], v[108:111], v[60:63], a[52:55]
  v_mfma_f32_16x16x32_bf16 a[56:59], v[108:111], v[64:67], a[56:59]
  buffer_load_dwordx4 v[20:23], v1, s[8:11], s51 offen
  v_mfma_f32_16x16x32_bf16 a[60:63], v[108:111], v[68:71], a[60:63]
  ds_read_b64_tr_b16 v[108:109], v3 offset:8200
  ds_read_b64_tr_b16 v[110:111], v3 offset:10248
  s_waitcnt lgkmcnt(6)
  v_mfma_f32_16x16x32_bf16 a[64:67], v[112:115], v[40:43], a[64:67]
  buffer_load_dwordx4 v[24:27], v1, s[8:11], s52 offen
  v_mfma_f32_16x16x32_bf16 a[68:71], v[112:115], v[44:47], a[68:71]
  v_mfma_f32_16x16x32_bf16 a[72:75], v[112:115], v[48:51], a[72:75]
  buffer_load_dwordx4 v[28:31], v1, s[8:11], s53 offen
  v_mfma_f32_16x16x32_bf16 a[76:79], v[112:115], v[52:55], a[76:79]
  v_mfma_f32_16x16x32_bf16 a[80:83], v[112:115], v[56:59], a[80:83]
  buffer_load_dwordx4 v[32:35], v1, s[8:11], s54 offen
  v_mfma_f32_16x16x32_bf16 a[84:87], v[112:115], v[60:63], a[84:87]
  v_mfma_f32_16x16x32_bf16 a[88:91], v[112:115], v[64:67], a[88:91]
  buffer_load_dwordx4 v[36:39], v1, s[8:11], s55 offen
  v_mfma_f32_16x16x32_bf16 a[92:95], v[112:115], v[68:71], a[92:95]
  ds_read_b64_tr_b16 v[112:113], v3 offset:8704
  ds_read_b64_tr_b16 v[114:115], v3 offset:10752
  s_waitcnt lgkmcnt(6)
  v_mfma_f32_16x16x32_bf16 a[96:99], v[116:119], v[40:43], a[96:99]
  v_mfma_f32_16x16x32_bf16 a[100:103], v[116:119], v[44:47], a[100:103]
  v_mfma_f32_16x16x32_bf16 a[104:107], v[116:119], v[48:51], a[104:107]
  v_mfma_f32_16x16x32_bf16 a[108:111], v[116:119], v[52:55], a[108:111]
  v_mfma_f32_16x16x32_bf16 a[112:115], v[116:119], v[56:59], a[112:115]
  v_mfma_f32_16x16x32_bf16 a[116:119], v[116:119], v[60:63], a[116:119]
  v_mfma_f32_16x16x32_bf16 a[120:123], v[116:119], v[64:67], a[120:123]
  v_mfma_f32_16x16x32_bf16 a[124:127], v[116:119], v[68:71], a[124:127]
  ds_read_b64_tr_b16 v[116:117], v3 offset:8712
  ds_read_b64_tr_b16 v[118:119], v3 offset:10760
  s_waitcnt vmcnt(8)
  s_waitcnt lgkmcnt(6)
  v_mfma_f32_16x16x32_bf16 a[0:3], v[104:107], v[72:75], a[0:3]
  s_add_u32 s35, s34, 4
  s_and_b32 s35, s35, 3
  s_add_u32 s35, s35, 4
  s_mul_i32 s35, s35, 40960
  v_add_u32 v2, s35, v6
  s_add_u32 m0, s32, 0
  s_nop 0
  buffer_load_dwordx4 v2, s[12:15], 0 offen lds
  v_mfma_f32_16x16x32_bf16 a[4:7], v[104:107], v[76:79], a[4:7]
  v_mfma_f32_16x16x32_bf16 a[8:11], v[104:107], v[80:83], a[8:11]
  s_add_u32 m0, s32, 1024
  s_nop 0
  buffer_load_dwordx4 v2, s[12:15], s57 offen lds
  v_mfma_f32_16x16x32_bf16 a[12:15], v[104:107], v[84:87], a[12:15]
  v_mfma_f32_16x16x32_bf16 a[16:19], v[104:107], v[88:91], a[16:19]
  s_add_u32 m0, s32, 2048
  s_nop 0
  buffer_load_dwordx4 v2, s[12:15], s58 offen lds
  v_mfma_f32_16x16x32_bf16 a[20:23], v[104:107], v[92:95], a[20:23]
  v_mfma_f32_16x16x32_bf16 a[24:27], v[104:107], v[96:99], a[24:27]
  s_add_u32 m0, s32, 3072
  s_nop 0
  buffer_load_dwordx4 v2, s[12:15], s59 offen lds
  v_mfma_f32_16x16x32_bf16 a[28:31], v[104:107], v[100:103], a[28:31]
  ds_read_b64_tr_b16 v[104:105], v3 offset:12288
  ds_read_b64_tr_b16 v[106:107], v3 offset:14336
  s_waitcnt lgkmcnt(6)
  v_mfma_f32_16x16x32_bf16 a[32:35], v[108:111], v[72:75], a[32:35]
  s_add_u32 s35, s34, 4
  s_and_b32 s35, s35, 3
  s_add_u32 s35, s35, 4
  s_lshl_b32 s35, s35, 10
  v_add_u32 v1, s35, v7
  buffer_load_dwordx4 v[40:43], v1, s[8:11], 0 offen
  v_mfma_f32_16x16x32_bf16 a[36:39], v[108:111], v[76:79], a[36:39]
  v_mfma_f32_16x16x32_bf16 a[40:43], v[108:111], v[80:83], a[40:43]
  buffer_load_dwordx4 v[44:47], v1, s[8:11], s49 offen
  v_mfma_f32_16x16x32_bf16 a[44:47], v[108:111], v[84:87], a[44:47]
  v_mfma_f32_16x16x32_bf16 a[48:51], v[108:111], v[88:91], a[48:51]
  buffer_load_dwordx4 v[48:51], v1, s[8:11], s50 offen
  v_mfma_f32_16x16x32_bf16 a[52:55], v[108:111], v[92:95], a[52:55]
  v_mfma_f32_16x16x32_bf16 a[56:59], v[108:111], v[96:99], a[56:59]
  buffer_load_dwordx4 v[52:55], v1, s[8:11], s51 offen
  v_mfma_f32_16x16x32_bf16 a[60:63], v[108:111], v[100:103], a[60:63]
  ds_read_b64_tr_b16 v[108:109], v3 offset:12296
  ds_read_b64_tr_b16 v[110:111], v3 offset:14344
  s_waitcnt lgkmcnt(6)
  v_mfma_f32_16x16x32_bf16 a[64:67], v[112:115], v[72:75], a[64:67]
  buffer_load_dwordx4 v[56:59], v1, s[8:11], s52 offen
  v_mfma_f32_16x16x32_bf16 a[68:71], v[112:115], v[76:79], a[68:71]
  v_mfma_f32_16x16x32_bf16 a[72:75], v[112:115], v[80:83], a[72:75]
  buffer_load_dwordx4 v[60:63], v1, s[8:11], s53 offen
  v_mfma_f32_16x16x32_bf16 a[76:79], v[112:115], v[84:87], a[76:79]
  v_mfma_f32_16x16x32_bf16 a[80:83], v[112:115], v[88:91], a[80:83]
  buffer_load_dwordx4 v[64:67], v1, s[8:11], s54 offen
  v_mfma_f32_16x16x32_bf16 a[84:87], v[112:115], v[92:95], a[84:87]
  v_mfma_f32_16x16x32_bf16 a[88:91], v[112:115], v[96:99], a[88:91]
  buffer_load_dwordx4 v[68:71], v1, s[8:11], s55 offen
  v_mfma_f32_16x16x32_bf16 a[92:95], v[112:115], v[100:103], a[92:95]
  ds_read_b64_tr_b16 v[112:113], v3 offset:12800
  ds_read_b64_tr_b16 v[114:115], v3 offset:14848
  s_waitcnt lgkmcnt(6)
  v_mfma_f32_16x16x32_bf16 a[96:99], v[116:119], v[72:75], a[96:99]
  v_mfma_f32_16x16x32_bf16 a[100:103], v[116:119], v[76:79], a[100:103]
  v_mfma_f32_16x16x32_bf16 a[104:107], v[116:119], v[80:83], a[104:107]
  v_mfma_f32_16x16x32_bf16 a[108:111], v[116:119], v[84:87], a[108:111]
  v_mfma_f32_16x16x32_bf16 a[112:115], v[116:119], v[88:91], a[112:115]
  v_mfma_f32_16x16x32_bf16 a[116:119], v[116:119], v[92:95], a[116:119]
  v_mfma_f32_16x16x32_bf16 a[120:123], v[116:119], v[96:99], a[120:123]
  v_mfma_f32_16x16x32_bf16 a[124:127], v[116:119], v[100:103], a[124:127]
  ds_read_b64_tr_b16 v[116:117], v3 offset:12808
  ds_read_b64_tr_b16 v[118:119], v3 offset:14856
  s_waitcnt vmcnt(8)
  s_waitcnt lgkmcnt(6)
  v_mfma_f32_16x16x32_bf16 a[0:3], v[104:107], v[8:11], a[0:3]
  s_add_u32 s35, s34, 5
  s_and_b32 s35, s35, 3
  s_add_u32 s35, s35, 4
  s_mul_i32 s35, s35, 40960
  v_add_u32 v2, s35, v6
  s_add_u32 m0, s32, 4096
  s_nop 0
  buffer_load_dwordx4 v2, s[12:15], 0 offen lds
  v_mfma_f32_16x16x32_bf16 a[4:7], v[104:107], v[12:15], a[4:7]
  v_mfma_f32_16x16x32_bf16 a[8:11], v[104:107], v[16:19], a[8:11]
  s_add_u32 m0, s32, 5120
  s_nop 0
  buffer_load_dwordx4 v2, s[12:15], s57 offen lds
  v_mfma_f32_16x16x32_bf16 a[12:15], v[104:107], v[20:23], a[12:15]
  v_mfma_f32_16x16x32_bf16 a[16:19], v[104:107], v[24:27], a[16:19]
  s_add_u32 m0, s32, 6144
  s_nop 0
  buffer_load_dwordx4 v2, s[12:15], s58 offen lds
  v_mfma_f32_16x16x32_bf16 a[20:23], v[104:107], v[28:31], a[20:23]
  v_mfma_f32_16x16x32_bf16 a[24:27], v[104:107], v[32:35], a[24:27]
  s_add_u32 m0, s32, 7168
  s_nop 0
  buffer_load_dwordx4 v2, s[12:15], s59 offen lds
  v_mfma_f32_16x16x32_bf16 a[28:31], v[104:107], v[36:39], a[28:31]
  ds_read_b64_tr_b16 v[104:105], v3 offset:0
  ds_read_b64_tr_b16 v[106:107], v3 offset:2048
  s_waitcnt lgkmcnt(6)
  v_mfma_f32_16x16x32_bf16 a[32:35], v[108:111], v[8:11], a[32:35]
  s_add_u32 s35, s34, 5
  s_and_b32 s35, s35, 3
  s_add_u32 s35, s35, 4
  s_lshl_b32 s35, s35, 10
  v_add_u32 v1, s35, v7
  buffer_load_dwordx4 v[72:75], v1, s[8:11], 0 offen
  v_mfma_f32_16x16x32_bf16 a[36:39], v[108:111], v[12:15], a[36:39]
  v_mfma_f32_16x16x32_bf16 a[40:43], v[108:111], v[16:19], a[40:43]
  buffer_load_dwordx4 v[76:79], v1, s[8:11], s49 offen
  v_mfma_f32_16x16x32_bf16 a[44:47], v[108:111], v[20:23], a[44:47]
  v_mfma_f32_16x16x32_bf16 a[48:51], v[108:111], v[24:27], a[48:51]
  buffer_load_dwordx4 v[80:83], v1, s[8:11], s50 offen
  v_mfma_f32_16x16x32_bf16 a[52:55], v[108:111], v[28:31], a[52:55]
  v_mfma_f32_16x16x32_bf16 a[56:59], v[108:111], v[32:35], a[56:59]
  buffer_load_dwordx4 v[84:87], v1, s[8:11], s51 offen
  v_mfma_f32_16x16x32_bf16 a[60:63], v[108:111], v[36:39], a[60:63]
  ds_read_b64_tr_b16 v[108:109], v3 offset:8
  ds_read_b64_tr_b16 v[110:111], v3 offset:2056
  s_waitcnt lgkmcnt(6)
  v_mfma_f32_16x16x32_bf16 a[64:67], v[112:115], v[8:11], a[64:67]
  buffer_load_dwordx4 v[88:91], v1, s[8:11], s52 offen
  v_mfma_f32_16x16x32_bf16 a[68:71], v[112:115], v[12:15], a[68:71]
  v_mfma_f32_16x16x32_bf16 a[72:75], v[112:115], v[16:19], a[72:75]
  buffer_load_dwordx4 v[92:95], v1, s[8:11], s53 offen
  v_mfma_f32_16x16x32_bf16 a[76:79], v[112:115], v[20:23], a[76:79]
  v_mfma_f32_16x16x32_bf16 a[80:83], v[112:115], v[24:27], a[80:83]
  buffer_load_dwordx4 v[96:99], v1, s[8:11], s54 offen
  v_mfma_f32_16x16x32_bf16 a[84:87], v[112:115], v[28:31], a[84:87]
  v_mfma_f32_16x16x32_bf16 a[88:91], v[112:115], v[32:35], a[88:91]
  buffer_load_dwordx4 v[100:103], v1, s[8:11], s55 offen
  v_mfma_f32_16x16x32_bf16 a[92:95], v[112:115], v[36:39], a[92:95]
  ds_read_b64_tr_b16 v[112:113], v3 offset:512
  ds_read_b64_tr_b16 v[114:115], v3 offset:2560
  s_waitcnt lgkmcnt(6)
  v_mfma_f32_16x16x32_bf16 a[96:99], v[116:119], v[8:11], a[96:99]
  v_mfma_f32_16x16x32_bf16 a[100:103], v[116:119], v[12:15], a[100:103]
  v_mfma_f32_16x16x32_bf16 a[104:107], v[116:119], v[16:19], a[104:107]
  v_mfma_f32_16x16x32_bf16 a[108:111], v[116:119], v[20:23], a[108:111]
  v_mfma_f32_16x16x32_bf16 a[112:115], v[116:119], v[24:27], a[112:115]
  v_mfma_f32_16x16x32_bf16 a[116:119], v[116:119], v[28:31], a[116:119]
  v_mfma_f32_16x16x32_bf16 a[120:123], v[116:119], v[32:35], a[120:123]
  v_mfma_f32_16x16x32_bf16 a[124:127], v[116:119], v[36:39], a[124:127]
  ds_read_b64_tr_b16 v[116:117], v3 offset:520
  ds_read_b64_tr_b16 v[118:119], v3 offset:2568
  s_waitcnt vmcnt(8)
  s_waitcnt lgkmcnt(6)
  v_mfma_f32_16x16x32_bf16 a[0:3], v[104:107], v[40:43], a[0:3]
  s_add_u32 s35, s34, 6
  s_and_b32 s35, s35, 3
  s_add_u32 s35, s35, 4
  s_mul_i32 s35, s35, 40960
  v_add_u32 v2, s35, v6
  s_add_u32 m0, s32, 8192
  s_nop 0
  buffer_load_dwordx4 v2, s[12:15], 0 offen lds
  v_mfma_f32_16x16x32_bf16 a[4:7], v[104:107], v[44:47], a[4:7]
  v_mfma_f32_16x16x32_bf16 a[8:11], v[104:107], v[48:51], a[8:11]
  s_add_u32 m0, s32, 9216
  s_nop 0
  buffer_load_dwordx4 v2, s[12:15], s57 offen lds
  v_mfma_f32_16x16x32_bf16 a[12:15], v[104:107], v[52:55], a[12:15]
  v_mfma_f32_16x16x32_bf16 a[16:19], v[104:107], v[56:59], a[16:19]
  s_add_u32 m0, s32, 10240
  s_nop 0
  buffer_load_dwordx4 v2, s[12:15], s58 offen lds
  v_mfma_f32_16x16x32_bf16 a[20:23], v[104:107], v[60:63], a[20:23]
  v_mfma_f32_16x16x32_bf16 a[24:27], v[104:107], v[64:67], a[24:27]
  s_add_u32 m0, s32, 11264
  s_nop 0
  buffer_load_dwordx4 v2, s[12:15], s59 offen lds
  v_mfma_f32_16x16x32_bf16 a[28:31], v[104:107], v[68:71], a[28:31]
  ds_read_b64_tr_b16 v[104:105], v3 offset:4096
  ds_read_b64_tr_b16 v[106:107], v3 offset:6144
  s_waitcnt lgkmcnt(6)
  v_mfma_f32_16x16x32_bf16 a[32:35], v[108:111], v[40:43], a[32:35]
  s_add_u32 s35, s34, 6
  s_and_b32 s35, s35, 3
  s_add_u32 s35, s35, 4
  s_lshl_b32 s35, s35, 10
  v_add_u32 v1, s35, v7
  buffer_load_dwordx4 v[8:11], v1, s[8:11], 0 offen
  v_mfma_f32_16x16x32_bf16 a[36:39], v[108:111], v[44:47], a[36:39]
  v_mfma_f32_16x16x32_bf16 a[40:43], v[108:111], v[48:51], a[40:43]
  buffer_load_dwordx4 v[12:15], v1, s[8:11], s49 offen
  v_mfma_f32_16x16x32_bf16 a[44:47], v[108:111], v[52:55], a[44:47]
  v_mfma_f32_16x16x32_bf16 a[48:51], v[108:111], v[56:59], a[48:51]
  buffer_load_dwordx4 v[16:19], v1, s[8:11], s50 offen
  v_mfma_f32_16x16x32_bf16 a[52:55], v[108:111], v[60:63], a[52:55]
  v_mfma_f32_16x16x32_bf16 a[56:59], v[108:111], v[64:67], a[56:59]
  buffer_load_dwordx4 v[20:23], v1, s[8:11], s51 offen
  v_mfma_f32_16x16x32_bf16 a[60:63], v[108:111], v[68:71], a[60:63]
  ds_read_b64_tr_b16 v[108:109], v3 offset:4104
  ds_read_b64_tr_b16 v[110:111], v3 offset:6152
  s_waitcnt lgkmcnt(6)
  v_mfma_f32_16x16x32_bf16 a[64:67], v[112:115], v[40:43], a[64:67]
  buffer_load_dwordx4 v[24:27], v1, s[8:11], s52 offen
  v_mfma_f32_16x16x32_bf16 a[68:71], v[112:115], v[44:47], a[68:71]
  v_mfma_f32_16x16x32_bf16 a[72:75], v[112:115], v[48:51], a[72:75]
  buffer_load_dwordx4 v[28:31], v1, s[8:11], s53 offen
  v_mfma_f32_16x16x32_bf16 a[76:79], v[112:115], v[52:55], a[76:79]
  v_mfma_f32_16x16x32_bf16 a[80:83], v[112:115], v[56:59], a[80:83]
  buffer_load_dwordx4 v[32:35], v1, s[8:11], s54 offen
  v_mfma_f32_16x16x32_bf16 a[84:87], v[112:115], v[60:63], a[84:87]
  v_mfma_f32_16x16x32_bf16 a[88:91], v[112:115], v[64:67], a[88:91]
  buffer_load_dwordx4 v[36:39], v1, s[8:11], s55 offen
  v_mfma_f32_16x16x32_bf16 a[92:95], v[112:115], v[68:71], a[92:95]
  ds_read_b64_tr_b16 v[112:113], v3 offset:4608
  ds_read_b64_tr_b16 v[114:115], v3 offset:6656
  s_waitcnt lgkmcnt(6)
  v_mfma_f32_16x16x32_bf16 a[96:99], v[116:119], v[40:43], a[96:99]
  v_mfma_f32_16x16x32_bf16 a[100:103], v[116:119], v[44:47], a[100:103]
  v_mfma_f32_16x16x32_bf16 a[104:107], v[116:119], v[48:51], a[104:107]
  v_mfma_f32_16x16x32_bf16 a[108:111], v[116:119], v[52:55], a[108:111]
  v_mfma_f32_16x16x32_bf16 a[112:115], v[116:119], v[56:59], a[112:115]
  v_mfma_f32_16x16x32_bf16 a[116:119], v[116:119], v[60:63], a[116:119]
  v_mfma_f32_16x16x32_bf16 a[120:123], v[116:119], v[64:67], a[120:123]
  v_mfma_f32_16x16x32_bf16 a[124:127], v[116:119], v[68:71], a[124:127]
  ds_read_b64_tr_b16 v[116:117], v3 offset:4616
  ds_read_b64_tr_b16 v[118:119], v3 offset:6664
  s_waitcnt vmcnt(8)
  s_waitcnt lgkmcnt(6)
  v_mfma_f32_16x16x32_bf16 a[0:3], v[104:107], v[72:75], a[0:3]
  s_add_u32 s35, s34, 7
  s_and_b32 s35, s35, 3
  s_add_u32 s35, s35, 4
  s_mul_i32 s35, s35, 40960
  v_add_u32 v2, s35, v6
  s_add_u32 m0, s32, 12288
  s_nop 0
  buffer_load_dwordx4 v2, s[12:15], 0 offen lds
  v_mfma_f32_16x16x32_bf16 a[4:7], v[104:107], v[76:79], a[4:7]
  v_mfma_f32_16x16x32_bf16 a[8:11], v[104:107], v[80:83], a[8:11]
  s_add_u32 m0, s32, 13312
  s_nop 0
  buffer_load_dwordx4 v2, s[12:15], s57 offen lds
  v_mfma_f32_16x16x32_bf16 a[12:15], v[104:107], v[84:87], a[12:15]
  v_mfma_f32_16x16x32_bf16 a[16:19], v[104:107], v[88:91], a[16:19]
  s_add_u32 m0, s32, 14336
  s_nop 0
  buffer_load_dwordx4 v2, s[12:15], s58 offen lds
  v_mfma_f32_16x16x32_bf16 a[20:23], v[104:107], v[92:95], a[20:23]
  v_mfma_f32_16x16x32_bf16 a[24:27], v[104:107], v[96:99], a[24:27]
  s_add_u32 m0, s32, 15360
  s_nop 0
  buffer_load_dwordx4 v2, s[12:15], s59 offen lds
  v_mfma_f32_16x16x32_bf16 a[28:31], v[104:107], v[100:103], a[28:31]
  ds_read_b64_tr_b16 v[104:105], v3 offset:8192
  ds_read_b64_tr_b16 v[106:107], v3 offset:10240
  s_waitcnt lgkmcnt(6)
  v_mfma_f32_16x16x32_bf16 a[32:35], v[108:111], v[72:75], a[32:35]
  s_add_u32 s35, s34, 7
  s_and_b32 s35, s35, 3
  s_add_u32 s35, s35, 4
  s_lshl_b32 s35, s35, 10
  v_add_u32 v1, s35, v7
  buffer_load_dwordx4 v[40:43], v1, s[8:11], 0 offen
  v_mfma_f32_16x16x32_bf16 a[36:39], v[108:111], v[76:79], a[36:39]
  v_mfma_f32_16x16x32_bf16 a[40:43], v[108:111], v[80:83], a[40:43]
  buffer_load_dwordx4 v[44:47], v1, s[8:11], s49 offen
  v_mfma_f32_16x16x32_bf16 a[44:47], v[108:111], v[84:87], a[44:47]
  v_mfma_f32_16x16x32_bf16 a[48:51], v[108:111], v[88:91], a[48:51]
  buffer_load_dwordx4 v[48:51], v1, s[8:11], s50 offen
  v_mfma_f32_16x16x32_bf16 a[52:55], v[108:111], v[92:95], a[52:55]
  v_mfma_f32_16x16x32_bf16 a[56:59], v[108:111], v[96:99], a[56:59]
  buffer_load_dwordx4 v[52:55], v1, s[8:11], s51 offen
  v_mfma_f32_16x16x32_bf16 a[60:63], v[108:111], v[100:103], a[60:63]
  ds_read_b64_tr_b16 v[108:109], v3 offset:8200
  ds_read_b64_tr_b16 v[110:111], v3 offset:10248
  s_waitcnt lgkmcnt(6)
  v_mfma_f32_16x16x32_bf16 a[64:67], v[112:115], v[72:75], a[64:67]
  buffer_load_dwordx4 v[56:59], v1, s[8:11], s52 offen
  v_mfma_f32_16x16x32_bf16 a[68:71], v[112:115], v[76:79], a[68:71]
  v_mfma_f32_16x16x32_bf16 a[72:75], v[112:115], v[80:83], a[72:75]
  buffer_load_dwordx4 v[60:63], v1, s[8:11], s53 offen
  v_mfma_f32_16x16x32_bf16 a[76:79], v[112:115], v[84:87], a[76:79]
  v_mfma_f32_16x16x32_bf16 a[80:83], v[112:115], v[88:91], a[80:83]
  buffer_load_dwordx4 v[64:67], v1, s[8:11], s54 offen
  v_mfma_f32_16x16x32_bf16 a[84:87], v[112:115], v[92:95], a[84:87]
  v_mfma_f32_16x16x32_bf16 a[88:91], v[112:115], v[96:99], a[88:91]
  buffer_load_dwordx4 v[68:71], v1, s[8:11], s55 offen
  v_mfma_f32_16x16x32_bf16 a[92:95], v[112:115], v[100:103], a[92:95]
  ds_read_b64_tr_b16 v[112:113], v3 offset:8704
  ds_read_b64_tr_b16 v[114:115], v3 offset:10752
  s_waitcnt lgkmcnt(6)
  v_mfma_f32_16x16x32_bf16 a[96:99], v[116:119], v[72:75], a[96:99]
  v_mfma_f32_16x16x32_bf16 a[100:103], v[116:119], v[76:79], a[100:103]
  v_mfma_f32_16x16x32_bf16 a[104:107], v[116:119], v[80:83], a[104:107]
  v_mfma_f32_16x16x32_bf16 a[108:111], v[116:119], v[84:87], a[108:111]
  v_mfma_f32_16x16x32_bf16 a[112:115], v[116:119], v[88:91], a[112:115]
  v_mfma_f32_16x16x32_bf16 a[116:119], v[116:119], v[92:95], a[116:119]
  v_mfma_f32_16x16x32_bf16 a[120:123], v[116:119], v[96:99], a[120:123]
  v_mfma_f32_16x16x32_bf16 a[124:127], v[116:119], v[100:103], a[124:127]
  ds_read_b64_tr_b16 v[116:117], v3 offset:8712
  ds_read_b64_tr_b16 v[118:119], v3 offset:10760
  s_waitcnt vmcnt(8)
  s_waitcnt lgkmcnt(6)
  v_mfma_f32_16x16x32_bf16 a[0:3], v[104:107], v[8:11], a[0:3]
  s_add_u32 s35, s34, 8
  s_and_b32 s35, s35, 3
  s_add_u32 s35, s35, 8
  s_mul_i32 s35, s35, 40960
  v_add_u32 v2, s35, v6
  s_add_u32 m0, s32, 0
  s_nop 0
  buffer_load_dwordx4 v2, s[12:15], 0 offen lds
  v_mfma_f32_16x16x32_bf16 a[4:7], v[104:107], v[12:15], a[4:7]
  v_mfma_f32_16x16x32_bf16 a[8:11], v[104:107], v[16:19], a[8:11]
  s_add_u32 m0, s32, 1024
  s_nop 0
  buffer_load_dwordx4 v2, s[12:15], s57 offen lds
  v_mfma_f32_16x16x32_bf16 a[12:15], v[104:107], v[20:23], a[12:15]
  v_mfma_f32_16x16x32_bf16 a[16:19], v[104:107], v[24:27], a[16:19]
  s_add_u32 m0, s32, 2048
  s_nop 0
  buffer_load_dwordx4 v2, s[12:15], s58 offen lds
  v_mfma_f32_16x16x32_bf16 a[20:23], v[104:107], v[28:31], a[20:23]
  v_mfma_f32_16x16x32_bf16 a[24:27], v[104:107], v[32:35], a[24:27]
  s_add_u32 m0, s32, 3072
  s_nop 0
  buffer_load_dwordx4 v2, s[12:15], s59 offen lds
  v_mfma_f32_16x16x32_bf16 a[28:31], v[104:107], v[36:39], a[28:31]
  ds_read_b64_tr_b16 v[104:105], v3 offset:12288
  ds_read_b64_tr_b16 v[106:107], v3 offset:14336
  s_waitcnt lgkmcnt(6)
  v_mfma_f32_16x16x32_bf16 a[32:35], v[108:111], v[8:11], a[32:35]
  s_add_u32 s35, s34, 8
  s_and_b32 s35, s35, 3
  s_add_u32 s35, s35, 8
  s_lshl_b32 s35, s35, 10
  v_add_u32 v1, s35, v7
  buffer_load_dwordx4 v[72:75], v1, s[8:11], 0 offen
  v_mfma_f32_16x16x32_bf16 a[36:39], v[108:111], v[12:15], a[36:39]
  v_mfma_f32_16x16x32_bf16 a[40:43], v[108:111], v[16:19], a[40:43]
  buffer_load_dwordx4 v[76:79], v1, s[8:11], s49 offen
  v_mfma_f32_16x16x32_bf16 a[44:47], v[108:111], v[20:23], a[44:47]
  v_mfma_f32_16x16x32_bf16 a[48:51], v[108:111], v[24:27], a[48:51]
  buffer_load_dwordx4 v[80:83], v1, s[8:11], s50 offen
  v_mfma_f32_16x16x32_bf16 a[52:55], v[108:111], v[28:31], a[52:55]
  v_mfma_f32_16x16x32_bf16 a[56:59], v[108:111], v[32:35], a[56:59]
  buffer_load_dwordx4 v[84:87], v1, s[8:11], s51 offen
  v_mfma_f32_16x16x32_bf16 a[60:63], v[108:111], v[36:39], a[60:63]
  ds_read_b64_tr_b16 v[108:109], v3 offset:12296
  ds_read_b64_tr_b16 v[110:111], v3 offset:14344
  s_waitcnt lgkmcnt(6)
  v_mfma_f32_16x16x32_bf16 a[64:67], v[112:115], v[8:11], a[64:67]
  buffer_load_dwordx4 v[88:91], v1, s[8:11], s52 offen
  v_mfma_f32_16x16x32_bf16 a[68:71], v[112:115], v[12:15], a[68:71]
  v_mfma_f32_16x16x32_bf16 a[72:75], v[112:115], v[16:19], a[72:75]
  buffer_load_dwordx4 v[92:95], v1, s[8:11], s53 offen
  v_mfma_f32_16x16x32_bf16 a[76:79], v[112:115], v[20:23], a[76:79]
  v_mfma_f32_16x16x32_bf16 a[80:83], v[112:115], v[24:27], a[80:83]
  buffer_load_dwordx4 v[96:99], v1, s[8:11], s54 offen
  v_mfma_f32_16x16x32_bf16 a[84:87], v[112:115], v[28:31], a[84:87]
  v_mfma_f32_16x16x32_bf16 a[88:91], v[112:115], v[32:35], a[88:91]
  buffer_load_dwordx4 v[100:103], v1, s[8:11], s55 offen
  v_mfma_f32_16x16x32_bf16 a[92:95], v[112:115], v[36:39], a[92:95]
  ds_read_b64_tr_b16 v[112:113], v3 offset:12800
  ds_read_b64_tr_b16 v[114:115], v3 offset:14848
  s_waitcnt lgkmcnt(6)
  v_mfma_f32_16x16x32_bf16 a[96:99], v[116:119], v[8:11], a[96:99]
  v_mfma_f32_16x16x32_bf16 a[100:103], v[116:119], v[12:15], a[100:103]
  v_mfma_f32_16x16x32_bf16 a[104:107], v[116:119], v[16:19], a[104:107]
  v_mfma_f32_16x16x32_bf16 a[108:111], v[116:119], v[20:23], a[108:111]
  v_mfma_f32_16x16x32_bf16 a[112:115], v[116:119], v[24:27], a[112:115]
  v_mfma_f32_16x16x32_bf16 a[116:119], v[116:119], v[28:31], a[116:119]
  v_mfma_f32_16x16x32_bf16 a[120:123], v[116:119], v[32:35], a[120:123]
  v_mfma_f32_16x16x32_bf16 a[124:127], v[116:119], v[36:39], a[124:127]
  ds_read_b64_tr_b16 v[116:117], v3 offset:12808
  ds_read_b64_tr_b16 v[118:119], v3 offset:14856
  s_waitcnt vmcnt(8)
  s_waitcnt lgkmcnt(6)
  v_mfma_f32_16x16x32_bf16 a[0:3], v[104:107], v[40:43], a[0:3]
  s_add_u32 s35, s34, 9
  s_and_b32 s35, s35, 3
  s_add_u32 s35, s35, 8
  s_mul_i32 s35, s35, 40960
  v_add_u32 v2, s35, v6
  s_add_u32 m0, s32, 4096
  s_nop 0
  buffer_load_dwordx4 v2, s[12:15], 0 offen lds
  v_mfma_f32_16x16x32_bf16 a[4:7], v[104:107], v[44:47], a[4:7]
  v_mfma_f32_16x16x32_bf16 a[8:11], v[104:107], v[48:51], a[8:11]
  s_add_u32 m0, s32, 5120
  s_nop 0
  buffer_load_dwordx4 v2, s[12:15], s57 offen lds
  v_mfma_f32_16x16x32_bf16 a[12:15], v[104:107], v[52:55], a[12:15]
  v_mfma_f32_16x16x32_bf16 a[16:19], v[104:107], v[56:59], a[16:19]
  s_add_u32 m0, s32, 6144
  s_nop 0
  buffer_load_dwordx4 v2, s[12:15], s58 offen lds
  v_mfma_f32_16x16x32_bf16 a[20:23], v[104:107], v[60:63], a[20:23]
  v_mfma_f32_16x16x32_bf16 a[24:27], v[104:107], v[64:67], a[24:27]
  s_add_u32 m0, s32, 7168
  s_nop 0
  buffer_load_dwordx4 v2, s[12:15], s59 offen lds
  v_mfma_f32_16x16x32_bf16 a[28:31], v[104:107], v[68:71], a[28:31]
  ds_read_b64_tr_b16 v[104:105], v3 offset:0
  ds_read_b64_tr_b16 v[106:107], v3 offset:2048
  s_waitcnt lgkmcnt(6)
  v_mfma_f32_16x16x32_bf16 a[32:35], v[108:111], v[40:43], a[32:35]
  s_add_u32 s35, s34, 9
  s_and_b32 s35, s35, 3
  s_add_u32 s35, s35, 8
  s_lshl_b32 s35, s35, 10
  v_add_u32 v1, s35, v7
  buffer_load_dwordx4 v[8:11], v1, s[8:11], 0 offen
  v_mfma_f32_16x16x32_bf16 a[36:39], v[108:111], v[44:47], a[36:39]
  v_mfma_f32_16x16x32_bf16 a[40:43], v[108:111], v[48:51], a[40:43]
  buffer_load_dwordx4 v[12:15], v1, s[8:11], s49 offen
  v_mfma_f32_16x16x32_bf16 a[44:47], v[108:111], v[52:55], a[44:47]
  v_mfma_f32_16x16x32_bf16 a[48:51], v[108:111], v[56:59], a[48:51]
  buffer_load_dwordx4 v[16:19], v1, s[8:11], s50 offen
  v_mfma_f32_16x16x32_bf16 a[52:55], v[108:111], v[60:63], a[52:55]
  v_mfma_f32_16x16x32_bf16 a[56:59], v[108:111], v[64:67], a[56:59]
  buffer_load_dwordx4 v[20:23], v1, s[8:11], s51 offen
  v_mfma_f32_16x16x32_bf16 a[60:63], v[108:111], v[68:71], a[60:63]
  ds_read_b64_tr_b16 v[108:109], v3 offset:8
  ds_read_b64_tr_b16 v[110:111], v3 offset:2056
  s_waitcnt lgkmcnt(6)
  v_mfma_f32_16x16x32_bf16 a[64:67], v[112:115], v[40:43], a[64:67]
  buffer_load_dwordx4 v[24:27], v1, s[8:11], s52 offen
  v_mfma_f32_16x16x32_bf16 a[68:71], v[112:115], v[44:47], a[68:71]
  v_mfma_f32_16x16x32_bf16 a[72:75], v[112:115], v[48:51], a[72:75]
  buffer_load_dwordx4 v[28:31], v1, s[8:11], s53 offen
  v_mfma_f32_16x16x32_bf16 a[76:79], v[112:115], v[52:55], a[76:79]
  v_mfma_f32_16x16x32_bf16 a[80:83], v[112:115], v[56:59], a[80:83]
  buffer_load_dwordx4 v[32:35], v1, s[8:11], s54 offen
  v_mfma_f32_16x16x32_bf16 a[84:87], v[112:115], v[60:63], a[84:87]
  v_mfma_f32_16x16x32_bf16 a[88:91], v[112:115], v[64:67], a[88:91]
  buffer_load_dwordx4 v[36:39], v1, s[8:11], s55 offen
  v_mfma_f32_16x16x32_bf16 a[92:95], v[112:115], v[68:71], a[92:95]
  ds_read_b64_tr_b16 v[112:113], v3 offset:512
  ds_read_b64_tr_b16 v[114:115], v3 offset:2560
  s_waitcnt lgkmcnt(6)
  v_mfma_f32_16x16x32_bf16 a[96:99], v[116:119], v[40:43], a[96:99]
  v_mfma_f32_16x16x32_bf16 a[100:103], v[116:119], v[44:47], a[100:103]
  v_mfma_f32_16x16x32_bf16 a[104:107], v[116:119], v[48:51], a[104:107]
  v_mfma_f32_16x16x32_bf16 a[108:111], v[116:119], v[52:55], a[108:111]
  v_mfma_f32_16x16x32_bf16 a[112:115], v[116:119], v[56:59], a[112:115]
  v_mfma_f32_16x16x32_bf16 a[116:119], v[116:119], v[60:63], a[116:119]
  v_mfma_f32_16x16x32_bf16 a[120:123], v[116:119], v[64:67], a[120:123]
  v_mfma_f32_16x16x32_bf16 a[124:127], v[116:119], v[68:71], a[124:127]
  ds_read_b64_tr_b16 v[116:117], v3 offset:520
  ds_read_b64_tr_b16 v[118:119], v3 offset:2568
  s_waitcnt vmcnt(8)
  s_waitcnt lgkmcnt(6)
  v_mfma_f32_16x16x32_bf16 a[0:3], v[104:107], v[72:75], a[0:3]
  s_add_u32 s35, s34, 10
  s_and_b32 s35, s35, 3
  s_add_u32 s35, s35, 8
  s_mul_i32 s35, s35, 40960
  v_add_u32 v2, s35, v6
  s_add_u32 m0, s32, 8192
  s_nop 0
  buffer_load_dwordx4 v2, s[12:15], 0 offen lds
  v_mfma_f32_16x16x32_bf16 a[4:7], v[104:107], v[76:79], a[4:7]
  v_mfma_f32_16x16x32_bf16 a[8:11], v[104:107], v[80:83], a[8:11]
  s_add_u32 m0, s32, 9216
  s_nop 0
  buffer_load_dwordx4 v2, s[12:15], s57 offen lds
  v_mfma_f32_16x16x32_bf16 a[12:15], v[104:107], v[84:87], a[12:15]
  v_mfma_f32_16x16x32_bf16 a[16:19], v[104:107], v[88:91], a[16:19]
  s_add_u32 m0, s32, 10240
  s_nop 0
  buffer_load_dwordx4 v2, s[12:15], s58 offen lds
  v_mfma_f32_16x16x32_bf16 a[20:23], v[104:107], v[92:95], a[20:23]
  v_mfma_f32_16x16x32_bf16 a[24:27], v[104:107], v[96:99], a[24:27]
  s_add_u32 m0, s32, 11264
  s_nop 0
  buffer_load_dwordx4 v2, s[12:15], s59 offen lds
  v_mfma_f32_16x16x32_bf16 a[28:31], v[104:107], v[100:103], a[28:31]
  ds_read_b64_tr_b16 v[104:105], v3 offset:4096
  ds_read_b64_tr_b16 v[106:107], v3 offset:6144
  s_waitcnt lgkmcnt(6)
  v_mfma_f32_16x16x32_bf16 a[32:35], v[108:111], v[72:75], a[32:35]
  s_add_u32 s35, s34, 10
  s_and_b32 s35, s35, 3
  s_add_u32 s35, s35, 8
  s_lshl_b32 s35, s35, 10
  v_add_u32 v1, s35, v7
  buffer_load_dwordx4 v[40:43], v1, s[8:11], 0 offen
  v_mfma_f32_16x16x32_bf16 a[36:39], v[108:111], v[76:79], a[36:39]
  v_mfma_f32_16x16x32_bf16 a[40:43], v[108:111], v[80:83], a[40:43]
  buffer_load_dwordx4 v[44:47], v1, s[8:11], s49 offen
  v_mfma_f32_16x16x32_bf16 a[44:47], v[108:111], v[84:87], a[44:47]
  v_mfma_f32_16x16x32_bf16 a[48:51], v[108:111], v[88:91], a[48:51]
  buffer_load_dwordx4 v[48:51], v1, s[8:11], s50 offen
  v_mfma_f32_16x16x32_bf16 a[52:55], v[108:111], v[92:95], a[52:55]
  v_mfma_f32_16x16x32_bf16 a[56:59], v[108:111], v[96:99], a[56:59]
  buffer_load_dwordx4 v[52:55], v1, s[8:11], s51 offen
  v_mfma_f32_16x16x32_bf16 a[60:63], v[108:111], v[100:103], a[60:63]
  ds_read_b64_tr_b16 v[108:109], v3 offset:4104
  ds_read_b64_tr_b16 v[110:111], v3 offset:6152
  s_waitcnt lgkmcnt(6)
  v_mfma_f32_16x16x32_bf16 a[64:67], v[112:115], v[72:75], a[64:67]
  buffer_load_dwordx4 v[56:59], v1, s[8:11], s52 offen
  v_mfma_f32_16x16x32_bf16 a[68:71], v[112:115], v[76:79], a[68:71]
  v_mfma_f32_16x16x32_bf16 a[72:75], v[112:115], v[80:83], a[72:75]
  buffer_load_dwordx4 v[60:63], v1, s[8:11], s53 offen
  v_mfma_f32_16x16x32_bf16 a[76:79], v[112:115], v[84:87], a[76:79]
  v_mfma_f32_16x16x32_bf16 a[80:83], v[112:115], v[88:91], a[80:83]
  buffer_load_dwordx4 v[64:67], v1, s[8:11], s54 offen
  v_mfma_f32_16x16x32_bf16 a[84:87], v[112:115], v[92:95], a[84:87]
  v_mfma_f32_16x16x32_bf16 a[88:91], v[112:115], v[96:99], a[88:91]
  buffer_load_dwordx4 v[68:71], v1, s[8:11], s55 offen
  v_mfma_f32_16x16x32_bf16 a[92:95], v[112:115], v[100:103], a[92:95]
  ds_read_b64_tr_b16 v[112:113], v3 offset:4608
  ds_read_b64_tr_b16 v[114:115], v3 offset:6656
  s_waitcnt lgkmcnt(6)
  v_mfma_f32_16x16x32_bf16 a[96:99], v[116:119], v[72:75], a[96:99]
  v_mfma_f32_16x16x32_bf16 a[100:103], v[116:119], v[76:79], a[100:103]
  v_mfma_f32_16x16x32_bf16 a[104:107], v[116:119], v[80:83], a[104:107]
  v_mfma_f32_16x16x32_bf16 a[108:111], v[116:119], v[84:87], a[108:111]
  v_mfma_f32_16x16x32_bf16 a[112:115], v[116:119], v[88:91], a[112:115]
  v_mfma_f32_16x16x32_bf16 a[116:119], v[116:119], v[92:95], a[116:119]
  v_mfma_f32_16x16x32_bf16 a[120:123], v[116:119], v[96:99], a[120:123]
  v_mfma_f32_16x16x32_bf16 a[124:127], v[116:119], v[100:103], a[124:127]
  ds_read_b64_tr_b16 v[116:117], v3 offset:4616
  ds_read_b64_tr_b16 v[118:119], v3 offset:6664
  s_waitcnt vmcnt(8)
  s_waitcnt lgkmcnt(6)
  v_mfma_f32_16x16x32_bf16 a[0:3], v[104:107], v[8:11], a[0:3]
  s_add_u32 s35, s34, 11
  s_and_b32 s35, s35, 3
  s_add_u32 s35, s35, 8
  s_mul_i32 s35, s35, 40960
  v_add_u32 v2, s35, v6
  s_add_u32 m0, s32, 12288
  s_nop 0
  buffer_load_dwordx4 v2, s[12:15], 0 offen lds
  v_mfma_f32_16x16x32_bf16 a[4:7], v[104:107], v[12:15], a[4:7]
  v_mfma_f32_16x16x32_bf16 a[8:11], v[104:107], v[16:19], a[8:11]
  s_add_u32 m0, s32, 13312
  s_nop 0
  buffer_load_dwordx4 v2, s[12:15], s57 offen lds
  v_mfma_f32_16x16x32_bf16 a[12:15], v[104:107], v[20:23], a[12:15]
  v_mfma_f32_16x16x32_bf16 a[16:19], v[104:107], v[24:27], a[16:19]
  s_add_u32 m0, s32, 14336
  s_nop 0
  buffer_load_dwordx4 v2, s[12:15], s58 offen lds
  v_mfma_f32_16x16x32_bf16 a[20:23], v[104:107], v[28:31], a[20:23]
  v_mfma_f32_16x16x32_bf16 a[24:27], v[104:107], v[32:35], a[24:27]
  s_add_u32 m0, s32, 15360
  s_nop 0
  buffer_load_dwordx4 v2, s[12:15], s59 offen lds
  v_mfma_f32_16x16x32_bf16 a[28:31], v[104:107], v[36:39], a[28:31]
  ds_read_b64_tr_b16 v[104:105], v3 offset:8192
  ds_read_b64_tr_b16 v[106:107], v3 offset:10240
  s_waitcnt lgkmcnt(6)
  v_mfma_f32_16x16x32_bf16 a[32:35], v[108:111], v[8:11], a[32:35]
  s_add_u32 s35, s34, 11
  s_and_b32 s35, s35, 3
  s_add_u32 s35, s35, 8
  s_lshl_b32 s35, s35, 10
  v_add_u32 v1, s35, v7
  buffer_load_dwordx4 v[72:75], v1, s[8:11], 0 offen
  v_mfma_f32_16x16x32_bf16 a[36:39], v[108:111], v[12:15], a[36:39]
  v_mfma_f32_16x16x32_bf16 a[40:43], v[108:111], v[16:19], a[40:43]
  buffer_load_dwordx4 v[76:79], v1, s[8:11], s49 offen
  v_mfma_f32_16x16x32_bf16 a[44:47], v[108:111], v[20:23], a[44:47]
  v_mfma_f32_16x16x32_bf16 a[48:51], v[108:111], v[24:27], a[48:51]
  buffer_load_dwordx4 v[80:83], v1, s[8:11], s50 offen
  v_mfma_f32_16x16x32_bf16 a[52:55], v[108:111], v[28:31], a[52:55]
  v_mfma_f32_16x16x32_bf16 a[56:59], v[108:111], v[32:35], a[56:59]
  buffer_load_dwordx4 v[84:87], v1, s[8:11], s51 offen
  v_mfma_f32_16x16x32_bf16 a[60:63], v[108:111], v[36:39], a[60:63]
  ds_read_b64_tr_b16 v[108:109], v3 offset:8200
  ds_read_b64_tr_b16 v[110:111], v3 offset:10248
  s_waitcnt lgkmcnt(6)
  v_mfma_f32_16x16x32_bf16 a[64:67], v[112:115], v[8:11], a[64:67]
  buffer_load_dwordx4 v[88:91], v1, s[8:11], s52 offen
  v_mfma_f32_16x16x32_bf16 a[68:71], v[112:115], v[12:15], a[68:71]
  v_mfma_f32_16x16x32_bf16 a[72:75], v[112:115], v[16:19], a[72:75]
  buffer_load_dwordx4 v[92:95], v1, s[8:11], s53 offen
  v_mfma_f32_16x16x32_bf16 a[76:79], v[112:115], v[20:23], a[76:79]
  v_mfma_f32_16x16x32_bf16 a[80:83], v[112:115], v[24:27], a[80:83]
  buffer_load_dwordx4 v[96:99], v1, s[8:11], s54 offen
  v_mfma_f32_16x16x32_bf16 a[84:87], v[112:115], v[28:31], a[84:87]
  v_mfma_f32_16x16x32_bf16 a[88:91], v[112:115], v[32:35], a[88:91]
  buffer_load_dwordx4 v[100:103], v1, s[8:11], s55 offen
  v_mfma_f32_16x16x32_bf16 a[92:95], v[112:115], v[36:39], a[92:95]
  ds_read_b64_tr_b16 v[112:113], v3 offset:8704
  ds_read_b64_tr_b16 v[114:115], v3 offset:10752
  s_waitcnt lgkmcnt(6)
  v_mfma_f32_16x16x32_bf16 a[96:99], v[116:119], v[8:11], a[96:99]
  v_mfma_f32_16x16x32_bf16 a[100:103], v[116:119], v[12:15], a[100:103]
  v_mfma_f32_16x16x32_bf16 a[104:107], v[116:119], v[16:19], a[104:107]
  v_mfma_f32_16x16x32_bf16 a[108:111], v[116:119], v[20:23], a[108:111]
  v_mfma_f32_16x16x32_bf16 a[112:115], v[116:119], v[24:27], a[112:115]
  v_mfma_f32_16x16x32_bf16 a[116:119], v[116:119], v[28:31], a[116:119]
  v_mfma_f32_16x16x32_bf16 a[120:123], v[116:119], v[32:35], a[120:123]
  v_mfma_f32_16x16x32_bf16 a[124:127], v[116:119], v[36:39], a[124:127]
  ds_read_b64_tr_b16 v[116:117], v3 offset:8712
  ds_read_b64_tr_b16 v[118:119], v3 offset:10760
  s_waitcnt vmcnt(8)
  s_waitcnt lgkmcnt(6)
  v_mfma_f32_16x16x32_bf16 a[0:3], v[104:107], v[40:43], a[0:3]
  s_add_u32 s35, s34, 12
  s_and_b32 s35, s35, 3
  s_add_u32 s35, s35, 12
  s_mul_i32 s35, s35, 40960
  v_add_u32 v2, s35, v6
  s_add_u32 m0, s32, 0
  s_nop 0
  buffer_load_dwordx4 v2, s[12:15], 0 offen lds
  v_mfma_f32_16x16x32_bf16 a[4:7], v[104:107], v[44:47], a[4:7]
  v_mfma_f32_16x16x32_bf16 a[8:11], v[104:107], v[48:51], a[8:11]
  s_add_u32 m0, s32, 1024
  s_nop 0
  buffer_load_dwordx4 v2, s[12:15], s57 offen lds
  v_mfma_f32_16x16x32_bf16 a[12:15], v[104:107], v[52:55], a[12:15]
  v_mfma_f32_16x16x32_bf16 a[16:19], v[104:107], v[56:59], a[16:19]
  s_add_u32 m0, s32, 2048
  s_nop 0
  buffer_load_dwordx4 v2, s[12:15], s58 offen lds
  v_mfma_f32_16x16x32_bf16 a[20:23], v[104:107], v[60:63], a[20:23]
  v_mfma_f32_16x16x32_bf16 a[24:27], v[104:107], v[64:67], a[24:27]
  s_add_u32 m0, s32, 3072
  s_nop 0
  buffer_load_dwordx4 v2, s[12:15], s59 offen lds
  v_mfma_f32_16x16x32_bf16 a[28:31], v[104:107], v[68:71], a[28:31]
  ds_read_b64_tr_b16 v[104:105], v3 offset:12288
  ds_read_b64_tr_b16 v[106:107], v3 offset:14336
  s_waitcnt lgkmcnt(6)
  v_mfma_f32_16x16x32_bf16 a[32:35], v[108:111], v[40:43], a[32:35]
  s_add_u32 s35, s34, 12
  s_and_b32 s35, s35, 3
  s_add_u32 s35, s35, 12
  s_lshl_b32 s35, s35, 10
  v_add_u32 v1, s35, v7
  buffer_load_dwordx4 v[8:11], v1, s[8:11], 0 offen
  v_mfma_f32_16x16x32_bf16 a[36:39], v[108:111], v[44:47], a[36:39]
  v_mfma_f32_16x16x32_bf16 a[40:43], v[108:111], v[48:51], a[40:43]
  buffer_load_dwordx4 v[12:15], v1, s[8:11], s49 offen
  v_mfma_f32_16x16x32_bf16 a[44:47], v[108:111], v[52:55], a[44:47]
  v_mfma_f32_16x16x32_bf16 a[48:51], v[108:111], v[56:59], a[48:51]
  buffer_load_dwordx4 v[16:19], v1, s[8:11], s50 offen
  v_mfma_f32_16x16x32_bf16 a[52:55], v[108:111], v[60:63], a[52:55]
  v_mfma_f32_16x16x32_bf16 a[56:59], v[108:111], v[64:67], a[56:59]
  buffer_load_dwordx4 v[20:23], v1, s[8:11], s51 offen
  v_mfma_f32_16x16x32_bf16 a[60:63], v[108:111], v[68:71], a[60:63]
  ds_read_b64_tr_b16 v[108:109], v3 offset:12296
  ds_read_b64_tr_b16 v[110:111], v3 offset:14344
  s_waitcnt lgkmcnt(6)
  v_mfma_f32_16x16x32_bf16 a[64:67], v[112:115], v[40:43], a[64:67]
  buffer_load_dwordx4 v[24:27], v1, s[8:11], s52 offen
  v_mfma_f32_16x16x32_bf16 a[68:71], v[112:115], v[44:47], a[68:71]
  v_mfma_f32_16x16x32_bf16 a[72:75], v[112:115], v[48:51], a[72:75]
  buffer_load_dwordx4 v[28:31], v1, s[8:11], s53 offen
  v_mfma_f32_16x16x32_bf16 a[76:79], v[112:115], v[52:55], a[76:79]
  v_mfma_f32_16x16x32_bf16 a[80:83], v[112:115], v[56:59], a[80:83]
  buffer_load_dwordx4 v[32:35], v1, s[8:11], s54 offen
  v_mfma_f32_16x16x32_bf16 a[84:87], v[112:115], v[60:63], a[84:87]
  v_mfma_f32_16x16x32_bf16 a[88:91], v[112:115], v[64:67], a[88:91]
  buffer_load_dwordx4 v[36:39], v1, s[8:11], s55 offen
  v_mfma_f32_16x16x32_bf16 a[92:95], v[112:115], v[68:71], a[92:95]
  ds_read_b64_tr_b16 v[112:113], v3 offset:12800
  ds_read_b64_tr_b16 v[114:115], v3 offset:14848
  s_waitcnt lgkmcnt(6)
  v_mfma_f32_16x16x32_bf16 a[96:99], v[116:119], v[40:43], a[96:99]
  v_mfma_f32_16x16x32_bf16 a[100:103], v[116:119], v[44:47], a[100:103]
  v_mfma_f32_16x16x32_bf16 a[104:107], v[116:119], v[48:51], a[104:107]
  v_mfma_f32_16x16x32_bf16 a[108:111], v[116:119], v[52:55], a[108:111]
  v_mfma_f32_16x16x32_bf16 a[112:115], v[116:119], v[56:59], a[112:115]
  v_mfma_f32_16x16x32_bf16 a[116:119], v[116:119], v[60:63], a[116:119]
  v_mfma_f32_16x16x32_bf16 a[120:123], v[116:119], v[64:67], a[120:123]
  v_mfma_f32_16x16x32_bf16 a[124:127], v[116:119], v[68:71], a[124:127]
  ds_read_b64_tr_b16 v[116:117], v3 offset:12808
  ds_read_b64_tr_b16 v[118:119], v3 offset:14856
  s_waitcnt vmcnt(8)
  s_waitcnt lgkmcnt(6)
  v_mfma_f32_16x16x32_bf16 a[0:3], v[104:107], v[72:75], a[0:3]
  s_add_u32 s35, s34, 13
  s_and_b32 s35, s35, 3
  s_add_u32 s35, s35, 12
  s_mul_i32 s35, s35, 40960
  v_add_u32 v2, s35, v6
  s_add_u32 m0, s32, 4096
  s_nop 0
  buffer_load_dwordx4 v2, s[12:15], 0 offen lds
  v_mfma_f32_16x16x32_bf16 a[4:7], v[104:107], v[76:79], a[4:7]
  v_mfma_f32_16x16x32_bf16 a[8:11], v[104:107], v[80:83], a[8:11]
  s_add_u32 m0, s32, 5120
  s_nop 0
  buffer_load_dwordx4 v2, s[12:15], s57 offen lds
  v_mfma_f32_16x16x32_bf16 a[12:15], v[104:107], v[84:87], a[12:15]
  v_mfma_f32_16x16x32_bf16 a[16:19], v[104:107], v[88:91], a[16:19]
  s_add_u32 m0, s32, 6144
  s_nop 0
  buffer_load_dwordx4 v2, s[12:15], s58 offen lds
  v_mfma_f32_16x16x32_bf16 a[20:23], v[104:107], v[92:95], a[20:23]
  v_mfma_f32_16x16x32_bf16 a[24:27], v[104:107], v[96:99], a[24:27]
  s_add_u32 m0, s32, 7168
  s_nop 0
  buffer_load_dwordx4 v2, s[12:15], s59 offen lds
  v_mfma_f32_16x16x32_bf16 a[28:31], v[104:107], v[100:103], a[28:31]
  ds_read_b64_tr_b16 v[104:105], v3 offset:0
  ds_read_b64_tr_b16 v[106:107], v3 offset:2048
  s_waitcnt lgkmcnt(6)
  v_mfma_f32_16x16x32_bf16 a[32:35], v[108:111], v[72:75], a[32:35]
  s_add_u32 s35, s34, 13
  s_and_b32 s35, s35, 3
  s_add_u32 s35, s35, 12
  s_lshl_b32 s35, s35, 10
  v_add_u32 v1, s35, v7
  buffer_load_dwordx4 v[40:43], v1, s[8:11], 0 offen
  v_mfma_f32_16x16x32_bf16 a[36:39], v[108:111], v[76:79], a[36:39]
  v_mfma_f32_16x16x32_bf16 a[40:43], v[108:111], v[80:83], a[40:43]
  buffer_load_dwordx4 v[44:47], v1, s[8:11], s49 offen
  v_mfma_f32_16x16x32_bf16 a[44:47], v[108:111], v[84:87], a[44:47]
  v_mfma_f32_16x16x32_bf16 a[48:51], v[108:111], v[88:91], a[48:51]
  buffer_load_dwordx4 v[48:51], v1, s[8:11], s50 offen
  v_mfma_f32_16x16x32_bf16 a[52:55], v[108:111], v[92:95], a[52:55]
  v_mfma_f32_16x16x32_bf16 a[56:59], v[108:111], v[96:99], a[56:59]
  buffer_load_dwordx4 v[52:55], v1, s[8:11], s51 offen
  v_mfma_f32_16x16x32_bf16 a[60:63], v[108:111], v[100:103], a[60:63]
  ds_read_b64_tr_b16 v[108:109], v3 offset:8
  ds_read_b64_tr_b16 v[110:111], v3 offset:2056
  s_waitcnt lgkmcnt(6)
  v_mfma_f32_16x16x32_bf16 a[64:67], v[112:115], v[72:75], a[64:67]
  buffer_load_dwordx4 v[56:59], v1, s[8:11], s52 offen
  v_mfma_f32_16x16x32_bf16 a[68:71], v[112:115], v[76:79], a[68:71]
  v_mfma_f32_16x16x32_bf16 a[72:75], v[112:115], v[80:83], a[72:75]
  buffer_load_dwordx4 v[60:63], v1, s[8:11], s53 offen
  v_mfma_f32_16x16x32_bf16 a[76:79], v[112:115], v[84:87], a[76:79]
  v_mfma_f32_16x16x32_bf16 a[80:83], v[112:115], v[88:91], a[80:83]
  buffer_load_dwordx4 v[64:67], v1, s[8:11], s54 offen
  v_mfma_f32_16x16x32_bf16 a[84:87], v[112:115], v[92:95], a[84:87]
  v_mfma_f32_16x16x32_bf16 a[88:91], v[112:115], v[96:99], a[88:91]
  buffer_load_dwordx4 v[68:71], v1, s[8:11], s55 offen
  v_mfma_f32_16x16x32_bf16 a[92:95], v[112:115], v[100:103], a[92:95]
  ds_read_b64_tr_b16 v[112:113], v3 offset:512
  ds_read_b64_tr_b16 v[114:115], v3 offset:2560
  s_waitcnt lgkmcnt(6)
  v_mfma_f32_16x16x32_bf16 a[96:99], v[116:119], v[72:75], a[96:99]
  v_mfma_f32_16x16x32_bf16 a[100:103], v[116:119], v[76:79], a[100:103]
  v_mfma_f32_16x16x32_bf16 a[104:107], v[116:119], v[80:83], a[104:107]
  v_mfma_f32_16x16x32_bf16 a[108:111], v[116:119], v[84:87], a[108:111]
  v_mfma_f32_16x16x32_bf16 a[112:115], v[116:119], v[88:91], a[112:115]
  v_mfma_f32_16x16x32_bf16 a[116:119], v[116:119], v[92:95], a[116:119]
  v_mfma_f32_16x16x32_bf16 a[120:123], v[116:119], v[96:99], a[120:123]
  v_mfma_f32_16x16x32_bf16 a[124:127], v[116:119], v[100:103], a[124:127]
  ds_read_b64_tr_b16 v[116:117], v3 offset:520
  ds_read_b64_tr_b16 v[118:119], v3 offset:2568
  s_waitcnt vmcnt(8)
  s_waitcnt lgkmcnt(6)
  v_mfma_f32_16x16x32_bf16 a[0:3], v[104:107], v[8:11], a[0:3]
  s_add_u32 s35, s34, 14
  s_and_b32 s35, s35, 3
  s_add_u32 s35, s35, 12
  s_mul_i32 s35, s35, 40960
  v_add_u32 v2, s35, v6
  s_add_u32 m0, s32, 8192
  s_nop 0
  buffer_load_dwordx4 v2, s[12:15], 0 offen lds
  v_mfma_f32_16x16x32_bf16 a[4:7], v[104:107], v[12:15], a[4:7]
  v_mfma_f32_16x16x32_bf16 a[8:11], v[104:107], v[16:19], a[8:11]
  s_add_u32 m0, s32, 9216
  s_nop 0
  buffer_load_dwordx4 v2, s[12:15], s57 offen lds
  v_mfma_f32_16x16x32_bf16 a[12:15], v[104:107], v[20:23], a[12:15]
  v_mfma_f32_16x16x32_bf16 a[16:19], v[104:107], v[24:27], a[16:19]
  s_add_u32 m0, s32, 10240
  s_nop 0
  buffer_load_dwordx4 v2, s[12:15], s58 offen lds
  v_mfma_f32_16x16x32_bf16 a[20:23], v[104:107], v[28:31], a[20:23]
  v_mfma_f32_16x16x32_bf16 a[24:27], v[104:107], v[32:35], a[24:27]
  s_add_u32 m0, s32, 11264
  s_nop 0
  buffer_load_dwordx4 v2, s[12:15], s59 offen lds
  v_mfma_f32_16x16x32_bf16 a[28:31], v[104:107], v[36:39], a[28:31]
  ds_read_b64_tr_b16 v[104:105], v3 offset:4096
  ds_read_b64_tr_b16 v[106:107], v3 offset:6144
  s_waitcnt lgkmcnt(6)
  v_mfma_f32_16x16x32_bf16 a[32:35], v[108:111], v[8:11], a[32:35]
  s_add_u32 s35, s34, 14
  s_and_b32 s35, s35, 3
  s_add_u32 s35, s35, 12
  s_lshl_b32 s35, s35, 10
  v_add_u32 v1, s35, v7
  buffer_load_dwordx4 v[72:75], v1, s[8:11], 0 offen
  v_mfma_f32_16x16x32_bf16 a[36:39], v[108:111], v[12:15], a[36:39]
  v_mfma_f32_16x16x32_bf16 a[40:43], v[108:111], v[16:19], a[40:43]
  buffer_load_dwordx4 v[76:79], v1, s[8:11], s49 offen
  v_mfma_f32_16x16x32_bf16 a[44:47], v[108:111], v[20:23], a[44:47]
  v_mfma_f32_16x16x32_bf16 a[48:51], v[108:111], v[24:27], a[48:51]
  buffer_load_dwordx4 v[80:83], v1, s[8:11], s50 offen
  v_mfma_f32_16x16x32_bf16 a[52:55], v[108:111], v[28:31], a[52:55]
  v_mfma_f32_16x16x32_bf16 a[56:59], v[108:111], v[32:35], a[56:59]
  buffer_load_dwordx4 v[84:87], v1, s[8:11], s51 offen
  v_mfma_f32_16x16x32_bf16 a[60:63], v[108:111], v[36:39], a[60:63]
  ds_read_b64_tr_b16 v[108:109], v3 offset:4104
  ds_read_b64_tr_b16 v[110:111], v3 offset:6152
  s_waitcnt lgkmcnt(6)
  v_mfma_f32_16x16x32_bf16 a[64:67], v[112:115], v[8:11], a[64:67]
  buffer_load_dwordx4 v[88:91], v1, s[8:11], s52 offen
  v_mfma_f32_16x16x32_bf16 a[68:71], v[112:115], v[12:15], a[68:71]
  v_mfma_f32_16x16x32_bf16 a[72:75], v[112:115], v[16:19], a[72:75]
  buffer_load_dwordx4 v[92:95], v1, s[8:11], s53 offen
  v_mfma_f32_16x16x32_bf16 a[76:79], v[112:115], v[20:23], a[76:79]
  v_mfma_f32_16x16x32_bf16 a[80:83], v[112:115], v[24:27], a[80:83]
  buffer_load_dwordx4 v[96:99], v1, s[8:11], s54 offen
  v_mfma_f32_16x16x32_bf16 a[84:87], v[112:115], v[28:31], a[84:87]
  v_mfma_f32_16x16x32_bf16 a[88:91], v[112:115], v[32:35], a[88:91]
  buffer_load_dwordx4 v[100:103], v1, s[8:11], s55 offen
  v_mfma_f32_16x16x32_bf16 a[92:95], v[112:115], v[36:39], a[92:95]
  ds_read_b64_tr_b16 v[112:113], v3 offset:4608
  ds_read_b64_tr_b16 v[114:115], v3 offset:6656
  s_waitcnt lgkmcnt(6)
  v_mfma_f32_16x16x32_bf16 a[96:99], v[116:119], v[8:11], a[96:99]
  v_mfma_f32_16x16x32_bf16 a[100:103], v[116:119], v[12:15], a[100:103]
  v_mfma_f32_16x16x32_bf16 a[104:107], v[116:119], v[16:19], a[104:107]
  v_mfma_f32_16x16x32_bf16 a[108:111], v[116:119], v[20:23], a[108:111]
  v_mfma_f32_16x16x32_bf16 a[112:115], v[116:119], v[24:27], a[112:115]
  v_mfma_f32_16x16x32_bf16 a[116:119], v[116:119], v[28:31], a[116:119]
  v_mfma_f32_16x16x32_bf16 a[120:123], v[116:119], v[32:35], a[120:123]
  v_mfma_f32_16x16x32_bf16 a[124:127], v[116:119], v[36:39], a[124:127]
  ds_read_b64_tr_b16 v[116:117], v3 offset:4616
  ds_read_b64_tr_b16 v[118:119], v3 offset:6664
  s_waitcnt vmcnt(8)
  s_waitcnt lgkmcnt(6)
  v_mfma_f32_16x16x32_bf16 a[0:3], v[104:107], v[40:43], a[0:3]
  s_add_u32 s35, s34, 15
  s_and_b32 s35, s35, 3
  s_add_u32 s35, s35, 12
  s_mul_i32 s35, s35, 40960
  v_add_u32 v2, s35, v6
  s_add_u32 m0, s32, 12288
  s_nop 0
  buffer_load_dwordx4 v2, s[12:15], 0 offen lds
  v_mfma_f32_16x16x32_bf16 a[4:7], v[104:107], v[44:47], a[4:7]
  v_mfma_f32_16x16x32_bf16 a[8:11], v[104:107], v[48:51], a[8:11]
  s_add_u32 m0, s32, 13312
  s_nop 0
  buffer_load_dwordx4 v2, s[12:15], s57 offen lds
  v_mfma_f32_16x16x32_bf16 a[12:15], v[104:107], v[52:55], a[12:15]
  v_mfma_f32_16x16x32_bf16 a[16:19], v[104:107], v[56:59], a[16:19]
  s_add_u32 m0, s32, 14336
  s_nop 0
  buffer_load_dwordx4 v2, s[12:15], s58 offen lds
  v_mfma_f32_16x16x32_bf16 a[20:23], v[104:107], v[60:63], a[20:23]
  v_mfma_f32_16x16x32_bf16 a[24:27], v[104:107], v[64:67], a[24:27]
  s_add_u32 m0, s32, 15360
  s_nop 0
  buffer_load_dwordx4 v2, s[12:15], s59 offen lds
  v_mfma_f32_16x16x32_bf16 a[28:31], v[104:107], v[68:71], a[28:31]
  ds_read_b64_tr_b16 v[104:105], v3 offset:8192
  ds_read_b64_tr_b16 v[106:107], v3 offset:10240
  s_waitcnt lgkmcnt(6)
  v_mfma_f32_16x16x32_bf16 a[32:35], v[108:111], v[40:43], a[32:35]
  s_add_u32 s35, s34, 15
  s_and_b32 s35, s35, 3
  s_add_u32 s35, s35, 12
  s_lshl_b32 s35, s35, 10
  v_add_u32 v1, s35, v7
  buffer_load_dwordx4 v[8:11], v1, s[8:11], 0 offen
  v_mfma_f32_16x16x32_bf16 a[36:39], v[108:111], v[44:47], a[36:39]
  v_mfma_f32_16x16x32_bf16 a[40:43], v[108:111], v[48:51], a[40:43]
  buffer_load_dwordx4 v[12:15], v1, s[8:11], s49 offen
  v_mfma_f32_16x16x32_bf16 a[44:47], v[108:111], v[52:55], a[44:47]
  v_mfma_f32_16x16x32_bf16 a[48:51], v[108:111], v[56:59], a[48:51]
  buffer_load_dwordx4 v[16:19], v1, s[8:11], s50 offen
  v_mfma_f32_16x16x32_bf16 a[52:55], v[108:111], v[60:63], a[52:55]
  v_mfma_f32_16x16x32_bf16 a[56:59], v[108:111], v[64:67], a[56:59]
  buffer_load_dwordx4 v[20:23], v1, s[8:11], s51 offen
  v_mfma_f32_16x16x32_bf16 a[60:63], v[108:111], v[68:71], a[60:63]
  ds_read_b64_tr_b16 v[108:109], v3 offset:8200
  ds_read_b64_tr_b16 v[110:111], v3 offset:10248
  s_waitcnt lgkmcnt(6)
  v_mfma_f32_16x16x32_bf16 a[64:67], v[112:115], v[40:43], a[64:67]
  buffer_load_dwordx4 v[24:27], v1, s[8:11], s52 offen
  v_mfma_f32_16x16x32_bf16 a[68:71], v[112:115], v[44:47], a[68:71]
  v_mfma_f32_16x16x32_bf16 a[72:75], v[112:115], v[48:51], a[72:75]
  buffer_load_dwordx4 v[28:31], v1, s[8:11], s53 offen
  v_mfma_f32_16x16x32_bf16 a[76:79], v[112:115], v[52:55], a[76:79]
  v_mfma_f32_16x16x32_bf16 a[80:83], v[112:115], v[56:59], a[80:83]
  buffer_load_dwordx4 v[32:35], v1, s[8:11], s54 offen
  v_mfma_f32_16x16x32_bf16 a[84:87], v[112:115], v[60:63], a[84:87]
  v_mfma_f32_16x16x32_bf16 a[88:91], v[112:115], v[64:67], a[88:91]
  buffer_load_dwordx4 v[36:39], v1, s[8:11], s55 offen
  v_mfma_f32_16x16x32_bf16 a[92:95], v[112:115], v[68:71], a[92:95]
  ds_read_b64_tr_b16 v[112:113], v3 offset:8704
  ds_read_b64_tr_b16 v[114:115], v3 offset:10752
  s_waitcnt lgkmcnt(6)
  v_mfma_f32_16x16x32_bf16 a[96:99], v[116:119], v[40:43], a[96:99]
  v_mfma_f32_16x16x32_bf16 a[100:103], v[116:119], v[44:47], a[100:103]
  v_mfma_f32_16x16x32_bf16 a[104:107], v[116:119], v[48:51], a[104:107]
  v_mfma_f32_16x16x32_bf16 a[108:111], v[116:119], v[52:55], a[108:111]
  v_mfma_f32_16x16x32_bf16 a[112:115], v[116:119], v[56:59], a[112:115]
  v_mfma_f32_16x16x32_bf16 a[116:119], v[116:119], v[60:63], a[116:119]
  v_mfma_f32_16x16x32_bf16 a[120:123], v[116:119], v[64:67], a[120:123]
  v_mfma_f32_16x16x32_bf16 a[124:127], v[116:119], v[68:71], a[124:127]
  ds_read_b64_tr_b16 v[116:117], v3 offset:8712
  ds_read_b64_tr_b16 v[118:119], v3 offset:10760
  s_waitcnt vmcnt(8)
  s_waitcnt lgkmcnt(6)
  v_mfma_f32_16x16x32_bf16 a[0:3], v[104:107], v[72:75], a[0:3]
  s_add_u32 s35, s34, 16
  s_and_b32 s35, s35, 3
  s_add_u32 s35, s35, 16
  s_mul_i32 s35, s35, 40960
  v_add_u32 v2, s35, v6
  s_add_u32 m0, s32, 0
  s_nop 0
  buffer_load_dwordx4 v2, s[12:15], 0 offen lds
  v_mfma_f32_16x16x32_bf16 a[4:7], v[104:107], v[76:79], a[4:7]
  v_mfma_f32_16x16x32_bf16 a[8:11], v[104:107], v[80:83], a[8:11]
  s_add_u32 m0, s32, 1024
  s_nop 0
  buffer_load_dwordx4 v2, s[12:15], s57 offen lds
  v_mfma_f32_16x16x32_bf16 a[12:15], v[104:107], v[84:87], a[12:15]
  v_mfma_f32_16x16x32_bf16 a[16:19], v[104:107], v[88:91], a[16:19]
  s_add_u32 m0, s32, 2048
  s_nop 0
  buffer_load_dwordx4 v2, s[12:15], s58 offen lds
  v_mfma_f32_16x16x32_bf16 a[20:23], v[104:107], v[92:95], a[20:23]
  v_mfma_f32_16x16x32_bf16 a[24:27], v[104:107], v[96:99], a[24:27]
  s_add_u32 m0, s32, 3072
  s_nop 0
  buffer_load_dwordx4 v2, s[12:15], s59 offen lds
  v_mfma_f32_16x16x32_bf16 a[28:31], v[104:107], v[100:103], a[28:31]
  ds_read_b64_tr_b16 v[104:105], v3 offset:12288
  ds_read_b64_tr_b16 v[106:107], v3 offset:14336
  s_waitcnt lgkmcnt(6)
  v_mfma_f32_16x16x32_bf16 a[32:35], v[108:111], v[72:75], a[32:35]
  s_add_u32 s35, s34, 16
  s_and_b32 s35, s35, 3
  s_add_u32 s35, s35, 16
  s_lshl_b32 s35, s35, 10
  v_add_u32 v1, s35, v7
  buffer_load_dwordx4 v[40:43], v1, s[8:11], 0 offen
  v_mfma_f32_16x16x32_bf16 a[36:39], v[108:111], v[76:79], a[36:39]
  v_mfma_f32_16x16x32_bf16 a[40:43], v[108:111], v[80:83], a[40:43]
  buffer_load_dwordx4 v[44:47], v1, s[8:11], s49 offen
  v_mfma_f32_16x16x32_bf16 a[44:47], v[108:111], v[84:87], a[44:47]
  v_mfma_f32_16x16x32_bf16 a[48:51], v[108:111], v[88:91], a[48:51]
  buffer_load_dwordx4 v[48:51], v1, s[8:11], s50 offen
  v_mfma_f32_16x16x32_bf16 a[52:55], v[108:111], v[92:95], a[52:55]
  v_mfma_f32_16x16x32_bf16 a[56:59], v[108:111], v[96:99], a[56:59]
  buffer_load_dwordx4 v[52:55], v1, s[8:11], s51 offen
  v_mfma_f32_16x16x32_bf16 a[60:63], v[108:111], v[100:103], a[60:63]
  ds_read_b64_tr_b16 v[108:109], v3 offset:12296
  ds_read_b64_tr_b16 v[110:111], v3 offset:14344
  s_waitcnt lgkmcnt(6)
  v_mfma_f32_16x16x32_bf16 a[64:67], v[112:115], v[72:75], a[64:67]
  buffer_load_dwordx4 v[56:59], v1, s[8:11], s52 offen
  v_mfma_f32_16x16x32_bf16 a[68:71], v[112:115], v[76:79], a[68:71]
  v_mfma_f32_16x16x32_bf16 a[72:75], v[112:115], v[80:83], a[72:75]
  buffer_load_dwordx4 v[60:63], v1, s[8:11], s53 offen
  v_mfma_f32_16x16x32_bf16 a[76:79], v[112:115], v[84:87], a[76:79]
  v_mfma_f32_16x16x32_bf16 a[80:83], v[112:115], v[88:91], a[80:83]
  buffer_load_dwordx4 v[64:67], v1, s[8:11], s54 offen
  v_mfma_f32_16x16x32_bf16 a[84:87], v[112:115], v[92:95], a[84:87]
  v_mfma_f32_16x16x32_bf16 a[88:91], v[112:115], v[96:99], a[88:91]
  buffer_load_dwordx4 v[68:71], v1, s[8:11], s55 offen
  v_mfma_f32_16x16x32_bf16 a[92:95], v[112:115], v[100:103], a[92:95]
  ds_read_b64_tr_b16 v[112:113], v3 offset:12800
  ds_read_b64_tr_b16 v[114:115], v3 offset:14848
  s_waitcnt lgkmcnt(6)
  v_mfma_f32_16x16x32_bf16 a[96:99], v[116:119], v[72:75], a[96:99]
  v_mfma_f32_16x16x32_bf16 a[100:103], v[116:119], v[76:79], a[100:103]
  v_mfma_f32_16x16x32_bf16 a[104:107], v[116:119], v[80:83], a[104:107]
  v_mfma_f32_16x16x32_bf16 a[108:111], v[116:119], v[84:87], a[108:111]
  v_mfma_f32_16x16x32_bf16 a[112:115], v[116:119], v[88:91], a[112:115]
  v_mfma_f32_16x16x32_bf16 a[116:119], v[116:119], v[92:95], a[116:119]
  v_mfma_f32_16x16x32_bf16 a[120:123], v[116:119], v[96:99], a[120:123]
  v_mfma_f32_16x16x32_bf16 a[124:127], v[116:119], v[100:103], a[124:127]
  ds_read_b64_tr_b16 v[116:117], v3 offset:12808
  ds_read_b64_tr_b16 v[118:119], v3 offset:14856
  s_waitcnt vmcnt(8)
  s_waitcnt lgkmcnt(6)
  v_mfma_f32_16x16x32_bf16 a[0:3], v[104:107], v[8:11], a[0:3]
  s_add_u32 s35, s34, 17
  s_and_b32 s35, s35, 3
  s_add_u32 s35, s35, 16
  s_mul_i32 s35, s35, 40960
  v_add_u32 v2, s35, v6
  s_add_u32 m0, s32, 4096
  s_nop 0
  buffer_load_dwordx4 v2, s[12:15], 0 offen lds
  v_mfma_f32_16x16x32_bf16 a[4:7], v[104:107], v[12:15], a[4:7]
  v_mfma_f32_16x16x32_bf16 a[8:11], v[104:107], v[16:19], a[8:11]
  s_add_u32 m0, s32, 5120
  s_nop 0
  buffer_load_dwordx4 v2, s[12:15], s57 offen lds
  v_mfma_f32_16x16x32_bf16 a[12:15], v[104:107], v[20:23], a[12:15]
  v_mfma_f32_16x16x32_bf16 a[16:19], v[104:107], v[24:27], a[16:19]
  s_add_u32 m0, s32, 6144
  s_nop 0
  buffer_load_dwordx4 v2, s[12:15], s58 offen lds
  v_mfma_f32_16x16x32_bf16 a[20:23], v[104:107], v[28:31], a[20:23]
  v_mfma_f32_16x16x32_bf16 a[24:27], v[104:107], v[32:35], a[24:27]
  s_add_u32 m0, s32, 7168
  s_nop 0
  buffer_load_dwordx4 v2, s[12:15], s59 offen lds
  v_mfma_f32_16x16x32_bf16 a[28:31], v[104:107], v[36:39], a[28:31]
  ds_read_b64_tr_b16 v[104:105], v3 offset:0
  ds_read_b64_tr_b16 v[106:107], v3 offset:2048
  s_waitcnt lgkmcnt(6)
  v_mfma_f32_16x16x32_bf16 a[32:35], v[108:111], v[8:11], a[32:35]
  s_add_u32 s35, s34, 17
  s_and_b32 s35, s35, 3
  s_add_u32 s35, s35, 16
  s_lshl_b32 s35, s35, 10
  v_add_u32 v1, s35, v7
  buffer_load_dwordx4 v[72:75], v1, s[8:11], 0 offen
  v_mfma_f32_16x16x32_bf16 a[36:39], v[108:111], v[12:15], a[36:39]
  v_mfma_f32_16x16x32_bf16 a[40:43], v[108:111], v[16:19], a[40:43]
  buffer_load_dwordx4 v[76:79], v1, s[8:11], s49 offen
  v_mfma_f32_16x16x32_bf16 a[44:47], v[108:111], v[20:23], a[44:47]
  v_mfma_f32_16x16x32_bf16 a[48:51], v[108:111], v[24:27], a[48:51]
  buffer_load_dwordx4 v[80:83], v1, s[8:11], s50 offen
  v_mfma_f32_16x16x32_bf16 a[52:55], v[108:111], v[28:31], a[52:55]
  v_mfma_f32_16x16x32_bf16 a[56:59], v[108:111], v[32:35], a[56:59]
  buffer_load_dwordx4 v[84:87], v1, s[8:11], s51 offen
  v_mfma_f32_16x16x32_bf16 a[60:63], v[108:111], v[36:39], a[60:63]
  ds_read_b64_tr_b16 v[108:109], v3 offset:8
  ds_read_b64_tr_b16 v[110:111], v3 offset:2056
  s_waitcnt lgkmcnt(6)
  v_mfma_f32_16x16x32_bf16 a[64:67], v[112:115], v[8:11], a[64:67]
  buffer_load_dwordx4 v[88:91], v1, s[8:11], s52 offen
  v_mfma_f32_16x16x32_bf16 a[68:71], v[112:115], v[12:15], a[68:71]
  v_mfma_f32_16x16x32_bf16 a[72:75], v[112:115], v[16:19], a[72:75]
  buffer_load_dwordx4 v[92:95], v1, s[8:11], s53 offen
  v_mfma_f32_16x16x32_bf16 a[76:79], v[112:115], v[20:23], a[76:79]
  v_mfma_f32_16x16x32_bf16 a[80:83], v[112:115], v[24:27], a[80:83]
  buffer_load_dwordx4 v[96:99], v1, s[8:11], s54 offen
  v_mfma_f32_16x16x32_bf16 a[84:87], v[112:115], v[28:31], a[84:87]
  v_mfma_f32_16x16x32_bf16 a[88:91], v[112:115], v[32:35], a[88:91]
  buffer_load_dwordx4 v[100:103], v1, s[8:11], s55 offen
  v_mfma_f32_16x16x32_bf16 a[92:95], v[112:115], v[36:39], a[92:95]
  ds_read_b64_tr_b16 v[112:113], v3 offset:512
  ds_read_b64_tr_b16 v[114:115], v3 offset:2560
  s_waitcnt lgkmcnt(6)
  v_mfma_f32_16x16x32_bf16 a[96:99], v[116:119], v[8:11], a[96:99]
  v_mfma_f32_16x16x32_bf16 a[100:103], v[116:119], v[12:15], a[100:103]
  v_mfma_f32_16x16x32_bf16 a[104:107], v[116:119], v[16:19], a[104:107]
  v_mfma_f32_16x16x32_bf16 a[108:111], v[116:119], v[20:23], a[108:111]
  v_mfma_f32_16x16x32_bf16 a[112:115], v[116:119], v[24:27], a[112:115]
  v_mfma_f32_16x16x32_bf16 a[116:119], v[116:119], v[28:31], a[116:119]
  v_mfma_f32_16x16x32_bf16 a[120:123], v[116:119], v[32:35], a[120:123]
  v_mfma_f32_16x16x32_bf16 a[124:127], v[116:119], v[36:39], a[124:127]
  ds_read_b64_tr_b16 v[116:117], v3 offset:520
  ds_read_b64_tr_b16 v[118:119], v3 offset:2568
  s_waitcnt vmcnt(8)
  s_waitcnt lgkmcnt(6)
  v_mfma_f32_16x16x32_bf16 a[0:3], v[104:107], v[40:43], a[0:3]
  s_add_u32 s35, s34, 18
  s_and_b32 s35, s35, 3
  s_add_u32 s35, s35, 16
  s_mul_i32 s35, s35, 40960
  v_add_u32 v2, s35, v6
  s_add_u32 m0, s32, 8192
  s_nop 0
  buffer_load_dwordx4 v2, s[12:15], 0 offen lds
  v_mfma_f32_16x16x32_bf16 a[4:7], v[104:107], v[44:47], a[4:7]
  v_mfma_f32_16x16x32_bf16 a[8:11], v[104:107], v[48:51], a[8:11]
  s_add_u32 m0, s32, 9216
  s_nop 0
  buffer_load_dwordx4 v2, s[12:15], s57 offen lds
  v_mfma_f32_16x16x32_bf16 a[12:15], v[104:107], v[52:55], a[12:15]
  v_mfma_f32_16x16x32_bf16 a[16:19], v[104:107], v[56:59], a[16:19]
  s_add_u32 m0, s32, 10240
  s_nop 0
  buffer_load_dwordx4 v2, s[12:15], s58 offen lds
  v_mfma_f32_16x16x32_bf16 a[20:23], v[104:107], v[60:63], a[20:23]
  v_mfma_f32_16x16x32_bf16 a[24:27], v[104:107], v[64:67], a[24:27]
  s_add_u32 m0, s32, 11264
  s_nop 0
  buffer_load_dwordx4 v2, s[12:15], s59 offen lds
  v_mfma_f32_16x16x32_bf16 a[28:31], v[104:107], v[68:71], a[28:31]
  ds_read_b64_tr_b16 v[104:105], v3 offset:4096
  ds_read_b64_tr_b16 v[106:107], v3 offset:6144
  s_waitcnt lgkmcnt(6)
  v_mfma_f32_16x16x32_bf16 a[32:35], v[108:111], v[40:43], a[32:35]
  s_add_u32 s35, s34, 18
  s_and_b32 s35, s35, 3
  s_add_u32 s35, s35, 16
  s_lshl_b32 s35, s35, 10
  v_add_u32 v1, s35, v7
  buffer_load_dwordx4 v[8:11], v1, s[8:11], 0 offen
  v_mfma_f32_16x16x32_bf16 a[36:39], v[108:111], v[44:47], a[36:39]
  v_mfma_f32_16x16x32_bf16 a[40:43], v[108:111], v[48:51], a[40:43]
  buffer_load_dwordx4 v[12:15], v1, s[8:11], s49 offen
  v_mfma_f32_16x16x32_bf16 a[44:47], v[108:111], v[52:55], a[44:47]
  v_mfma_f32_16x16x32_bf16 a[48:51], v[108:111], v[56:59], a[48:51]
  buffer_load_dwordx4 v[16:19], v1, s[8:11], s50 offen
  v_mfma_f32_16x16x32_bf16 a[52:55], v[108:111], v[60:63], a[52:55]
  v_mfma_f32_16x16x32_bf16 a[56:59], v[108:111], v[64:67], a[56:59]
  buffer_load_dwordx4 v[20:23], v1, s[8:11], s51 offen
  v_mfma_f32_16x16x32_bf16 a[60:63], v[108:111], v[68:71], a[60:63]
  ds_read_b64_tr_b16 v[108:109], v3 offset:4104
  ds_read_b64_tr_b16 v[110:111], v3 offset:6152
  s_waitcnt lgkmcnt(6)
  v_mfma_f32_16x16x32_bf16 a[64:67], v[112:115], v[40:43], a[64:67]
  buffer_load_dwordx4 v[24:27], v1, s[8:11], s52 offen
  v_mfma_f32_16x16x32_bf16 a[68:71], v[112:115], v[44:47], a[68:71]
  v_mfma_f32_16x16x32_bf16 a[72:75], v[112:115], v[48:51], a[72:75]
  buffer_load_dwordx4 v[28:31], v1, s[8:11], s53 offen
  v_mfma_f32_16x16x32_bf16 a[76:79], v[112:115], v[52:55], a[76:79]
  v_mfma_f32_16x16x32_bf16 a[80:83], v[112:115], v[56:59], a[80:83]
  buffer_load_dwordx4 v[32:35], v1, s[8:11], s54 offen
  v_mfma_f32_16x16x32_bf16 a[84:87], v[112:115], v[60:63], a[84:87]
  v_mfma_f32_16x16x32_bf16 a[88:91], v[112:115], v[64:67], a[88:91]
  buffer_load_dwordx4 v[36:39], v1, s[8:11], s55 offen
  v_mfma_f32_16x16x32_bf16 a[92:95], v[112:115], v[68:71], a[92:95]
  ds_read_b64_tr_b16 v[112:113], v3 offset:4608
  ds_read_b64_tr_b16 v[114:115], v3 offset:6656
  s_waitcnt lgkmcnt(6)
  v_mfma_f32_16x16x32_bf16 a[96:99], v[116:119], v[40:43], a[96:99]
  v_mfma_f32_16x16x32_bf16 a[100:103], v[116:119], v[44:47], a[100:103]
  v_mfma_f32_16x16x32_bf16 a[104:107], v[116:119], v[48:51], a[104:107]
  v_mfma_f32_16x16x32_bf16 a[108:111], v[116:119], v[52:55], a[108:111]
  v_mfma_f32_16x16x32_bf16 a[112:115], v[116:119], v[56:59], a[112:115]
  v_mfma_f32_16x16x32_bf16 a[116:119], v[116:119], v[60:63], a[116:119]
  v_mfma_f32_16x16x32_bf16 a[120:123], v[116:119], v[64:67], a[120:123]
  v_mfma_f32_16x16x32_bf16 a[124:127], v[116:119], v[68:71], a[124:127]
  ds_read_b64_tr_b16 v[116:117], v3 offset:4616
  ds_read_b64_tr_b16 v[118:119], v3 offset:6664
  s_waitcnt vmcnt(8)
  s_waitcnt lgkmcnt(6)
  v_mfma_f32_16x16x32_bf16 a[0:3], v[104:107], v[72:75], a[0:3]
  s_add_u32 s35, s34, 19
  s_and_b32 s35, s35, 3
  s_add_u32 s35, s35, 16
  s_mul_i32 s35, s35, 40960
  v_add_u32 v2, s35, v6
  s_add_u32 m0, s32, 12288
  s_nop 0
  buffer_load_dwordx4 v2, s[12:15], 0 offen lds
  v_mfma_f32_16x16x32_bf16 a[4:7], v[104:107], v[76:79], a[4:7]
  v_mfma_f32_16x16x32_bf16 a[8:11], v[104:107], v[80:83], a[8:11]
  s_add_u32 m0, s32, 13312
  s_nop 0
  buffer_load_dwordx4 v2, s[12:15], s57 offen lds
  v_mfma_f32_16x16x32_bf16 a[12:15], v[104:107], v[84:87], a[12:15]
  v_mfma_f32_16x16x32_bf16 a[16:19], v[104:107], v[88:91], a[16:19]
  s_add_u32 m0, s32, 14336
  s_nop 0
  buffer_load_dwordx4 v2, s[12:15], s58 offen lds
  v_mfma_f32_16x16x32_bf16 a[20:23], v[104:107], v[92:95], a[20:23]
  v_mfma_f32_16x16x32_bf16 a[24:27], v[104:107], v[96:99], a[24:27]
  s_add_u32 m0, s32, 15360
  s_nop 0
  buffer_load_dwordx4 v2, s[12:15], s59 offen lds
  v_mfma_f32_16x16x32_bf16 a[28:31], v[104:107], v[100:103], a[28:31]
  ds_read_b64_tr_b16 v[104:105], v3 offset:8192
  ds_read_b64_tr_b16 v[106:107], v3 offset:10240
  s_waitcnt lgkmcnt(6)
  v_mfma_f32_16x16x32_bf16 a[32:35], v[108:111], v[72:75], a[32:35]
  s_add_u32 s35, s34, 19
  s_and_b32 s35, s35, 3
  s_add_u32 s35, s35, 16
  s_lshl_b32 s35, s35, 10
  v_add_u32 v1, s35, v7
  buffer_load_dwordx4 v[40:43], v1, s[8:11], 0 offen
  v_mfma_f32_16x16x32_bf16 a[36:39], v[108:111], v[76:79], a[36:39]
  v_mfma_f32_16x16x32_bf16 a[40:43], v[108:111], v[80:83], a[40:43]
  buffer_load_dwordx4 v[44:47], v1, s[8:11], s49 offen
  v_mfma_f32_16x16x32_bf16 a[44:47], v[108:111], v[84:87], a[44:47]
  v_mfma_f32_16x16x32_bf16 a[48:51], v[108:111], v[88:91], a[48:51]
  buffer_load_dwordx4 v[48:51], v1, s[8:11], s50 offen
  v_mfma_f32_16x16x32_bf16 a[52:55], v[108:111], v[92:95], a[52:55]
  v_mfma_f32_16x16x32_bf16 a[56:59], v[108:111], v[96:99], a[56:59]
  buffer_load_dwordx4 v[52:55], v1, s[8:11], s51 offen
  v_mfma_f32_16x16x32_bf16 a[60:63], v[108:111], v[100:103], a[60:63]
  ds_read_b64_tr_b16 v[108:109], v3 offset:8200
  ds_read_b64_tr_b16 v[110:111], v3 offset:10248
  s_waitcnt lgkmcnt(6)
  v_mfma_f32_16x16x32_bf16 a[64:67], v[112:115], v[72:75], a[64:67]
  buffer_load_dwordx4 v[56:59], v1, s[8:11], s52 offen
  v_mfma_f32_16x16x32_bf16 a[68:71], v[112:115], v[76:79], a[68:71]
  v_mfma_f32_16x16x32_bf16 a[72:75], v[112:115], v[80:83], a[72:75]
  buffer_load_dwordx4 v[60:63], v1, s[8:11], s53 offen
  v_mfma_f32_16x16x32_bf16 a[76:79], v[112:115], v[84:87], a[76:79]
  v_mfma_f32_16x16x32_bf16 a[80:83], v[112:115], v[88:91], a[80:83]
  buffer_load_dwordx4 v[64:67], v1, s[8:11], s54 offen
  v_mfma_f32_16x16x32_bf16 a[84:87], v[112:115], v[92:95], a[84:87]
  v_mfma_f32_16x16x32_bf16 a[88:91], v[112:115], v[96:99], a[88:91]
  buffer_load_dwordx4 v[68:71], v1, s[8:11], s55 offen
  v_mfma_f32_16x16x32_bf16 a[92:95], v[112:115], v[100:103], a[92:95]
  ds_read_b64_tr_b16 v[112:113], v3 offset:8704
  ds_read_b64_tr_b16 v[114:115], v3 offset:10752
  s_waitcnt lgkmcnt(6)
  v_mfma_f32_16x16x32_bf16 a[96:99], v[116:119], v[72:75], a[96:99]
  v_mfma_f32_16x16x32_bf16 a[100:103], v[116:119], v[76:79], a[100:103]
  v_mfma_f32_16x16x32_bf16 a[104:107], v[116:119], v[80:83], a[104:107]
  v_mfma_f32_16x16x32_bf16 a[108:111], v[116:119], v[84:87], a[108:111]
  v_mfma_f32_16x16x32_bf16 a[112:115], v[116:119], v[88:91], a[112:115]
  v_mfma_f32_16x16x32_bf16 a[116:119], v[116:119], v[92:95], a[116:119]
  v_mfma_f32_16x16x32_bf16 a[120:123], v[116:119], v[96:99], a[120:123]
  v_mfma_f32_16x16x32_bf16 a[124:127], v[116:119], v[100:103], a[124:127]
  ds_read_b64_tr_b16 v[116:117], v3 offset:8712
  ds_read_b64_tr_b16 v[118:119], v3 offset:10760
  s_waitcnt vmcnt(8)
  s_waitcnt lgkmcnt(6)
  v_mfma_f32_16x16x32_bf16 a[0:3], v[104:107], v[8:11], a[0:3]
  s_add_u32 s35, s34, 20
  s_and_b32 s35, s35, 3
  s_add_u32 s35, s35, 20
  s_mul_i32 s35, s35, 40960
  v_add_u32 v2, s35, v6
  s_add_u32 m0, s32, 0
  s_nop 0
  buffer_load_dwordx4 v2, s[12:15], 0 offen lds
  v_mfma_f32_16x16x32_bf16 a[4:7], v[104:107], v[12:15], a[4:7]
  v_mfma_f32_16x16x32_bf16 a[8:11], v[104:107], v[16:19], a[8:11]
  s_add_u32 m0, s32, 1024
  s_nop 0
  buffer_load_dwordx4 v2, s[12:15], s57 offen lds
  v_mfma_f32_16x16x32_bf16 a[12:15], v[104:107], v[20:23], a[12:15]
  v_mfma_f32_16x16x32_bf16 a[16:19], v[104:107], v[24:27], a[16:19]
  s_add_u32 m0, s32, 2048
  s_nop 0
  buffer_load_dwordx4 v2, s[12:15], s58 offen lds
  v_mfma_f32_16x16x32_bf16 a[20:23], v[104:107], v[28:31], a[20:23]
  v_mfma_f32_16x16x32_bf16 a[24:27], v[104:107], v[32:35], a[24:27]
  s_add_u32 m0, s32, 3072
  s_nop 0
  buffer_load_dwordx4 v2, s[12:15], s59 offen lds
  v_mfma_f32_16x16x32_bf16 a[28:31], v[104:107], v[36:39], a[28:31]
  ds_read_b64_tr_b16 v[104:105], v3 offset:12288
  ds_read_b64_tr_b16 v[106:107], v3 offset:14336
  s_waitcnt lgkmcnt(6)
  v_mfma_f32_16x16x32_bf16 a[32:35], v[108:111], v[8:11], a[32:35]
  s_add_u32 s35, s34, 20
  s_and_b32 s35, s35, 3
  s_add_u32 s35, s35, 20
  s_lshl_b32 s35, s35, 10
  v_add_u32 v1, s35, v7
  buffer_load_dwordx4 v[72:75], v1, s[8:11], 0 offen
  v_mfma_f32_16x16x32_bf16 a[36:39], v[108:111], v[12:15], a[36:39]
  v_mfma_f32_16x16x32_bf16 a[40:43], v[108:111], v[16:19], a[40:43]
  buffer_load_dwordx4 v[76:79], v1, s[8:11], s49 offen
  v_mfma_f32_16x16x32_bf16 a[44:47], v[108:111], v[20:23], a[44:47]
  v_mfma_f32_16x16x32_bf16 a[48:51], v[108:111], v[24:27], a[48:51]
  buffer_load_dwordx4 v[80:83], v1, s[8:11], s50 offen
  v_mfma_f32_16x16x32_bf16 a[52:55], v[108:111], v[28:31], a[52:55]
  v_mfma_f32_16x16x32_bf16 a[56:59], v[108:111], v[32:35], a[56:59]
  buffer_load_dwordx4 v[84:87], v1, s[8:11], s51 offen
  v_mfma_f32_16x16x32_bf16 a[60:63], v[108:111], v[36:39], a[60:63]
  ds_read_b64_tr_b16 v[108:109], v3 offset:12296
  ds_read_b64_tr_b16 v[110:111], v3 offset:14344
  s_waitcnt lgkmcnt(6)
  v_mfma_f32_16x16x32_bf16 a[64:67], v[112:115], v[8:11], a[64:67]
  buffer_load_dwordx4 v[88:91], v1, s[8:11], s52 offen
  v_mfma_f32_16x16x32_bf16 a[68:71], v[112:115], v[12:15], a[68:71]
  v_mfma_f32_16x16x32_bf16 a[72:75], v[112:115], v[16:19], a[72:75]
  buffer_load_dwordx4 v[92:95], v1, s[8:11], s53 offen
  v_mfma_f32_16x16x32_bf16 a[76:79], v[112:115], v[20:23], a[76:79]
  v_mfma_f32_16x16x32_bf16 a[80:83], v[112:115], v[24:27], a[80:83]
  buffer_load_dwordx4 v[96:99], v1, s[8:11], s54 offen
  v_mfma_f32_16x16x32_bf16 a[84:87], v[112:115], v[28:31], a[84:87]
  v_mfma_f32_16x16x32_bf16 a[88:91], v[112:115], v[32:35], a[88:91]
  buffer_load_dwordx4 v[100:103], v1, s[8:11], s55 offen
  v_mfma_f32_16x16x32_bf16 a[92:95], v[112:115], v[36:39], a[92:95]
  ds_read_b64_tr_b16 v[112:113], v3 offset:12800
  ds_read_b64_tr_b16 v[114:115], v3 offset:14848
  s_waitcnt lgkmcnt(6)
  v_mfma_f32_16x16x32_bf16 a[96:99], v[116:119], v[8:11], a[96:99]
  v_mfma_f32_16x16x32_bf16 a[100:103], v[116:119], v[12:15], a[100:103]
  v_mfma_f32_16x16x32_bf16 a[104:107], v[116:119], v[16:19], a[104:107]
  v_mfma_f32_16x16x32_bf16 a[108:111], v[116:119], v[20:23], a[108:111]
  v_mfma_f32_16x16x32_bf16 a[112:115], v[116:119], v[24:27], a[112:115]
  v_mfma_f32_16x16x32_bf16 a[116:119], v[116:119], v[28:31], a[116:119]
  v_mfma_f32_16x16x32_bf16 a[120:123], v[116:119], v[32:35], a[120:123]
  v_mfma_f32_16x16x32_bf16 a[124:127], v[116:119], v[36:39], a[124:127]
  ds_read_b64_tr_b16 v[116:117], v3 offset:12808
  ds_read_b64_tr_b16 v[118:119], v3 offset:14856
  s_waitcnt vmcnt(8)
  s_waitcnt lgkmcnt(6)
  v_mfma_f32_16x16x32_bf16 a[0:3], v[104:107], v[40:43], a[0:3]
  s_add_u32 s35, s34, 21
  s_and_b32 s35, s35, 3
  s_add_u32 s35, s35, 20
  s_mul_i32 s35, s35, 40960
  v_add_u32 v2, s35, v6
  s_add_u32 m0, s32, 4096
  s_nop 0
  buffer_load_dwordx4 v2, s[12:15], 0 offen lds
  v_mfma_f32_16x16x32_bf16 a[4:7], v[104:107], v[44:47], a[4:7]
  v_mfma_f32_16x16x32_bf16 a[8:11], v[104:107], v[48:51], a[8:11]
  s_add_u32 m0, s32, 5120
  s_nop 0
  buffer_load_dwordx4 v2, s[12:15], s57 offen lds
  v_mfma_f32_16x16x32_bf16 a[12:15], v[104:107], v[52:55], a[12:15]
  v_mfma_f32_16x16x32_bf16 a[16:19], v[104:107], v[56:59], a[16:19]
  s_add_u32 m0, s32, 6144
  s_nop 0
  buffer_load_dwordx4 v2, s[12:15], s58 offen lds
  v_mfma_f32_16x16x32_bf16 a[20:23], v[104:107], v[60:63], a[20:23]
  v_mfma_f32_16x16x32_bf16 a[24:27], v[104:107], v[64:67], a[24:27]
  s_add_u32 m0, s32, 7168
  s_nop 0
  buffer_load_dwordx4 v2, s[12:15], s59 offen lds
  v_mfma_f32_16x16x32_bf16 a[28:31], v[104:107], v[68:71], a[28:31]
  ds_read_b64_tr_b16 v[104:105], v3 offset:0
  ds_read_b64_tr_b16 v[106:107], v3 offset:2048
  s_waitcnt lgkmcnt(6)
  v_mfma_f32_16x16x32_bf16 a[32:35], v[108:111], v[40:43], a[32:35]
  s_add_u32 s35, s34, 21
  s_and_b32 s35, s35, 3
  s_add_u32 s35, s35, 20
  s_lshl_b32 s35, s35, 10
  v_add_u32 v1, s35, v7
  buffer_load_dwordx4 v[8:11], v1, s[8:11], 0 offen
  v_mfma_f32_16x16x32_bf16 a[36:39], v[108:111], v[44:47], a[36:39]
  v_mfma_f32_16x16x32_bf16 a[40:43], v[108:111], v[48:51], a[40:43]
  buffer_load_dwordx4 v[12:15], v1, s[8:11], s49 offen
  v_mfma_f32_16x16x32_bf16 a[44:47], v[108:111], v[52:55], a[44:47]
  v_mfma_f32_16x16x32_bf16 a[48:51], v[108:111], v[56:59], a[48:51]
  buffer_load_dwordx4 v[16:19], v1, s[8:11], s50 offen
  v_mfma_f32_16x16x32_bf16 a[52:55], v[108:111], v[60:63], a[52:55]
  v_mfma_f32_16x16x32_bf16 a[56:59], v[108:111], v[64:67], a[56:59]
  buffer_load_dwordx4 v[20:23], v1, s[8:11], s51 offen
  v_mfma_f32_16x16x32_bf16 a[60:63], v[108:111], v[68:71], a[60:63]
  ds_read_b64_tr_b16 v[108:109], v3 offset:8
  ds_read_b64_tr_b16 v[110:111], v3 offset:2056
  s_waitcnt lgkmcnt(6)
  v_mfma_f32_16x16x32_bf16 a[64:67], v[112:115], v[40:43], a[64:67]
  buffer_load_dwordx4 v[24:27], v1, s[8:11], s52 offen
  v_mfma_f32_16x16x32_bf16 a[68:71], v[112:115], v[44:47], a[68:71]
  v_mfma_f32_16x16x32_bf16 a[72:75], v[112:115], v[48:51], a[72:75]
  buffer_load_dwordx4 v[28:31], v1, s[8:11], s53 offen
  v_mfma_f32_16x16x32_bf16 a[76:79], v[112:115], v[52:55], a[76:79]
  v_mfma_f32_16x16x32_bf16 a[80:83], v[112:115], v[56:59], a[80:83]
  buffer_load_dwordx4 v[32:35], v1, s[8:11], s54 offen
  v_mfma_f32_16x16x32_bf16 a[84:87], v[112:115], v[60:63], a[84:87]
  v_mfma_f32_16x16x32_bf16 a[88:91], v[112:115], v[64:67], a[88:91]
  buffer_load_dwordx4 v[36:39], v1, s[8:11], s55 offen
  v_mfma_f32_16x16x32_bf16 a[92:95], v[112:115], v[68:71], a[92:95]
  ds_read_b64_tr_b16 v[112:113], v3 offset:512
  ds_read_b64_tr_b16 v[114:115], v3 offset:2560
  s_waitcnt lgkmcnt(6)
  v_mfma_f32_16x16x32_bf16 a[96:99], v[116:119], v[40:43], a[96:99]
  v_mfma_f32_16x16x32_bf16 a[100:103], v[116:119], v[44:47], a[100:103]
  v_mfma_f32_16x16x32_bf16 a[104:107], v[116:119], v[48:51], a[104:107]
  v_mfma_f32_16x16x32_bf16 a[108:111], v[116:119], v[52:55], a[108:111]
  v_mfma_f32_16x16x32_bf16 a[112:115], v[116:119], v[56:59], a[112:115]
  v_mfma_f32_16x16x32_bf16 a[116:119], v[116:119], v[60:63], a[116:119]
  v_mfma_f32_16x16x32_bf16 a[120:123], v[116:119], v[64:67], a[120:123]
  v_mfma_f32_16x16x32_bf16 a[124:127], v[116:119], v[68:71], a[124:127]
  ds_read_b64_tr_b16 v[116:117], v3 offset:520
  ds_read_b64_tr_b16 v[118:119], v3 offset:2568
  s_waitcnt vmcnt(8)
  s_waitcnt lgkmcnt(6)
  v_mfma_f32_16x16x32_bf16 a[0:3], v[104:107], v[72:75], a[0:3]
  s_add_u32 s35, s34, 22
  s_and_b32 s35, s35, 3
  s_add_u32 s35, s35, 20
  s_mul_i32 s35, s35, 40960
  v_add_u32 v2, s35, v6
  s_add_u32 m0, s32, 8192
  s_nop 0
  buffer_load_dwordx4 v2, s[12:15], 0 offen lds
  v_mfma_f32_16x16x32_bf16 a[4:7], v[104:107], v[76:79], a[4:7]
  v_mfma_f32_16x16x32_bf16 a[8:11], v[104:107], v[80:83], a[8:11]
  s_add_u32 m0, s32, 9216
  s_nop 0
  buffer_load_dwordx4 v2, s[12:15], s57 offen lds
  v_mfma_f32_16x16x32_bf16 a[12:15], v[104:107], v[84:87], a[12:15]
  v_mfma_f32_16x16x32_bf16 a[16:19], v[104:107], v[88:91], a[16:19]
  s_add_u32 m0, s32, 10240
  s_nop 0
  buffer_load_dwordx4 v2, s[12:15], s58 offen lds
  v_mfma_f32_16x16x32_bf16 a[20:23], v[104:107], v[92:95], a[20:23]
  v_mfma_f32_16x16x32_bf16 a[24:27], v[104:107], v[96:99], a[24:27]
  s_add_u32 m0, s32, 11264
  s_nop 0
  buffer_load_dwordx4 v2, s[12:15], s59 offen lds
  v_mfma_f32_16x16x32_bf16 a[28:31], v[104:107], v[100:103], a[28:31]
  ds_read_b64_tr_b16 v[104:105], v3 offset:4096
  ds_read_b64_tr_b16 v[106:107], v3 offset:6144
  s_waitcnt lgkmcnt(6)
  v_mfma_f32_16x16x32_bf16 a[32:35], v[108:111], v[72:75], a[32:35]
  s_add_u32 s35, s34, 22
  s_and_b32 s35, s35, 3
  s_add_u32 s35, s35, 20
  s_lshl_b32 s35, s35, 10
  v_add_u32 v1, s35, v7
  buffer_load_dwordx4 v[40:43], v1, s[8:11], 0 offen
  v_mfma_f32_16x16x32_bf16 a[36:39], v[108:111], v[76:79], a[36:39]
  v_mfma_f32_16x16x32_bf16 a[40:43], v[108:111], v[80:83], a[40:43]
  buffer_load_dwordx4 v[44:47], v1, s[8:11], s49 offen
  v_mfma_f32_16x16x32_bf16 a[44:47], v[108:111], v[84:87], a[44:47]
  v_mfma_f32_16x16x32_bf16 a[48:51], v[108:111], v[88:91], a[48:51]
  buffer_load_dwordx4 v[48:51], v1, s[8:11], s50 offen
  v_mfma_f32_16x16x32_bf16 a[52:55], v[108:111], v[92:95], a[52:55]
  v_mfma_f32_16x16x32_bf16 a[56:59], v[108:111], v[96:99], a[56:59]
  buffer_load_dwordx4 v[52:55], v1, s[8:11], s51 offen
  v_mfma_f32_16x16x32_bf16 a[60:63], v[108:111], v[100:103], a[60:63]
  ds_read_b64_tr_b16 v[108:109], v3 offset:4104
  ds_read_b64_tr_b16 v[110:111], v3 offset:6152
  s_waitcnt lgkmcnt(6)
  v_mfma_f32_16x16x32_bf16 a[64:67], v[112:115], v[72:75], a[64:67]
  buffer_load_dwordx4 v[56:59], v1, s[8:11], s52 offen
  v_mfma_f32_16x16x32_bf16 a[68:71], v[112:115], v[76:79], a[68:71]
  v_mfma_f32_16x16x32_bf16 a[72:75], v[112:115], v[80:83], a[72:75]
  buffer_load_dwordx4 v[60:63], v1, s[8:11], s53 offen
  v_mfma_f32_16x16x32_bf16 a[76:79], v[112:115], v[84:87], a[76:79]
  v_mfma_f32_16x16x32_bf16 a[80:83], v[112:115], v[88:91], a[80:83]
  buffer_load_dwordx4 v[64:67], v1, s[8:11], s54 offen
  v_mfma_f32_16x16x32_bf16 a[84:87], v[112:115], v[92:95], a[84:87]
  v_mfma_f32_16x16x32_bf16 a[88:91], v[112:115], v[96:99], a[88:91]
  buffer_load_dwordx4 v[68:71], v1, s[8:11], s55 offen
  v_mfma_f32_16x16x32_bf16 a[92:95], v[112:115], v[100:103], a[92:95]
  ds_read_b64_tr_b16 v[112:113], v3 offset:4608
  ds_read_b64_tr_b16 v[114:115], v3 offset:6656
  s_waitcnt lgkmcnt(6)
  v_mfma_f32_16x16x32_bf16 a[96:99], v[116:119], v[72:75], a[96:99]
  v_mfma_f32_16x16x32_bf16 a[100:103], v[116:119], v[76:79], a[100:103]
  v_mfma_f32_16x16x32_bf16 a[104:107], v[116:119], v[80:83], a[104:107]
  v_mfma_f32_16x16x32_bf16 a[108:111], v[116:119], v[84:87], a[108:111]
  v_mfma_f32_16x16x32_bf16 a[112:115], v[116:119], v[88:91], a[112:115]
  v_mfma_f32_16x16x32_bf16 a[116:119], v[116:119], v[92:95], a[116:119]
  v_mfma_f32_16x16x32_bf16 a[120:123], v[116:119], v[96:99], a[120:123]
  v_mfma_f32_16x16x32_bf16 a[124:127], v[116:119], v[100:103], a[124:127]
  ds_read_b64_tr_b16 v[116:117], v3 offset:4616
  ds_read_b64_tr_b16 v[118:119], v3 offset:6664
  s_waitcnt vmcnt(8)
  s_waitcnt lgkmcnt(6)
  v_mfma_f32_16x16x32_bf16 a[0:3], v[104:107], v[8:11], a[0:3]
  s_add_u32 s35, s34, 23
  s_and_b32 s35, s35, 3
  s_add_u32 s35, s35, 20
  s_mul_i32 s35, s35, 40960
  v_add_u32 v2, s35, v6
  s_add_u32 m0, s32, 12288
  s_nop 0
  buffer_load_dwordx4 v2, s[12:15], 0 offen lds
  v_mfma_f32_16x16x32_bf16 a[4:7], v[104:107], v[12:15], a[4:7]
  v_mfma_f32_16x16x32_bf16 a[8:11], v[104:107], v[16:19], a[8:11]
  s_add_u32 m0, s32, 13312
  s_nop 0
  buffer_load_dwordx4 v2, s[12:15], s57 offen lds
  v_mfma_f32_16x16x32_bf16 a[12:15], v[104:107], v[20:23], a[12:15]
  v_mfma_f32_16x16x32_bf16 a[16:19], v[104:107], v[24:27], a[16:19]
  s_add_u32 m0, s32, 14336
  s_nop 0
  buffer_load_dwordx4 v2, s[12:15], s58 offen lds
  v_mfma_f32_16x16x32_bf16 a[20:23], v[104:107], v[28:31], a[20:23]
  v_mfma_f32_16x16x32_bf16 a[24:27], v[104:107], v[32:35], a[24:27]
  s_add_u32 m0, s32, 15360
  s_nop 0
  buffer_load_dwordx4 v2, s[12:15], s59 offen lds
  v_mfma_f32_16x16x32_bf16 a[28:31], v[104:107], v[36:39], a[28:31]
  ds_read_b64_tr_b16 v[104:105], v3 offset:8192
  ds_read_b64_tr_b16 v[106:107], v3 offset:10240
  s_waitcnt lgkmcnt(6)
  v_mfma_f32_16x16x32_bf16 a[32:35], v[108:111], v[8:11], a[32:35]
  s_add_u32 s35, s34, 23
  s_and_b32 s35, s35, 3
  s_add_u32 s35, s35, 20
  s_lshl_b32 s35, s35, 10
  v_add_u32 v1, s35, v7
  buffer_load_dwordx4 v[72:75], v1, s[8:11], 0 offen
  v_mfma_f32_16x16x32_bf16 a[36:39], v[108:111], v[12:15], a[36:39]
  v_mfma_f32_16x16x32_bf16 a[40:43], v[108:111], v[16:19], a[40:43]
  buffer_load_dwordx4 v[76:79], v1, s[8:11], s49 offen
  v_mfma_f32_16x16x32_bf16 a[44:47], v[108:111], v[20:23], a[44:47]
  v_mfma_f32_16x16x32_bf16 a[48:51], v[108:111], v[24:27], a[48:51]
  buffer_load_dwordx4 v[80:83], v1, s[8:11], s50 offen
  v_mfma_f32_16x16x32_bf16 a[52:55], v[108:111], v[28:31], a[52:55]
  v_mfma_f32_16x16x32_bf16 a[56:59], v[108:111], v[32:35], a[56:59]
  buffer_load_dwordx4 v[84:87], v1, s[8:11], s51 offen
  v_mfma_f32_16x16x32_bf16 a[60:63], v[108:111], v[36:39], a[60:63]
  ds_read_b64_tr_b16 v[108:109], v3 offset:8200
  ds_read_b64_tr_b16 v[110:111], v3 offset:10248
  s_waitcnt lgkmcnt(6)
  v_mfma_f32_16x16x32_bf16 a[64:67], v[112:115], v[8:11], a[64:67]
  buffer_load_dwordx4 v[88:91], v1, s[8:11], s52 offen
  v_mfma_f32_16x16x32_bf16 a[68:71], v[112:115], v[12:15], a[68:71]
  v_mfma_f32_16x16x32_bf16 a[72:75], v[112:115], v[16:19], a[72:75]
  buffer_load_dwordx4 v[92:95], v1, s[8:11], s53 offen
  v_mfma_f32_16x16x32_bf16 a[76:79], v[112:115], v[20:23], a[76:79]
  v_mfma_f32_16x16x32_bf16 a[80:83], v[112:115], v[24:27], a[80:83]
  buffer_load_dwordx4 v[96:99], v1, s[8:11], s54 offen
  v_mfma_f32_16x16x32_bf16 a[84:87], v[112:115], v[28:31], a[84:87]
  v_mfma_f32_16x16x32_bf16 a[88:91], v[112:115], v[32:35], a[88:91]
  buffer_load_dwordx4 v[100:103], v1, s[8:11], s55 offen
  v_mfma_f32_16x16x32_bf16 a[92:95], v[112:115], v[36:39], a[92:95]
  ds_read_b64_tr_b16 v[112:113], v3 offset:8704
  ds_read_b64_tr_b16 v[114:115], v3 offset:10752
  s_waitcnt lgkmcnt(6)
  v_mfma_f32_16x16x32_bf16 a[96:99], v[116:119], v[8:11], a[96:99]
  v_mfma_f32_16x16x32_bf16 a[100:103], v[116:119], v[12:15], a[100:103]
  v_mfma_f32_16x16x32_bf16 a[104:107], v[116:119], v[16:19], a[104:107]
  v_mfma_f32_16x16x32_bf16 a[108:111], v[116:119], v[20:23], a[108:111]
  v_mfma_f32_16x16x32_bf16 a[112:115], v[116:119], v[24:27], a[112:115]
  v_mfma_f32_16x16x32_bf16 a[116:119], v[116:119], v[28:31], a[116:119]
  v_mfma_f32_16x16x32_bf16 a[120:123], v[116:119], v[32:35], a[120:123]
  v_mfma_f32_16x16x32_bf16 a[124:127], v[116:119], v[36:39], a[124:127]
  ds_read_b64_tr_b16 v[116:117], v3 offset:8712
  ds_read_b64_tr_b16 v[118:119], v3 offset:10760
  s_waitcnt vmcnt(8)
  s_waitcnt lgkmcnt(6)
  v_mfma_f32_16x16x32_bf16 a[0:3], v[104:107], v[40:43], a[0:3]
  s_add_u32 s35, s34, 24
  s_and_b32 s35, s35, 3
  s_add_u32 s35, s35, 24
  s_mul_i32 s35, s35, 40960
  v_add_u32 v2, s35, v6
  s_add_u32 m0, s32, 0
  s_nop 0
  buffer_load_dwordx4 v2, s[12:15], 0 offen lds
  v_mfma_f32_16x16x32_bf16 a[4:7], v[104:107], v[44:47], a[4:7]
  v_mfma_f32_16x16x32_bf16 a[8:11], v[104:107], v[48:51], a[8:11]
  s_add_u32 m0, s32, 1024
  s_nop 0
  buffer_load_dwordx4 v2, s[12:15], s57 offen lds
  v_mfma_f32_16x16x32_bf16 a[12:15], v[104:107], v[52:55], a[12:15]
  v_mfma_f32_16x16x32_bf16 a[16:19], v[104:107], v[56:59], a[16:19]
  s_add_u32 m0, s32, 2048
  s_nop 0
  buffer_load_dwordx4 v2, s[12:15], s58 offen lds
  v_mfma_f32_16x16x32_bf16 a[20:23], v[104:107], v[60:63], a[20:23]
  v_mfma_f32_16x16x32_bf16 a[24:27], v[104:107], v[64:67], a[24:27]
  s_add_u32 m0, s32, 3072
  s_nop 0
  buffer_load_dwordx4 v2, s[12:15], s59 offen lds
  v_mfma_f32_16x16x32_bf16 a[28:31], v[104:107], v[68:71], a[28:31]
  ds_read_b64_tr_b16 v[104:105], v3 offset:12288
  ds_read_b64_tr_b16 v[106:107], v3 offset:14336
  s_waitcnt lgkmcnt(6)
  v_mfma_f32_16x16x32_bf16 a[32:35], v[108:111], v[40:43], a[32:35]
  s_add_u32 s35, s34, 24
  s_and_b32 s35, s35, 3
  s_add_u32 s35, s35, 24
  s_lshl_b32 s35, s35, 10
  v_add_u32 v1, s35, v7
  buffer_load_dwordx4 v[8:11], v1, s[8:11], 0 offen
  v_mfma_f32_16x16x32_bf16 a[36:39], v[108:111], v[44:47], a[36:39]
  v_mfma_f32_16x16x32_bf16 a[40:43], v[108:111], v[48:51], a[40:43]
  buffer_load_dwordx4 v[12:15], v1, s[8:11], s49 offen
  v_mfma_f32_16x16x32_bf16 a[44:47], v[108:111], v[52:55], a[44:47]
  v_mfma_f32_16x16x32_bf16 a[48:51], v[108:111], v[56:59], a[48:51]
  buffer_load_dwordx4 v[16:19], v1, s[8:11], s50 offen
  v_mfma_f32_16x16x32_bf16 a[52:55], v[108:111], v[60:63], a[52:55]
  v_mfma_f32_16x16x32_bf16 a[56:59], v[108:111], v[64:67], a[56:59]
  buffer_load_dwordx4 v[20:23], v1, s[8:11], s51 offen
  v_mfma_f32_16x16x32_bf16 a[60:63], v[108:111], v[68:71], a[60:63]
  ds_read_b64_tr_b16 v[108:109], v3 offset:12296
  ds_read_b64_tr_b16 v[110:111], v3 offset:14344
  s_waitcnt lgkmcnt(6)
  v_mfma_f32_16x16x32_bf16 a[64:67], v[112:115], v[40:43], a[64:67]
  buffer_load_dwordx4 v[24:27], v1, s[8:11], s52 offen
  v_mfma_f32_16x16x32_bf16 a[68:71], v[112:115], v[44:47], a[68:71]
  v_mfma_f32_16x16x32_bf16 a[72:75], v[112:115], v[48:51], a[72:75]
  buffer_load_dwordx4 v[28:31], v1, s[8:11], s53 offen
  v_mfma_f32_16x16x32_bf16 a[76:79], v[112:115], v[52:55], a[76:79]
  v_mfma_f32_16x16x32_bf16 a[80:83], v[112:115], v[56:59], a[80:83]
  buffer_load_dwordx4 v[32:35], v1, s[8:11], s54 offen
  v_mfma_f32_16x16x32_bf16 a[84:87], v[112:115], v[60:63], a[84:87]
  v_mfma_f32_16x16x32_bf16 a[88:91], v[112:115], v[64:67], a[88:91]
  buffer_load_dwordx4 v[36:39], v1, s[8:11], s55 offen
  v_mfma_f32_16x16x32_bf16 a[92:95], v[112:115], v[68:71], a[92:95]
  ds_read_b64_tr_b16 v[112:113], v3 offset:12800
  ds_read_b64_tr_b16 v[114:115], v3 offset:14848
  s_waitcnt lgkmcnt(6)
  v_mfma_f32_16x16x32_bf16 a[96:99], v[116:119], v[40:43], a[96:99]
  v_mfma_f32_16x16x32_bf16 a[100:103], v[116:119], v[44:47], a[100:103]
  v_mfma_f32_16x16x32_bf16 a[104:107], v[116:119], v[48:51], a[104:107]
  v_mfma_f32_16x16x32_bf16 a[108:111], v[116:119], v[52:55], a[108:111]
  v_mfma_f32_16x16x32_bf16 a[112:115], v[116:119], v[56:59], a[112:115]
  v_mfma_f32_16x16x32_bf16 a[116:119], v[116:119], v[60:63], a[116:119]
  v_mfma_f32_16x16x32_bf16 a[120:123], v[116:119], v[64:67], a[120:123]
  v_mfma_f32_16x16x32_bf16 a[124:127], v[116:119], v[68:71], a[124:127]
  ds_read_b64_tr_b16 v[116:117], v3 offset:12808
  ds_read_b64_tr_b16 v[118:119], v3 offset:14856
  s_waitcnt vmcnt(8)
  s_waitcnt lgkmcnt(6)
  v_mfma_f32_16x16x32_bf16 a[0:3], v[104:107], v[72:75], a[0:3]
  s_add_u32 s35, s34, 25
  s_and_b32 s35, s35, 3
  s_add_u32 s35, s35, 24
  s_mul_i32 s35, s35, 40960
  v_add_u32 v2, s35, v6
  s_add_u32 m0, s32, 4096
  s_nop 0
  buffer_load_dwordx4 v2, s[12:15], 0 offen lds
  v_mfma_f32_16x16x32_bf16 a[4:7], v[104:107], v[76:79], a[4:7]
  v_mfma_f32_16x16x32_bf16 a[8:11], v[104:107], v[80:83], a[8:11]
  s_add_u32 m0, s32, 5120
  s_nop 0
  buffer_load_dwordx4 v2, s[12:15], s57 offen lds
  v_mfma_f32_16x16x32_bf16 a[12:15], v[104:107], v[84:87], a[12:15]
  v_mfma_f32_16x16x32_bf16 a[16:19], v[104:107], v[88:91], a[16:19]
  s_add_u32 m0, s32, 6144
  s_nop 0
  buffer_load_dwordx4 v2, s[12:15], s58 offen lds
  v_mfma_f32_16x16x32_bf16 a[20:23], v[104:107], v[92:95], a[20:23]
  v_mfma_f32_16x16x32_bf16 a[24:27], v[104:107], v[96:99], a[24:27]
  s_add_u32 m0, s32, 7168
  s_nop 0
  buffer_load_dwordx4 v2, s[12:15], s59 offen lds
  v_mfma_f32_16x16x32_bf16 a[28:31], v[104:107], v[100:103], a[28:31]
  ds_read_b64_tr_b16 v[104:105], v3 offset:0
  ds_read_b64_tr_b16 v[106:107], v3 offset:2048
  s_waitcnt lgkmcnt(6)
  v_mfma_f32_16x16x32_bf16 a[32:35], v[108:111], v[72:75], a[32:35]
  s_add_u32 s35, s34, 25
  s_and_b32 s35, s35, 3
  s_add_u32 s35, s35, 24
  s_lshl_b32 s35, s35, 10
  v_add_u32 v1, s35, v7
  buffer_load_dwordx4 v[40:43], v1, s[8:11], 0 offen
  v_mfma_f32_16x16x32_bf16 a[36:39], v[108:111], v[76:79], a[36:39]
  v_mfma_f32_16x16x32_bf16 a[40:43], v[108:111], v[80:83], a[40:43]
  buffer_load_dwordx4 v[44:47], v1, s[8:11], s49 offen
  v_mfma_f32_16x16x32_bf16 a[44:47], v[108:111], v[84:87], a[44:47]
  v_mfma_f32_16x16x32_bf16 a[48:51], v[108:111], v[88:91], a[48:51]
  buffer_load_dwordx4 v[48:51], v1, s[8:11], s50 offen
  v_mfma_f32_16x16x32_bf16 a[52:55], v[108:111], v[92:95], a[52:55]
  v_mfma_f32_16x16x32_bf16 a[56:59], v[108:111], v[96:99], a[56:59]
  buffer_load_dwordx4 v[52:55], v1, s[8:11], s51 offen
  v_mfma_f32_16x16x32_bf16 a[60:63], v[108:111], v[100:103], a[60:63]
  ds_read_b64_tr_b16 v[108:109], v3 offset:8
  ds_read_b64_tr_b16 v[110:111], v3 offset:2056
  s_waitcnt lgkmcnt(6)
  v_mfma_f32_16x16x32_bf16 a[64:67], v[112:115], v[72:75], a[64:67]
  buffer_load_dwordx4 v[56:59], v1, s[8:11], s52 offen
  v_mfma_f32_16x16x32_bf16 a[68:71], v[112:115], v[76:79], a[68:71]
  v_mfma_f32_16x16x32_bf16 a[72:75], v[112:115], v[80:83], a[72:75]
  buffer_load_dwordx4 v[60:63], v1, s[8:11], s53 offen
  v_mfma_f32_16x16x32_bf16 a[76:79], v[112:115], v[84:87], a[76:79]
  v_mfma_f32_16x16x32_bf16 a[80:83], v[112:115], v[88:91], a[80:83]
  buffer_load_dwordx4 v[64:67], v1, s[8:11], s54 offen
  v_mfma_f32_16x16x32_bf16 a[84:87], v[112:115], v[92:95], a[84:87]
  v_mfma_f32_16x16x32_bf16 a[88:91], v[112:115], v[96:99], a[88:91]
  buffer_load_dwordx4 v[68:71], v1, s[8:11], s55 offen
  v_mfma_f32_16x16x32_bf16 a[92:95], v[112:115], v[100:103], a[92:95]
  ds_read_b64_tr_b16 v[112:113], v3 offset:512
  ds_read_b64_tr_b16 v[114:115], v3 offset:2560
  s_waitcnt lgkmcnt(6)
  v_mfma_f32_16x16x32_bf16 a[96:99], v[116:119], v[72:75], a[96:99]
  v_mfma_f32_16x16x32_bf16 a[100:103], v[116:119], v[76:79], a[100:103]
  v_mfma_f32_16x16x32_bf16 a[104:107], v[116:119], v[80:83], a[104:107]
  v_mfma_f32_16x16x32_bf16 a[108:111], v[116:119], v[84:87], a[108:111]
  v_mfma_f32_16x16x32_bf16 a[112:115], v[116:119], v[88:91], a[112:115]
  v_mfma_f32_16x16x32_bf16 a[116:119], v[116:119], v[92:95], a[116:119]
  v_mfma_f32_16x16x32_bf16 a[120:123], v[116:119], v[96:99], a[120:123]
  v_mfma_f32_16x16x32_bf16 a[124:127], v[116:119], v[100:103], a[124:127]
  ds_read_b64_tr_b16 v[116:117], v3 offset:520
  ds_read_b64_tr_b16 v[118:119], v3 offset:2568
  s_waitcnt vmcnt(8)
  s_waitcnt lgkmcnt(6)
  v_mfma_f32_16x16x32_bf16 a[0:3], v[104:107], v[8:11], a[0:3]
  s_add_u32 s35, s34, 26
  s_and_b32 s35, s35, 3
  s_add_u32 s35, s35, 24
  s_mul_i32 s35, s35, 40960
  v_add_u32 v2, s35, v6
  s_add_u32 m0, s32, 8192
  s_nop 0
  buffer_load_dwordx4 v2, s[12:15], 0 offen lds
  v_mfma_f32_16x16x32_bf16 a[4:7], v[104:107], v[12:15], a[4:7]
  v_mfma_f32_16x16x32_bf16 a[8:11], v[104:107], v[16:19], a[8:11]
  s_add_u32 m0, s32, 9216
  s_nop 0
  buffer_load_dwordx4 v2, s[12:15], s57 offen lds
  v_mfma_f32_16x16x32_bf16 a[12:15], v[104:107], v[20:23], a[12:15]
  v_mfma_f32_16x16x32_bf16 a[16:19], v[104:107], v[24:27], a[16:19]
  s_add_u32 m0, s32, 10240
  s_nop 0
  buffer_load_dwordx4 v2, s[12:15], s58 offen lds
  v_mfma_f32_16x16x32_bf16 a[20:23], v[104:107], v[28:31], a[20:23]
  v_mfma_f32_16x16x32_bf16 a[24:27], v[104:107], v[32:35], a[24:27]
  s_add_u32 m0, s32, 11264
  s_nop 0
  buffer_load_dwordx4 v2, s[12:15], s59 offen lds
  v_mfma_f32_16x16x32_bf16 a[28:31], v[104:107], v[36:39], a[28:31]
  ds_read_b64_tr_b16 v[104:105], v3 offset:4096
  ds_read_b64_tr_b16 v[106:107], v3 offset:6144
  s_waitcnt lgkmcnt(6)
  v_mfma_f32_16x16x32_bf16 a[32:35], v[108:111], v[8:11], a[32:35]
  s_add_u32 s35, s34, 26
  s_and_b32 s35, s35, 3
  s_add_u32 s35, s35, 24
  s_lshl_b32 s35, s35, 10
  v_add_u32 v1, s35, v7
  buffer_load_dwordx4 v[72:75], v1, s[8:11], 0 offen
  v_mfma_f32_16x16x32_bf16 a[36:39], v[108:111], v[12:15], a[36:39]
  v_mfma_f32_16x16x32_bf16 a[40:43], v[108:111], v[16:19], a[40:43]
  buffer_load_dwordx4 v[76:79], v1, s[8:11], s49 offen
  v_mfma_f32_16x16x32_bf16 a[44:47], v[108:111], v[20:23], a[44:47]
  v_mfma_f32_16x16x32_bf16 a[48:51], v[108:111], v[24:27], a[48:51]
  buffer_load_dwordx4 v[80:83], v1, s[8:11], s50 offen
  v_mfma_f32_16x16x32_bf16 a[52:55], v[108:111], v[28:31], a[52:55]
  v_mfma_f32_16x16x32_bf16 a[56:59], v[108:111], v[32:35], a[56:59]
  buffer_load_dwordx4 v[84:87], v1, s[8:11], s51 offen
  v_mfma_f32_16x16x32_bf16 a[60:63], v[108:111], v[36:39], a[60:63]
  ds_read_b64_tr_b16 v[108:109], v3 offset:4104
  ds_read_b64_tr_b16 v[110:111], v3 offset:6152
  s_waitcnt lgkmcnt(6)
  v_mfma_f32_16x16x32_bf16 a[64:67], v[112:115], v[8:11], a[64:67]
  buffer_load_dwordx4 v[88:91], v1, s[8:11], s52 offen
  v_mfma_f32_16x16x32_bf16 a[68:71], v[112:115], v[12:15], a[68:71]
  v_mfma_f32_16x16x32_bf16 a[72:75], v[112:115], v[16:19], a[72:75]
  buffer_load_dwordx4 v[92:95], v1, s[8:11], s53 offen
  v_mfma_f32_16x16x32_bf16 a[76:79], v[112:115], v[20:23], a[76:79]
  v_mfma_f32_16x16x32_bf16 a[80:83], v[112:115], v[24:27], a[80:83]
  buffer_load_dwordx4 v[96:99], v1, s[8:11], s54 offen
  v_mfma_f32_16x16x32_bf16 a[84:87], v[112:115], v[28:31], a[84:87]
  v_mfma_f32_16x16x32_bf16 a[88:91], v[112:115], v[32:35], a[88:91]
  buffer_load_dwordx4 v[100:103], v1, s[8:11], s55 offen
  v_mfma_f32_16x16x32_bf16 a[92:95], v[112:115], v[36:39], a[92:95]
  ds_read_b64_tr_b16 v[112:113], v3 offset:4608
  ds_read_b64_tr_b16 v[114:115], v3 offset:6656
  s_waitcnt lgkmcnt(6)
  v_mfma_f32_16x16x32_bf16 a[96:99], v[116:119], v[8:11], a[96:99]
  v_mfma_f32_16x16x32_bf16 a[100:103], v[116:119], v[12:15], a[100:103]
  v_mfma_f32_16x16x32_bf16 a[104:107], v[116:119], v[16:19], a[104:107]
  v_mfma_f32_16x16x32_bf16 a[108:111], v[116:119], v[20:23], a[108:111]
  v_mfma_f32_16x16x32_bf16 a[112:115], v[116:119], v[24:27], a[112:115]
  v_mfma_f32_16x16x32_bf16 a[116:119], v[116:119], v[28:31], a[116:119]
  v_mfma_f32_16x16x32_bf16 a[120:123], v[116:119], v[32:35], a[120:123]
  v_mfma_f32_16x16x32_bf16 a[124:127], v[116:119], v[36:39], a[124:127]
  ds_read_b64_tr_b16 v[116:117], v3 offset:4616
  ds_read_b64_tr_b16 v[118:119], v3 offset:6664
  s_waitcnt vmcnt(8)
  s_waitcnt lgkmcnt(6)
  v_mfma_f32_16x16x32_bf16 a[0:3], v[104:107], v[40:43], a[0:3]
  s_add_u32 s35, s34, 27
  s_and_b32 s35, s35, 3
  s_add_u32 s35, s35, 24
  s_mul_i32 s35, s35, 40960
  v_add_u32 v2, s35, v6
  s_add_u32 m0, s32, 12288
  s_nop 0
  buffer_load_dwordx4 v2, s[12:15], 0 offen lds
  v_mfma_f32_16x16x32_bf16 a[4:7], v[104:107], v[44:47], a[4:7]
  v_mfma_f32_16x16x32_bf16 a[8:11], v[104:107], v[48:51], a[8:11]
  s_add_u32 m0, s32, 13312
  s_nop 0
  buffer_load_dwordx4 v2, s[12:15], s57 offen lds
  v_mfma_f32_16x16x32_bf16 a[12:15], v[104:107], v[52:55], a[12:15]
  v_mfma_f32_16x16x32_bf16 a[16:19], v[104:107], v[56:59], a[16:19]
  s_add_u32 m0, s32, 14336
  s_nop 0
  buffer_load_dwordx4 v2, s[12:15], s58 offen lds
  v_mfma_f32_16x16x32_bf16 a[20:23], v[104:107], v[60:63], a[20:23]
  v_mfma_f32_16x16x32_bf16 a[24:27], v[104:107], v[64:67], a[24:27]
  s_add_u32 m0, s32, 15360
  s_nop 0
  buffer_load_dwordx4 v2, s[12:15], s59 offen lds
  v_mfma_f32_16x16x32_bf16 a[28:31], v[104:107], v[68:71], a[28:31]
  ds_read_b64_tr_b16 v[104:105], v3 offset:8192
  ds_read_b64_tr_b16 v[106:107], v3 offset:10240
  s_waitcnt lgkmcnt(6)
  v_mfma_f32_16x16x32_bf16 a[32:35], v[108:111], v[40:43], a[32:35]
  s_add_u32 s35, s34, 27
  s_and_b32 s35, s35, 3
  s_add_u32 s35, s35, 24
  s_lshl_b32 s35, s35, 10
  v_add_u32 v1, s35, v7
  buffer_load_dwordx4 v[8:11], v1, s[8:11], 0 offen
  v_mfma_f32_16x16x32_bf16 a[36:39], v[108:111], v[44:47], a[36:39]
  v_mfma_f32_16x16x32_bf16 a[40:43], v[108:111], v[48:51], a[40:43]
  buffer_load_dwordx4 v[12:15], v1, s[8:11], s49 offen
  v_mfma_f32_16x16x32_bf16 a[44:47], v[108:111], v[52:55], a[44:47]
  v_mfma_f32_16x16x32_bf16 a[48:51], v[108:111], v[56:59], a[48:51]
  buffer_load_dwordx4 v[16:19], v1, s[8:11], s50 offen
  v_mfma_f32_16x16x32_bf16 a[52:55], v[108:111], v[60:63], a[52:55]
  v_mfma_f32_16x16x32_bf16 a[56:59], v[108:111], v[64:67], a[56:59]
  buffer_load_dwordx4 v[20:23], v1, s[8:11], s51 offen
  v_mfma_f32_16x16x32_bf16 a[60:63], v[108:111], v[68:71], a[60:63]
  ds_read_b64_tr_b16 v[108:109], v3 offset:8200
  ds_read_b64_tr_b16 v[110:111], v3 offset:10248
  s_waitcnt lgkmcnt(6)
  v_mfma_f32_16x16x32_bf16 a[64:67], v[112:115], v[40:43], a[64:67]
  buffer_load_dwordx4 v[24:27], v1, s[8:11], s52 offen
  v_mfma_f32_16x16x32_bf16 a[68:71], v[112:115], v[44:47], a[68:71]
  v_mfma_f32_16x16x32_bf16 a[72:75], v[112:115], v[48:51], a[72:75]
  buffer_load_dwordx4 v[28:31], v1, s[8:11], s53 offen
  v_mfma_f32_16x16x32_bf16 a[76:79], v[112:115], v[52:55], a[76:79]
  v_mfma_f32_16x16x32_bf16 a[80:83], v[112:115], v[56:59], a[80:83]
  buffer_load_dwordx4 v[32:35], v1, s[8:11], s54 offen
  v_mfma_f32_16x16x32_bf16 a[84:87], v[112:115], v[60:63], a[84:87]
  v_mfma_f32_16x16x32_bf16 a[88:91], v[112:115], v[64:67], a[88:91]
  buffer_load_dwordx4 v[36:39], v1, s[8:11], s55 offen
  v_mfma_f32_16x16x32_bf16 a[92:95], v[112:115], v[68:71], a[92:95]
  ds_read_b64_tr_b16 v[112:113], v3 offset:8704
  ds_read_b64_tr_b16 v[114:115], v3 offset:10752
  s_waitcnt lgkmcnt(6)
  v_mfma_f32_16x16x32_bf16 a[96:99], v[116:119], v[40:43], a[96:99]
  v_mfma_f32_16x16x32_bf16 a[100:103], v[116:119], v[44:47], a[100:103]
  v_mfma_f32_16x16x32_bf16 a[104:107], v[116:119], v[48:51], a[104:107]
  v_mfma_f32_16x16x32_bf16 a[108:111], v[116:119], v[52:55], a[108:111]
  v_mfma_f32_16x16x32_bf16 a[112:115], v[116:119], v[56:59], a[112:115]
  v_mfma_f32_16x16x32_bf16 a[116:119], v[116:119], v[60:63], a[116:119]
  v_mfma_f32_16x16x32_bf16 a[120:123], v[116:119], v[64:67], a[120:123]
  v_mfma_f32_16x16x32_bf16 a[124:127], v[116:119], v[68:71], a[124:127]
  ds_read_b64_tr_b16 v[116:117], v3 offset:8712
  ds_read_b64_tr_b16 v[118:119], v3 offset:10760
  s_waitcnt vmcnt(8)
  s_waitcnt lgkmcnt(6)
  v_mfma_f32_16x16x32_bf16 a[0:3], v[104:107], v[72:75], a[0:3]
  s_add_u32 s35, s34, 28
  s_and_b32 s35, s35, 3
  s_add_u32 s35, s35, 28
  s_mul_i32 s35, s35, 40960
  v_add_u32 v2, s35, v6
  s_add_u32 m0, s32, 0
  s_nop 0
  buffer_load_dwordx4 v2, s[12:15], 0 offen lds
  v_mfma_f32_16x16x32_bf16 a[4:7], v[104:107], v[76:79], a[4:7]
  v_mfma_f32_16x16x32_bf16 a[8:11], v[104:107], v[80:83], a[8:11]
  s_add_u32 m0, s32, 1024
  s_nop 0
  buffer_load_dwordx4 v2, s[12:15], s57 offen lds
  v_mfma_f32_16x16x32_bf16 a[12:15], v[104:107], v[84:87], a[12:15]
  v_mfma_f32_16x16x32_bf16 a[16:19], v[104:107], v[88:91], a[16:19]
  s_add_u32 m0, s32, 2048
  s_nop 0
  buffer_load_dwordx4 v2, s[12:15], s58 offen lds
  v_mfma_f32_16x16x32_bf16 a[20:23], v[104:107], v[92:95], a[20:23]
  v_mfma_f32_16x16x32_bf16 a[24:27], v[104:107], v[96:99], a[24:27]
  s_add_u32 m0, s32, 3072
  s_nop 0
  buffer_load_dwordx4 v2, s[12:15], s59 offen lds
  v_mfma_f32_16x16x32_bf16 a[28:31], v[104:107], v[100:103], a[28:31]
  ds_read_b64_tr_b16 v[104:105], v3 offset:12288
  ds_read_b64_tr_b16 v[106:107], v3 offset:14336
  s_waitcnt lgkmcnt(6)
  v_mfma_f32_16x16x32_bf16 a[32:35], v[108:111], v[72:75], a[32:35]
  s_add_u32 s35, s34, 28
  s_and_b32 s35, s35, 3
  s_add_u32 s35, s35, 28
  s_lshl_b32 s35, s35, 10
  v_add_u32 v1, s35, v7
  buffer_load_dwordx4 v[40:43], v1, s[8:11], 0 offen
  v_mfma_f32_16x16x32_bf16 a[36:39], v[108:111], v[76:79], a[36:39]
  v_mfma_f32_16x16x32_bf16 a[40:43], v[108:111], v[80:83], a[40:43]
  buffer_load_dwordx4 v[44:47], v1, s[8:11], s49 offen
  v_mfma_f32_16x16x32_bf16 a[44:47], v[108:111], v[84:87], a[44:47]
  v_mfma_f32_16x16x32_bf16 a[48:51], v[108:111], v[88:91], a[48:51]
  buffer_load_dwordx4 v[48:51], v1, s[8:11], s50 offen
  v_mfma_f32_16x16x32_bf16 a[52:55], v[108:111], v[92:95], a[52:55]
  v_mfma_f32_16x16x32_bf16 a[56:59], v[108:111], v[96:99], a[56:59]
  buffer_load_dwordx4 v[52:55], v1, s[8:11], s51 offen
  v_mfma_f32_16x16x32_bf16 a[60:63], v[108:111], v[100:103], a[60:63]
  ds_read_b64_tr_b16 v[108:109], v3 offset:12296
  ds_read_b64_tr_b16 v[110:111], v3 offset:14344
  s_waitcnt lgkmcnt(6)
  v_mfma_f32_16x16x32_bf16 a[64:67], v[112:115], v[72:75], a[64:67]
  buffer_load_dwordx4 v[56:59], v1, s[8:11], s52 offen
  v_mfma_f32_16x16x32_bf16 a[68:71], v[112:115], v[76:79], a[68:71]
  v_mfma_f32_16x16x32_bf16 a[72:75], v[112:115], v[80:83], a[72:75]
  buffer_load_dwordx4 v[60:63], v1, s[8:11], s53 offen
  v_mfma_f32_16x16x32_bf16 a[76:79], v[112:115], v[84:87], a[76:79]
  v_mfma_f32_16x16x32_bf16 a[80:83], v[112:115], v[88:91], a[80:83]
  buffer_load_dwordx4 v[64:67], v1, s[8:11], s54 offen
  v_mfma_f32_16x16x32_bf16 a[84:87], v[112:115], v[92:95], a[84:87]
  v_mfma_f32_16x16x32_bf16 a[88:91], v[112:115], v[96:99], a[88:91]
  buffer_load_dwordx4 v[68:71], v1, s[8:11], s55 offen
  v_mfma_f32_16x16x32_bf16 a[92:95], v[112:115], v[100:103], a[92:95]
  ds_read_b64_tr_b16 v[112:113], v3 offset:12800
  ds_read_b64_tr_b16 v[114:115], v3 offset:14848
  s_waitcnt lgkmcnt(6)
  v_mfma_f32_16x16x32_bf16 a[96:99], v[116:119], v[72:75], a[96:99]
  v_mfma_f32_16x16x32_bf16 a[100:103], v[116:119], v[76:79], a[100:103]
  v_mfma_f32_16x16x32_bf16 a[104:107], v[116:119], v[80:83], a[104:107]
  v_mfma_f32_16x16x32_bf16 a[108:111], v[116:119], v[84:87], a[108:111]
  v_mfma_f32_16x16x32_bf16 a[112:115], v[116:119], v[88:91], a[112:115]
  v_mfma_f32_16x16x32_bf16 a[116:119], v[116:119], v[92:95], a[116:119]
  v_mfma_f32_16x16x32_bf16 a[120:123], v[116:119], v[96:99], a[120:123]
  v_mfma_f32_16x16x32_bf16 a[124:127], v[116:119], v[100:103], a[124:127]
  ds_read_b64_tr_b16 v[116:117], v3 offset:12808
  ds_read_b64_tr_b16 v[118:119], v3 offset:14856
  s_waitcnt vmcnt(8)
  s_waitcnt lgkmcnt(6)
  v_mfma_f32_16x16x32_bf16 a[0:3], v[104:107], v[8:11], a[0:3]
  s_add_u32 s35, s34, 29
  s_and_b32 s35, s35, 3
  s_add_u32 s35, s35, 28
  s_mul_i32 s35, s35, 40960
  v_add_u32 v2, s35, v6
  s_add_u32 m0, s32, 4096
  s_nop 0
  buffer_load_dwordx4 v2, s[12:15], 0 offen lds
  v_mfma_f32_16x16x32_bf16 a[4:7], v[104:107], v[12:15], a[4:7]
  v_mfma_f32_16x16x32_bf16 a[8:11], v[104:107], v[16:19], a[8:11]
  s_add_u32 m0, s32, 5120
  s_nop 0
  buffer_load_dwordx4 v2, s[12:15], s57 offen lds
  v_mfma_f32_16x16x32_bf16 a[12:15], v[104:107], v[20:23], a[12:15]
  v_mfma_f32_16x16x32_bf16 a[16:19], v[104:107], v[24:27], a[16:19]
  s_add_u32 m0, s32, 6144
  s_nop 0
  buffer_load_dwordx4 v2, s[12:15], s58 offen lds
  v_mfma_f32_16x16x32_bf16 a[20:23], v[104:107], v[28:31], a[20:23]
  v_mfma_f32_16x16x32_bf16 a[24:27], v[104:107], v[32:35], a[24:27]
  s_add_u32 m0, s32, 7168
  s_nop 0
  buffer_load_dwordx4 v2, s[12:15], s59 offen lds
  v_mfma_f32_16x16x32_bf16 a[28:31], v[104:107], v[36:39], a[28:31]
  ds_read_b64_tr_b16 v[104:105], v3 offset:0
  ds_read_b64_tr_b16 v[106:107], v3 offset:2048
  s_waitcnt lgkmcnt(6)
  v_mfma_f32_16x16x32_bf16 a[32:35], v[108:111], v[8:11], a[32:35]
  s_add_u32 s35, s34, 29
  s_and_b32 s35, s35, 3
  s_add_u32 s35, s35, 28
  s_lshl_b32 s35, s35, 10
  v_add_u32 v1, s35, v7
  buffer_load_dwordx4 v[72:75], v1, s[8:11], 0 offen
  v_mfma_f32_16x16x32_bf16 a[36:39], v[108:111], v[12:15], a[36:39]
  v_mfma_f32_16x16x32_bf16 a[40:43], v[108:111], v[16:19], a[40:43]
  buffer_load_dwordx4 v[76:79], v1, s[8:11], s49 offen
  v_mfma_f32_16x16x32_bf16 a[44:47], v[108:111], v[20:23], a[44:47]
  v_mfma_f32_16x16x32_bf16 a[48:51], v[108:111], v[24:27], a[48:51]
  buffer_load_dwordx4 v[80:83], v1, s[8:11], s50 offen
  v_mfma_f32_16x16x32_bf16 a[52:55], v[108:111], v[28:31], a[52:55]
  v_mfma_f32_16x16x32_bf16 a[56:59], v[108:111], v[32:35], a[56:59]
  buffer_load_dwordx4 v[84:87], v1, s[8:11], s51 offen
  v_mfma_f32_16x16x32_bf16 a[60:63], v[108:111], v[36:39], a[60:63]
  ds_read_b64_tr_b16 v[108:109], v3 offset:8
  ds_read_b64_tr_b16 v[110:111], v3 offset:2056
  s_waitcnt lgkmcnt(6)
  v_mfma_f32_16x16x32_bf16 a[64:67], v[112:115], v[8:11], a[64:67]
  buffer_load_dwordx4 v[88:91], v1, s[8:11], s52 offen
  v_mfma_f32_16x16x32_bf16 a[68:71], v[112:115], v[12:15], a[68:71]
  v_mfma_f32_16x16x32_bf16 a[72:75], v[112:115], v[16:19], a[72:75]
  buffer_load_dwordx4 v[92:95], v1, s[8:11], s53 offen
  v_mfma_f32_16x16x32_bf16 a[76:79], v[112:115], v[20:23], a[76:79]
  v_mfma_f32_16x16x32_bf16 a[80:83], v[112:115], v[24:27], a[80:83]
  buffer_load_dwordx4 v[96:99], v1, s[8:11], s54 offen
  v_mfma_f32_16x16x32_bf16 a[84:87], v[112:115], v[28:31], a[84:87]
  v_mfma_f32_16x16x32_bf16 a[88:91], v[112:115], v[32:35], a[88:91]
  buffer_load_dwordx4 v[100:103], v1, s[8:11], s55 offen
  v_mfma_f32_16x16x32_bf16 a[92:95], v[112:115], v[36:39], a[92:95]
  ds_read_b64_tr_b16 v[112:113], v3 offset:512
  ds_read_b64_tr_b16 v[114:115], v3 offset:2560
  s_waitcnt lgkmcnt(6)
  v_mfma_f32_16x16x32_bf16 a[96:99], v[116:119], v[8:11], a[96:99]
  v_mfma_f32_16x16x32_bf16 a[100:103], v[116:119], v[12:15], a[100:103]
  v_mfma_f32_16x16x32_bf16 a[104:107], v[116:119], v[16:19], a[104:107]
  v_mfma_f32_16x16x32_bf16 a[108:111], v[116:119], v[20:23], a[108:111]
  v_mfma_f32_16x16x32_bf16 a[112:115], v[116:119], v[24:27], a[112:115]
  v_mfma_f32_16x16x32_bf16 a[116:119], v[116:119], v[28:31], a[116:119]
  v_mfma_f32_16x16x32_bf16 a[120:123], v[116:119], v[32:35], a[120:123]
  v_mfma_f32_16x16x32_bf16 a[124:127], v[116:119], v[36:39], a[124:127]
  ds_read_b64_tr_b16 v[116:117], v3 offset:520
  ds_read_b64_tr_b16 v[118:119], v3 offset:2568
  s_waitcnt vmcnt(8)
  s_waitcnt lgkmcnt(6)
  v_mfma_f32_16x16x32_bf16 a[0:3], v[104:107], v[40:43], a[0:3]
  s_add_u32 s35, s34, 30
  s_and_b32 s35, s35, 3
  s_add_u32 s35, s35, 28
  s_mul_i32 s35, s35, 40960
  v_add_u32 v2, s35, v6
  s_add_u32 m0, s32, 8192
  s_nop 0
  buffer_load_dwordx4 v2, s[12:15], 0 offen lds
  v_mfma_f32_16x16x32_bf16 a[4:7], v[104:107], v[44:47], a[4:7]
  v_mfma_f32_16x16x32_bf16 a[8:11], v[104:107], v[48:51], a[8:11]
  s_add_u32 m0, s32, 9216
  s_nop 0
  buffer_load_dwordx4 v2, s[12:15], s57 offen lds
  v_mfma_f32_16x16x32_bf16 a[12:15], v[104:107], v[52:55], a[12:15]
  v_mfma_f32_16x16x32_bf16 a[16:19], v[104:107], v[56:59], a[16:19]
  s_add_u32 m0, s32, 10240
  s_nop 0
  buffer_load_dwordx4 v2, s[12:15], s58 offen lds
  v_mfma_f32_16x16x32_bf16 a[20:23], v[104:107], v[60:63], a[20:23]
  v_mfma_f32_16x16x32_bf16 a[24:27], v[104:107], v[64:67], a[24:27]
  s_add_u32 m0, s32, 11264
  s_nop 0
  buffer_load_dwordx4 v2, s[12:15], s59 offen lds
  v_mfma_f32_16x16x32_bf16 a[28:31], v[104:107], v[68:71], a[28:31]
  ds_read_b64_tr_b16 v[104:105], v3 offset:4096
  ds_read_b64_tr_b16 v[106:107], v3 offset:6144
  s_waitcnt lgkmcnt(6)
  v_mfma_f32_16x16x32_bf16 a[32:35], v[108:111], v[40:43], a[32:35]
  s_add_u32 s35, s34, 30
  s_and_b32 s35, s35, 3
  s_add_u32 s35, s35, 28
  s_lshl_b32 s35, s35, 10
  v_add_u32 v1, s35, v7
  buffer_load_dwordx4 v[8:11], v1, s[8:11], 0 offen
  v_mfma_f32_16x16x32_bf16 a[36:39], v[108:111], v[44:47], a[36:39]
  v_mfma_f32_16x16x32_bf16 a[40:43], v[108:111], v[48:51], a[40:43]
  buffer_load_dwordx4 v[12:15], v1, s[8:11], s49 offen
  v_mfma_f32_16x16x32_bf16 a[44:47], v[108:111], v[52:55], a[44:47]
  v_mfma_f32_16x16x32_bf16 a[48:51], v[108:111], v[56:59], a[48:51]
  buffer_load_dwordx4 v[16:19], v1, s[8:11], s50 offen
  v_mfma_f32_16x16x32_bf16 a[52:55], v[108:111], v[60:63], a[52:55]
  v_mfma_f32_16x16x32_bf16 a[56:59], v[108:111], v[64:67], a[56:59]
  buffer_load_dwordx4 v[20:23], v1, s[8:11], s51 offen
  v_mfma_f32_16x16x32_bf16 a[60:63], v[108:111], v[68:71], a[60:63]
  ds_read_b64_tr_b16 v[108:109], v3 offset:4104
  ds_read_b64_tr_b16 v[110:111], v3 offset:6152
  s_waitcnt lgkmcnt(6)
  v_mfma_f32_16x16x32_bf16 a[64:67], v[112:115], v[40:43], a[64:67]
  buffer_load_dwordx4 v[24:27], v1, s[8:11], s52 offen
  v_mfma_f32_16x16x32_bf16 a[68:71], v[112:115], v[44:47], a[68:71]
  v_mfma_f32_16x16x32_bf16 a[72:75], v[112:115], v[48:51], a[72:75]
  buffer_load_dwordx4 v[28:31], v1, s[8:11], s53 offen
  v_mfma_f32_16x16x32_bf16 a[76:79], v[112:115], v[52:55], a[76:79]
  v_mfma_f32_16x16x32_bf16 a[80:83], v[112:115], v[56:59], a[80:83]
  buffer_load_dwordx4 v[32:35], v1, s[8:11], s54 offen
  v_mfma_f32_16x16x32_bf16 a[84:87], v[112:115], v[60:63], a[84:87]
  v_mfma_f32_16x16x32_bf16 a[88:91], v[112:115], v[64:67], a[88:91]
  buffer_load_dwordx4 v[36:39], v1, s[8:11], s55 offen
  v_mfma_f32_16x16x32_bf16 a[92:95], v[112:115], v[68:71], a[92:95]
  ds_read_b64_tr_b16 v[112:113], v3 offset:4608
  ds_read_b64_tr_b16 v[114:115], v3 offset:6656
  s_waitcnt lgkmcnt(6)
  v_mfma_f32_16x16x32_bf16 a[96:99], v[116:119], v[40:43], a[96:99]
  v_mfma_f32_16x16x32_bf16 a[100:103], v[116:119], v[44:47], a[100:103]
  v_mfma_f32_16x16x32_bf16 a[104:107], v[116:119], v[48:51], a[104:107]
  v_mfma_f32_16x16x32_bf16 a[108:111], v[116:119], v[52:55], a[108:111]
  v_mfma_f32_16x16x32_bf16 a[112:115], v[116:119], v[56:59], a[112:115]
  v_mfma_f32_16x16x32_bf16 a[116:119], v[116:119], v[60:63], a[116:119]
  v_mfma_f32_16x16x32_bf16 a[120:123], v[116:119], v[64:67], a[120:123]
  v_mfma_f32_16x16x32_bf16 a[124:127], v[116:119], v[68:71], a[124:127]
  ds_read_b64_tr_b16 v[116:117], v3 offset:4616
  ds_read_b64_tr_b16 v[118:119], v3 offset:6664
  s_waitcnt vmcnt(8)
  s_waitcnt lgkmcnt(6)
  v_mfma_f32_16x16x32_bf16 a[0:3], v[104:107], v[72:75], a[0:3]
  s_add_u32 s35, s34, 31
  s_and_b32 s35, s35, 3
  s_add_u32 s35, s35, 28
  s_mul_i32 s35, s35, 40960
  v_add_u32 v2, s35, v6
  s_add_u32 m0, s32, 12288
  s_nop 0
  buffer_load_dwordx4 v2, s[12:15], 0 offen lds
  v_mfma_f32_16x16x32_bf16 a[4:7], v[104:107], v[76:79], a[4:7]
  v_mfma_f32_16x16x32_bf16 a[8:11], v[104:107], v[80:83], a[8:11]
  s_add_u32 m0, s32, 13312
  s_nop 0
  buffer_load_dwordx4 v2, s[12:15], s57 offen lds
  v_mfma_f32_16x16x32_bf16 a[12:15], v[104:107], v[84:87], a[12:15]
  v_mfma_f32_16x16x32_bf16 a[16:19], v[104:107], v[88:91], a[16:19]
  s_add_u32 m0, s32, 14336
  s_nop 0
  buffer_load_dwordx4 v2, s[12:15], s58 offen lds
  v_mfma_f32_16x16x32_bf16 a[20:23], v[104:107], v[92:95], a[20:23]
  v_mfma_f32_16x16x32_bf16 a[24:27], v[104:107], v[96:99], a[24:27]
  s_add_u32 m0, s32, 15360
  s_nop 0
  buffer_load_dwordx4 v2, s[12:15], s59 offen lds
  v_mfma_f32_16x16x32_bf16 a[28:31], v[104:107], v[100:103], a[28:31]
  ds_read_b64_tr_b16 v[104:105], v3 offset:8192
  ds_read_b64_tr_b16 v[106:107], v3 offset:10240
  s_waitcnt lgkmcnt(6)
  v_mfma_f32_16x16x32_bf16 a[32:35], v[108:111], v[72:75], a[32:35]
  s_add_u32 s35, s34, 31
  s_and_b32 s35, s35, 3
  s_add_u32 s35, s35, 28
  s_lshl_b32 s35, s35, 10
  v_add_u32 v1, s35, v7
  buffer_load_dwordx4 v[40:43], v1, s[8:11], 0 offen
  v_mfma_f32_16x16x32_bf16 a[36:39], v[108:111], v[76:79], a[36:39]
  v_mfma_f32_16x16x32_bf16 a[40:43], v[108:111], v[80:83], a[40:43]
  buffer_load_dwordx4 v[44:47], v1, s[8:11], s49 offen
  v_mfma_f32_16x16x32_bf16 a[44:47], v[108:111], v[84:87], a[44:47]
  v_mfma_f32_16x16x32_bf16 a[48:51], v[108:111], v[88:91], a[48:51]
  buffer_load_dwordx4 v[48:51], v1, s[8:11], s50 offen
  v_mfma_f32_16x16x32_bf16 a[52:55], v[108:111], v[92:95], a[52:55]
  v_mfma_f32_16x16x32_bf16 a[56:59], v[108:111], v[96:99], a[56:59]
  buffer_load_dwordx4 v[52:55], v1, s[8:11], s51 offen
  v_mfma_f32_16x16x32_bf16 a[60:63], v[108:111], v[100:103], a[60:63]
  ds_read_b64_tr_b16 v[108:109], v3 offset:8200
  ds_read_b64_tr_b16 v[110:111], v3 offset:10248
  s_waitcnt lgkmcnt(6)
  v_mfma_f32_16x16x32_bf16 a[64:67], v[112:115], v[72:75], a[64:67]
  buffer_load_dwordx4 v[56:59], v1, s[8:11], s52 offen
  v_mfma_f32_16x16x32_bf16 a[68:71], v[112:115], v[76:79], a[68:71]
  v_mfma_f32_16x16x32_bf16 a[72:75], v[112:115], v[80:83], a[72:75]
  buffer_load_dwordx4 v[60:63], v1, s[8:11], s53 offen
  v_mfma_f32_16x16x32_bf16 a[76:79], v[112:115], v[84:87], a[76:79]
  v_mfma_f32_16x16x32_bf16 a[80:83], v[112:115], v[88:91], a[80:83]
  buffer_load_dwordx4 v[64:67], v1, s[8:11], s54 offen
  v_mfma_f32_16x16x32_bf16 a[84:87], v[112:115], v[92:95], a[84:87]
  v_mfma_f32_16x16x32_bf16 a[88:91], v[112:115], v[96:99], a[88:91]
  buffer_load_dwordx4 v[68:71], v1, s[8:11], s55 offen
  v_mfma_f32_16x16x32_bf16 a[92:95], v[112:115], v[100:103], a[92:95]
  ds_read_b64_tr_b16 v[112:113], v3 offset:8704
  ds_read_b64_tr_b16 v[114:115], v3 offset:10752
  s_waitcnt lgkmcnt(6)
  v_mfma_f32_16x16x32_bf16 a[96:99], v[116:119], v[72:75], a[96:99]
  v_mfma_f32_16x16x32_bf16 a[100:103], v[116:119], v[76:79], a[100:103]
  v_mfma_f32_16x16x32_bf16 a[104:107], v[116:119], v[80:83], a[104:107]
  v_mfma_f32_16x16x32_bf16 a[108:111], v[116:119], v[84:87], a[108:111]
  v_mfma_f32_16x16x32_bf16 a[112:115], v[116:119], v[88:91], a[112:115]
  v_mfma_f32_16x16x32_bf16 a[116:119], v[116:119], v[92:95], a[116:119]
  v_mfma_f32_16x16x32_bf16 a[120:123], v[116:119], v[96:99], a[120:123]
  v_mfma_f32_16x16x32_bf16 a[124:127], v[116:119], v[100:103], a[124:127]
  ds_read_b64_tr_b16 v[116:117], v3 offset:8712
  ds_read_b64_tr_b16 v[118:119], v3 offset:10760
  s_waitcnt vmcnt(8)
  s_waitcnt lgkmcnt(6)
  v_mfma_f32_16x16x32_bf16 a[0:3], v[104:107], v[8:11], a[0:3]
  v_mfma_f32_16x16x32_bf16 a[4:7], v[104:107], v[12:15], a[4:7]
  v_mfma_f32_16x16x32_bf16 a[8:11], v[104:107], v[16:19], a[8:11]
  v_mfma_f32_16x16x32_bf16 a[12:15], v[104:107], v[20:23], a[12:15]
  v_mfma_f32_16x16x32_bf16 a[16:19], v[104:107], v[24:27], a[16:19]
  v_mfma_f32_16x16x32_bf16 a[20:23], v[104:107], v[28:31], a[20:23]
  v_mfma_f32_16x16x32_bf16 a[24:27], v[104:107], v[32:35], a[24:27]
  v_mfma_f32_16x16x32_bf16 a[28:31], v[104:107], v[36:39], a[28:31]
  ds_read_b64_tr_b16 v[104:105], v3 offset:12288
  ds_read_b64_tr_b16 v[106:107], v3 offset:14336
  s_waitcnt lgkmcnt(6)
  v_mfma_f32_16x16x32_bf16 a[32:35], v[108:111], v[8:11], a[32:35]
  v_mfma_f32_16x16x32_bf16 a[36:39], v[108:111], v[12:15], a[36:39]
  v_mfma_f32_16x16x32_bf16 a[40:43], v[108:111], v[16:19], a[40:43]
  v_mfma_f32_16x16x32_bf16 a[44:47], v[108:111], v[20:23], a[44:47]
  v_mfma_f32_16x16x32_bf16 a[48:51], v[108:111], v[24:27], a[48:51]
  v_mfma_f32_16x16x32_bf16 a[52:55], v[108:111], v[28:31], a[52:55]
  v_mfma_f32_16x16x32_bf16 a[56:59], v[108:111], v[32:35], a[56:59]
  v_mfma_f32_16x16x32_bf16 a[60:63], v[108:111], v[36:39], a[60:63]
  ds_read_b64_tr_b16 v[108:109], v3 offset:12296
  ds_read_b64_tr_b16 v[110:111], v3 offset:14344
  s_waitcnt lgkmcnt(6)
  v_mfma_f32_16x16x32_bf16 a[64:67], v[112:115], v[8:11], a[64:67]
  v_mfma_f32_16x16x32_bf16 a[68:71], v[112:115], v[12:15], a[68:71]
  v_mfma_f32_16x16x32_bf16 a[72:75], v[112:115], v[16:19], a[72:75]
  v_mfma_f32_16x16x32_bf16 a[76:79], v[112:115], v[20:23], a[76:79]
  v_mfma_f32_16x16x32_bf16 a[80:83], v[112:115], v[24:27], a[80:83]
  v_mfma_f32_16x16x32_bf16 a[84:87], v[112:115], v[28:31], a[84:87]
  v_mfma_f32_16x16x32_bf16 a[88:91], v[112:115], v[32:35], a[88:91]
  v_mfma_f32_16x16x32_bf16 a[92:95], v[112:115], v[36:39], a[92:95]
  ds_read_b64_tr_b16 v[112:113], v3 offset:12800
  ds_read_b64_tr_b16 v[114:115], v3 offset:14848
  s_waitcnt lgkmcnt(6)
  v_mfma_f32_16x16x32_bf16 a[96:99], v[116:119], v[8:11], a[96:99]
  v_mfma_f32_16x16x32_bf16 a[100:103], v[116:119], v[12:15], a[100:103]
  v_mfma_f32_16x16x32_bf16 a[104:107], v[116:119], v[16:19], a[104:107]
  v_mfma_f32_16x16x32_bf16 a[108:111], v[116:119], v[20:23], a[108:111]
  v_mfma_f32_16x16x32_bf16 a[112:115], v[116:119], v[24:27], a[112:115]
  v_mfma_f32_16x16x32_bf16 a[116:119], v[116:119], v[28:31], a[116:119]
  v_mfma_f32_16x16x32_bf16 a[120:123], v[116:119], v[32:35], a[120:123]
  v_mfma_f32_16x16x32_bf16 a[124:127], v[116:119], v[36:39], a[124:127]
  ds_read_b64_tr_b16 v[116:117], v3 offset:12808
  ds_read_b64_tr_b16 v[118:119], v3 offset:14856
  s_waitcnt vmcnt(0)
  s_waitcnt lgkmcnt(6)
  v_mfma_f32_16x16x32_bf16 a[0:3], v[104:107], v[40:43], a[0:3]
  v_mfma_f32_16x16x32_bf16 a[4:7], v[104:107], v[44:47], a[4:7]
  v_mfma_f32_16x16x32_bf16 a[8:11], v[104:107], v[48:51], a[8:11]
  v_mfma_f32_16x16x32_bf16 a[12:15], v[104:107], v[52:55], a[12:15]
  v_mfma_f32_16x16x32_bf16 a[16:19], v[104:107], v[56:59], a[16:19]
  v_mfma_f32_16x16x32_bf16 a[20:23], v[104:107], v[60:63], a[20:23]
  v_mfma_f32_16x16x32_bf16 a[24:27], v[104:107], v[64:67], a[24:27]
  v_mfma_f32_16x16x32_bf16 a[28:31], v[104:107], v[68:71], a[28:31]
  s_waitcnt lgkmcnt(4)
  v_mfma_f32_16x16x32_bf16 a[32:35], v[108:111], v[40:43], a[32:35]
  v_mfma_f32_16x16x32_bf16 a[36:39], v[108:111], v[44:47], a[36:39]
  v_mfma_f32_16x16x32_bf16 a[40:43], v[108:111], v[48:51], a[40:43]
  v_mfma_f32_16x16x32_bf16 a[44:47], v[108:111], v[52:55], a[44:47]
  v_mfma_f32_16x16x32_bf16 a[48:51], v[108:111], v[56:59], a[48:51]
  v_mfma_f32_16x16x32_bf16 a[52:55], v[108:111], v[60:63], a[52:55]
  v_mfma_f32_16x16x32_bf16 a[56:59], v[108:111], v[64:67], a[56:59]
  v_mfma_f32_16x16x32_bf16 a[60:63], v[108:111], v[68:71], a[60:63]
  s_waitcnt lgkmcnt(2)
  v_mfma_f32_16x16x32_bf16 a[64:67], v[112:115], v[40:43], a[64:67]
  v_mfma_f32_16x16x32_bf16 a[68:71], v[112:115], v[44:47], a[68:71]
  v_mfma_f32_16x16x32_bf16 a[72:75], v[112:115], v[48:51], a[72:75]
  v_mfma_f32_16x16x32_bf16 a[76:79], v[112:115], v[52:55], a[76:79]
  v_mfma_f32_16x16x32_bf16 a[80:83], v[112:115], v[56:59], a[80:83]
  v_mfma_f32_16x16x32_bf16 a[84:87], v[112:115], v[60:63], a[84:87]
  v_mfma_f32_16x16x32_bf16 a[88:91], v[112:115], v[64:67], a[88:91]
  v_mfma_f32_16x16x32_bf16 a[92:95], v[112:115], v[68:71], a[92:95]
  s_waitcnt lgkmcnt(0)
  v_mfma_f32_16x16x32_bf16 a[96:99], v[116:119], v[40:43], a[96:99]
  v_mfma_f32_16x16x32_bf16 a[100:103], v[116:119], v[44:47], a[100:103]
  v_mfma_f32_16x16x32_bf16 a[104:107], v[116:119], v[48:51], a[104:107]
  v_mfma_f32_16x16x32_bf16 a[108:111], v[116:119], v[52:55], a[108:111]
  v_mfma_f32_16x16x32_bf16 a[112:115], v[116:119], v[56:59], a[112:115]
  v_mfma_f32_16x16x32_bf16 a[116:119], v[116:119], v[60:63], a[116:119]
  v_mfma_f32_16x16x32_bf16 a[120:123], v[116:119], v[64:67], a[120:123]
  v_mfma_f32_16x16x32_bf16 a[124:127], v[116:119], v[68:71], a[124:127]
  v_lshlrev_b32 v1, 4, v0
  s_lshl_b32 s38, s3, 15
  v_add_u32 v2, s38, v1
  s_lshl_b32 s38, s3, 13
  v_add_u32 v1, s38, v1
  v_add_u32 v3, 0x10000, v1
  s_mov_b32 s39, 40960
  s_barrier
  ds_write_b128 v2, a[0:3] offset:0
  ds_write_b128 v2, a[32:35] offset:1024
  ds_write_b128 v2, a[64:67] offset:2048
  ds_write_b128 v2, a[96:99] offset:3072
  ds_write_b128 v2, a[4:7] offset:4096
  ds_write_b128 v2, a[36:39] offset:5120
  ds_write_b128 v2, a[68:71] offset:6144
  ds_write_b128 v2, a[100:103] offset:7168
  ds_write_b128 v2, a[8:11] offset:8192
  ds_write_b128 v2, a[40:43] offset:9216
  ds_write_b128 v2, a[72:75] offset:10240
  ds_write_b128 v2, a[104:107] offset:11264
  ds_write_b128 v2, a[12:15] offset:12288
  ds_write_b128 v2, a[44:47] offset:13312
  ds_write_b128 v2, a[76:79] offset:14336
  ds_write_b128 v2, a[108:111] offset:15360
  ds_write_b128 v2, a[16:19] offset:16384
  ds_write_b128 v2, a[48:51] offset:17408
  ds_write_b128 v2, a[80:83] offset:18432
  ds_write_b128 v2, a[112:115] offset:19456
  ds_write_b128 v2, a[20:23] offset:20480
  ds_write_b128 v2, a[52:55] offset:21504
  ds_write_b128 v2, a[84:87] offset:22528
  ds_write_b128 v2, a[116:119] offset:23552
  ds_write_b128 v2, a[24:27] offset:24576
  ds_write_b128 v2, a[56:59] offset:25600
  ds_write_b128 v2, a[88:91] offset:26624
  ds_write_b128 v2, a[120:123] offset:27648
  ds_write_b128 v2, a[28:31] offset:28672
  ds_write_b128 v2, a[60:63] offset:29696
  ds_write_b128 v2, a[92:95] offset:30720
  ds_write_b128 v2, a[124:127] offset:31744
  s_waitcnt lgkmcnt(0)
  s_barrier
  ds_read_b128 v[8:11], v1 offset:0
  ds_read_b128 v[12:15], v1 offset:1024
  ds_read_b128 v[16:19], v1 offset:32768
  ds_read_b128 v[20:23], v1 offset:33792
  ds_read_b128 v[24:27], v3 offset:0
  ds_read_b128 v[28:31], v3 offset:1024
  ds_read_b128 v[32:35], v3 offset:32768
  ds_read_b128 v[36:39], v3 offset:33792
  ds_read_b128 v[40:43], v1 offset:2048
  ds_read_b128 v[44:47], v1 offset:3072
  ds_read_b128 v[48:51], v1 offset:34816
  ds_read_b128 v[52:55], v1 offset:35840
  ds_read_b128 v[56:59], v3 offset:2048
  ds_read_b128 v[60:63], v3 offset:3072
  ds_read_b128 v[64:67], v3 offset:34816
  ds_read_b128 v[68:71], v3 offset:35840
  ds_read_b128 v[72:75], v1 offset:4096
  ds_read_b128 v[76:79], v1 offset:5120
  ds_read_b128 v[80:83], v1 offset:36864
  ds_read_b128 v[84:87], v1 offset:37888
  ds_read_b128 v[88:91], v3 offset:4096
  ds_read_b128 v[92:95], v3 offset:5120
  ds_read_b128 v[96:99], v3 offset:36864
  ds_read_b128 v[100:103], v3 offset:37888
  ds_read_b128 v[104:107], v1 offset:6144
  ds_read_b128 v[108:111], v1 offset:7168
  ds_read_b128 v[112:115], v1 offset:38912
  ds_read_b128 v[116:119], v1 offset:39936
  ds_read_b128 v[120:123], v3 offset:6144
  ds_read_b128 v[124:127], v3 offset:7168
  ds_read_b128 v[128:131], v3 offset:38912
  ds_read_b128 v[132:135], v3 offset:39936
  s_waitcnt lgkmcnt(15)
  v_pk_add_f32 v[8:9], v[8:9], v[16:17]
  v_pk_add_f32 v[10:11], v[10:11], v[18:19]
  v_pk_add_f32 v[12:13], v[12:13], v[20:21]
  v_pk_add_f32 v[14:15], v[14:15], v[22:23]
  v_pk_add_f32 v[24:25], v[24:25], v[32:33]
  v_pk_add_f32 v[26:27], v[26:27], v[34:35]
  v_pk_add_f32 v[28:29], v[28:29], v[36:37]
  v_pk_add_f32 v[30:31], v[30:31], v[38:39]
  v_pk_add_f32 v[8:9], v[8:9], v[24:25]
  v_pk_add_f32 v[10:11], v[10:11], v[26:27]
  v_pk_add_f32 v[12:13], v[12:13], v[28:29]
  v_pk_add_f32 v[14:15], v[14:15], v[30:31]
  v_cvt_pk_bf16_f32 v8, v8, v9
  v_cvt_pk_bf16_f32 v9, v10, v11
  v_cvt_pk_bf16_f32 v10, v12, v13
  v_cvt_pk_bf16_f32 v11, v14, v15
  buffer_store_dwordx4 v[8:11], v4, s[16:19], 0 offen offset:0
  v_pk_add_f32 v[40:41], v[40:41], v[48:49]
  v_pk_add_f32 v[42:43], v[42:43], v[50:51]
  v_pk_add_f32 v[44:45], v[44:45], v[52:53]
  v_pk_add_f32 v[46:47], v[46:47], v[54:55]
  v_pk_add_f32 v[56:57], v[56:57], v[64:65]
  v_pk_add_f32 v[58:59], v[58:59], v[66:67]
  v_pk_add_f32 v[60:61], v[60:61], v[68:69]
  v_pk_add_f32 v[62:63], v[62:63], v[70:71]
  v_pk_add_f32 v[40:41], v[40:41], v[56:57]
  v_pk_add_f32 v[42:43], v[42:43], v[58:59]
  v_pk_add_f32 v[44:45], v[44:45], v[60:61]
  v_pk_add_f32 v[46:47], v[46:47], v[62:63]
  v_cvt_pk_bf16_f32 v40, v40, v41
  v_cvt_pk_bf16_f32 v41, v42, v43
  v_cvt_pk_bf16_f32 v42, v44, v45
  v_cvt_pk_bf16_f32 v43, v46, v47
  buffer_store_dwordx4 v[40:43], v4, s[16:19], 0 offen offset:64
  s_waitcnt lgkmcnt(12)
  v_pk_add_f32 v[72:73], v[72:73], v[80:81]
  v_pk_add_f32 v[74:75], v[74:75], v[82:83]
  v_pk_add_f32 v[76:77], v[76:77], v[84:85]
  v_pk_add_f32 v[78:79], v[78:79], v[86:87]
  s_waitcnt lgkmcnt(8)
  v_pk_add_f32 v[88:89], v[88:89], v[96:97]
  v_pk_add_f32 v[90:91], v[90:91], v[98:99]
  v_pk_add_f32 v[92:93], v[92:93], v[100:101]
  v_pk_add_f32 v[94:95], v[94:95], v[102:103]
  v_pk_add_f32 v[72:73], v[72:73], v[88:89]
  v_pk_add_f32 v[74:75], v[74:75], v[90:91]
  v_pk_add_f32 v[76:77], v[76:77], v[92:93]
  v_pk_add_f32 v[78:79], v[78:79], v[94:95]
  v_cvt_pk_bf16_f32 v72, v72, v73
  v_cvt_pk_bf16_f32 v73, v74, v75
  v_cvt_pk_bf16_f32 v74, v76, v77
  v_cvt_pk_bf16_f32 v75, v78, v79
  buffer_store_dwordx4 v[72:75], v4, s[16:19], s39 offen offset:0
  s_waitcnt lgkmcnt(4)
  v_pk_add_f32 v[104:105], v[104:105], v[112:113]
  v_pk_add_f32 v[106:107], v[106:107], v[114:115]
  v_pk_add_f32 v[108:109], v[108:109], v[116:117]
  v_pk_add_f32 v[110:111], v[110:111], v[118:119]
  s_waitcnt lgkmcnt(0)
  v_pk_add_f32 v[120:121], v[120:121], v[128:129]
  v_pk_add_f32 v[122:123], v[122:123], v[130:131]
  v_pk_add_f32 v[124:125], v[124:125], v[132:133]
  v_pk_add_f32 v[126:127], v[126:127], v[134:135]
  v_pk_add_f32 v[104:105], v[104:105], v[120:121]
  v_pk_add_f32 v[106:107], v[106:107], v[122:123]
  v_pk_add_f32 v[108:109], v[108:109], v[124:125]
  v_pk_add_f32 v[110:111], v[110:111], v[126:127]
  v_cvt_pk_bf16_f32 v104, v104, v105
  v_cvt_pk_bf16_f32 v105, v106, v107
  v_cvt_pk_bf16_f32 v106, v108, v109
  v_cvt_pk_bf16_f32 v107, v110, v111
  buffer_store_dwordx4 v[104:107], v4, s[16:19], s39 offen offset:64
O_END:
  s_endpgm
.section .rodata,"a"
.p2align 6
.amdhsa_kernel attn_kernel
  .amdhsa_next_free_vgpr 256
  .amdhsa_next_free_sgpr 72
  .amdhsa_accum_offset 112
  .amdhsa_group_segment_fixed_size 0
  .amdhsa_kernarg_size 104
  .amdhsa_user_sgpr_count 2
  .amdhsa_user_sgpr_kernarg_segment_ptr 1
  .amdhsa_system_sgpr_workgroup_id_x 1
.end_amdhsa_kernel
.p2align 6
.amdhsa_kernel oproj_kernel
  .amdhsa_next_free_vgpr 384
  .amdhsa_next_free_sgpr 72
  .amdhsa_accum_offset 256
  .amdhsa_group_segment_fixed_size 0
  .amdhsa_kernarg_size 104
  .amdhsa_user_sgpr_count 2
  .amdhsa_user_sgpr_kernarg_segment_ptr 1
  .amdhsa_system_sgpr_workgroup_id_x 1
.end_amdhsa_kernel
```
